```python
import torch

def _softmax(x, axis=-1):
    return torch.softmax(x, dim=axis)
def _gelu(x):
    return torch.nn.functional.gelu(x, approximate="tanh")
def _silu(x):
    return torch.nn.functional.silu(x)
def _sigmoid(x):
    return torch.sigmoid(x)
def _layernorm(x, axis=-1, eps=1e-5):
    m = x.mean(dim=axis, keepdim=True)
    v = x.var(dim=axis, keepdim=True, unbiased=False)
    return (x - m) / torch.sqrt(v + eps)
def _scatter_add(tgt, idx, src, axis=0):
    return tgt.clone().index_add_(axis, idx, src)
def _segment_sum(src, seg, n):
    out = torch.zeros((n,) + src.shape[1:], dtype=src.dtype)
    return out.index_add_(0, seg, src)
def _pad(x, pw):
    flat = tuple(v for pair in reversed(pw) for v in pair)
    return torch.nn.functional.pad(x, flat)

kernel_name = 'sequential_preLN__ssm_conv_s4d__mixer_s_mlp__prompt'

def setup_inputs():

    _w = (lambda a: (lambda t: t.to(torch.bfloat16) if t.is_floating_point() else t)(torch.as_tensor(a)))
    def _A_setup():
        Bsz, L, D, N = 1, 2048, 640, 192
        return {
            "u": _w((lambda *s: torch.randn(*s, dtype=torch.bfloat16) * 0.05)(Bsz, L, D)),
            "log_A_real": _w((lambda *s: torch.randn(*s, dtype=torch.bfloat16) * 6.4)(D, N) * 0.5),
            "A_imag": _w((lambda *s: torch.randn(*s, dtype=torch.bfloat16) * 0.05)(D, N) * 3.14),
            "C_real": _w((lambda *s: torch.randn(*s, dtype=torch.bfloat16) * 0.05)(D, N) / N ** 0.5),
            "C_imag": _w((lambda *s: torch.randn(*s, dtype=torch.bfloat16) * 0.05)(D, N) / N ** 0.5),
            "log_dt": _w((lambda *s: torch.randn(*s, dtype=torch.bfloat16) * 0.05)(D) * 0.5 - 4.0),
            "D_skip": _w((lambda *s: torch.randn(*s, dtype=torch.bfloat16) * 0.05)(D)),
        }
    _A_in = _A_setup()

    def _B_setup():
        B, S, D, F = 1, 2048, 640, 1536
        return {
            "x":  _w((lambda *s: torch.randn(*s, dtype=torch.bfloat16) * 0.05)(B, S, D)),
            "w1": _w((lambda *s: torch.randn(*s, dtype=torch.bfloat16) * 6.4)(D, D) * (D ** -0.5)),
            "w2": _w((lambda *s: torch.randn(*s, dtype=torch.bfloat16) * 6.4)(D, D) * (D ** -0.5)),
            "w3": _w((lambda *s: torch.randn(*s, dtype=torch.bfloat16) * 6.4)(D, F) * (D ** -0.5)),
            "w4": _w((lambda *s: torch.randn(*s, dtype=torch.bfloat16) * 3.2)(F, D) * (F ** -0.5)),
        }
    _B_in = _B_setup()

    return {
        "A_u": _A_in["u"],
        "A_log_A_real": _A_in["log_A_real"],
        "A_A_imag": _A_in["A_imag"],
        "A_C_real": _A_in["C_real"],
        "A_C_imag": _A_in["C_imag"],
        "A_log_dt": _A_in["log_dt"],
        "A_D_skip": _A_in["D_skip"],
        "B_x": _B_in["x"],
        "B_w1": _B_in["w1"],
        "B_w2": _B_in["w2"],
        "B_w3": _B_in["w3"],
        "B_w4": _B_in["w4"],
    }

def reference(A_u, A_log_A_real, A_A_imag, A_C_real, A_C_imag, A_log_dt, A_D_skip, B_x, B_w1, B_w2, B_w3, B_w4):
    def _A_ref(u, log_A_real, A_imag, C_real, C_imag, log_dt, D_skip):
        L = u.shape[1]
        dt = torch.exp(log_dt)
        A = -torch.exp(log_A_real) + 1j * A_imag
        C = (C_real + 1j * C_imag) * dt[:, None]
        pos = (lambda x, dt: x.to(dt))(torch.arange(L), log_dt.dtype)
        P = torch.exp((A * dt[:, None])[:, :, None] * pos[None, None, :])
        K = 2.0 * torch.einsum("dn,dnl->dl", C, P).real
        L2 = 2 * L
        u_t = (lambda x, *d: x.permute(*d))(u, 0, 2, 1)
        Kf = (lambda x, *a, **k: torch.fft.rfft(x.float(), *a, **k))(K, L2)
        Uf = (lambda x, *a, **k: torch.fft.rfft(x.float(), *a, **k))(u_t, L2)
        y = (lambda x, *a, **k: torch.fft.irfft(x, *a, **k).to(torch.bfloat16))(Uf * Kf[None, :, :], L2)[:, :, :L]
        y = (lambda x, *d: x.permute(*d))(y, 0, 2, 1)
        return y + u * D_skip[None, None, :]

    def _B_ref(x, w1, w2, w3, w4):
        B, S, D = x.shape
        h = _gelu(_layernorm(x, axis=-1) @ w1)
        c = D // 4
        g0 = _pad(h[:, :, 0*c:1*c], ((0, 0), (1, 0), (0, 0)))[:, :S, :]
        g1 = _pad(h[:, :, 1*c:2*c], ((0, 0), (0, 1), (0, 0)))[:, 1:, :]
        g2 = _pad(h[:, :, 2*c:3*c], ((0, 0), (2, 0), (0, 0)))[:, :S, :]
        g3 = _pad(h[:, :, 3*c:   ], ((0, 0), (0, 2), (0, 0)))[:, 2:, :]
        hs = torch.concatenate([g0, g1, g2, g3], axis=-1) @ w2
        x1 = x + hs
        h2 = _gelu(_layernorm(x1, axis=-1) @ w3) @ w4
        return x1 + h2

    x = A_u
    h = x + _A_ref(_layernorm(x, axis=-1), A_log_A_real, A_A_imag, A_C_real, A_C_imag, A_log_dt, A_D_skip)
    h2 = h + _B_ref(_layernorm(h, axis=-1), B_w1, B_w2, B_w3, B_w4)
    return h2
```

```asm
; @launch grid=(256,1,1) block=(256,1,1) lds=163840
.amdgcn_target "amdgcn-amd-amdhsa--gfx950"
.text
.globl sequential_preLN__ssm_conv_s4d__mixer_s_mlp__prompt_kernel
.p2align 8
.type sequential_preLN__ssm_conv_s4d__mixer_s_mlp__prompt_kernel,@function
sequential_preLN__ssm_conv_s4d__mixer_s_mlp__prompt_kernel:
  s_cmp_ge_u32 s2, 256
  s_cbranch_scc1 END
  s_load_dwordx16 s[64:79], s[0:1], 0
  s_load_dwordx8 s[80:87], s[0:1], 64
  s_load_dwordx4 s[88:91], s[0:1], 96
  s_load_dwordx2 s[92:93], s[0:1], 112
  v_lshrrev_b32 v1, 6, v0
  v_and_b32 v0, 63, v0
  s_and_b32 s4, s2, 7
  s_lshr_b32 s5, s2, 3
  v_readfirstlane_b32 s6, v1
  s_mul_i32 s94, s4, 80
  s_lshr_b32 s7, s5, 1
  s_mul_i32 s7, s7, 5
  s_add_u32 s94, s94, s7
  s_and_b32 s7, s5, 1
  s_sub_u32 s95, 3, s7
  s_mul_i32 s7, s7, 3
  s_add_u32 s94, s94, s7
  s_lshl_b32 s96, s4, 5
  s_add_u32 s96, s96, s5
  s_lshr_b32 s98, s96, 3
  s_and_b32 s99, s96, 7
  s_getpc_b64 s[28:29]
  s_and_b32 s28, s28, 0xffffff00
  s_mov_b32 s30, END-sequential_preLN__ssm_conv_s4d__mixer_s_mlp__prompt_kernel
  s_mov_b32 s31, 0x00020000
  s_lshl_b32 s7, s5, 2
  s_add_u32 s7, s7, s6
  s_lshl_b32 s7, s7, 10
  v_lshlrev_b32 v1, 4, v0
  buffer_load_dwordx4 v[252:255], v1, s[28:31], s7 offen
  v_lshlrev_b32 v110, 4, v0
  s_waitcnt lgkmcnt(0)
  s_load_dword s3, s[92:93], 0
  s_mov_b32 s8, s92
  s_mov_b32 s9, s93
  s_mov_b32 s10, 14614528
  s_mov_b32 s11, 0x00020000
  s_mov_b32 s20, s88
  s_mov_b32 s21, s89
  s_mov_b32 s22, 2621440
  s_mov_b32 s23, 0x00020000
  s_getreg_b32 s88, hwreg(HW_REG_XCC_ID, 0, 4)
  s_and_b32 s90, s99, 1
  s_lshr_b32 s91, s99, 1
  s_lshl_b32 s89, s99, 2
  s_add_u32 s89, s89, s6
  s_cmp_eq_u32 s6, 3
  s_cbranch_scc1 ln0_1
  s_cmp_ge_u32 s6, s95
  s_cbranch_scc1 pre_2
  s_add_u32 s40, s94, s6
  s_mov_b32 s24, s66
  s_mov_b32 s25, s67
  s_mov_b32 s26, 245760
  s_mov_b32 s27, 0x00020000
  s_mov_b32 s28, s68
  s_mov_b32 s29, s69
  s_mov_b32 s30, 245760
  s_mov_b32 s31, 0x00020000
  s_mov_b32 s32, s70
  s_mov_b32 s33, s71
  s_mov_b32 s34, 245760
  s_mov_b32 s35, 0x00020000
  s_mov_b32 s36, s72
  s_mov_b32 s37, s73
  s_mov_b32 s38, 245760
  s_mov_b32 s39, 0x00020000
  s_mov_b32 s12, s84
  s_mov_b32 s13, s85
  s_mov_b32 s14, 1966080
  s_mov_b32 s15, 0x00020000
  s_mul_i32 s41, s40, 384
  v_lshlrev_b32 v1, 2, v0
  v_lshlrev_b32 v2, 1, v0
  v_mov_b32 v8, 0
  v_mov_b32 v9, 0
  v_mov_b32 v10, 0
  v_mov_b32 v11, 0
  buffer_load_dword v4, v1, s[24:27], s41 offen
  buffer_load_short_d16_hi v8, v2, s[24:27], s41 offen offset:256
  buffer_load_dword v5, v1, s[28:31], s41 offen
  buffer_load_short_d16_hi v9, v2, s[28:31], s41 offen offset:256
  buffer_load_dword v6, v1, s[32:35], s41 offen
  buffer_load_short_d16_hi v10, v2, s[32:35], s41 offen offset:256
  buffer_load_dword v7, v1, s[36:39], s41 offen
  buffer_load_short_d16_hi v11, v2, s[36:39], s41 offen offset:256
  s_lshl_b32 s42, s40, 1
  s_and_b32 s42, s42, 0xfffffffc
  s_add_u32 s44, s74, s42
  s_addc_u32 s45, s75, 0
  s_load_dword s43, s[44:45], 0
  s_mul_i32 s46, s6, 16464
  s_mul_i32 s100, s40, 3277
  s_lshr_b32 s100, s100, 16
  s_mul_i32 s101, s100, 20
  s_sub_u32 s101, s40, s101
  s_mul_i32 s41, s101, 52
  s_lshr_b32 s41, s41, 8
  s_mul_i32 s42, s41, 5
  s_sub_u32 s42, s101, s42
  s_mul_i32 s41, s41, 160
  s_lshr_b32 s47, s42, 1
  s_mul_i32 s47, s47, 80
  s_and_b32 s7, s42, 1
  s_lshl_b32 s7, s7, 3
  s_add_u32 s47, s47, s7
  s_cmp_eq_u32 s42, 4
  s_cselect_b32 s47, 16, s47
  s_cselect_b32 s42, 20, 1
  s_mul_i32 s42, s42, 12288
  s_add_u32 s41, s41, s47
  s_mul_i32 s41, s41, 3072
  s_mul_i32 s7, s100, 96
  s_add_u32 s41, s41, s7
  s_mul_i32 s47, s6, 3072
  s_add_u32 s47, s47, 148736
  v_add_u32 v12, 0, v0
  v_mul_u32_u24 v13, 171, v12
  v_lshrrev_b32 v13, 10, v13
  v_mul_u32_u24 v14, 6, v13
  v_sub_u32 v12, v12, v14
  v_lshlrev_b32 v12, 4, v12
  v_lshrrev_b32 v14, 4, v13
  v_mul_lo_u32 v14, v14, s42
  v_add_u32 v12, v12, v14
  v_lshrrev_b32 v14, 2, v13
  v_and_b32 v14, 3, v14
  v_mul_u32_u24 v14, 20, v14
  v_and_b32 v13, 3, v13
  v_add_u32 v13, v13, v14
  v_mul_u32_u24 v13, 3072, v13
  v_add_u32 v90, v12, v13
  v_add_u32 v12, 64, v0
  v_mul_u32_u24 v13, 171, v12
  v_lshrrev_b32 v13, 10, v13
  v_mul_u32_u24 v14, 6, v13
  v_sub_u32 v12, v12, v14
  v_lshlrev_b32 v12, 4, v12
  v_lshrrev_b32 v14, 4, v13
  v_mul_lo_u32 v14, v14, s42
  v_add_u32 v12, v12, v14
  v_lshrrev_b32 v14, 2, v13
  v_and_b32 v14, 3, v14
  v_mul_u32_u24 v14, 20, v14
  v_and_b32 v13, 3, v13
  v_add_u32 v13, v13, v14
  v_mul_u32_u24 v13, 3072, v13
  v_add_u32 v91, v12, v13
  v_add_u32 v12, 128, v0
  v_mul_u32_u24 v13, 171, v12
  v_lshrrev_b32 v13, 10, v13
  v_mul_u32_u24 v14, 6, v13
  v_sub_u32 v12, v12, v14
  v_lshlrev_b32 v12, 4, v12
  v_lshrrev_b32 v14, 4, v13
  v_mul_lo_u32 v14, v14, s42
  v_add_u32 v12, v12, v14
  v_lshrrev_b32 v14, 2, v13
  v_and_b32 v14, 3, v14
  v_mul_u32_u24 v14, 20, v14
  v_and_b32 v13, 3, v13
  v_add_u32 v13, v13, v14
  v_mul_u32_u24 v13, 3072, v13
  v_add_u32 v92, v12, v13
  s_add_u32 m0, s47, 0
  s_nop 0
  buffer_load_dwordx4 v90, s[12:15], s41 offen lds
  s_add_u32 m0, s47, 1024
  s_nop 0
  buffer_load_dwordx4 v91, s[12:15], s41 offen lds
  s_add_u32 m0, s47, 2048
  s_nop 0
  buffer_load_dwordx4 v92, s[12:15], s41 offen lds
  v_lshrrev_b32 v93, 2, v0
  v_mul_u32_u24 v93, 96, v93
  v_and_b32 v12, 3, v0
  v_lshlrev_b32 v12, 3, v12
  v_add_u32 v93, v93, v12
  v_add_u32 v93, s47, v93
  s_mul_i32 s100, s40, 3072
  s_add_u32 s100, s100, 10682368
  s_lshl_b32 s101, s40, 7
  s_add_u32 s101, s101, 425984
  s_mul_i32 s79, s6, 25088
  s_add_u32 s79, s79, 49392
  s_mov_b32 m0, s46
  s_waitcnt lgkmcnt(0)
  s_mul_i32 s3, s3, 1664525
  s_add_u32 s3, s3, 1013904223
  s_xor_b32 s88, s88, s3
  s_bitcmp1_b32 s40, 0
  s_cselect_b32 s42, 0, 16
  s_lshl_b32 s43, s43, s42
  s_and_b32 s43, s43, 0xffff0000
  v_mov_b32 v3, s43
  v_mul_f32 v3, 0x3fb8aa3b, v3
  v_exp_f32 v3, v3
  s_nop 0
  v_cvt_pk_bf16_f32 v3, v3, v3
  v_lshlrev_b32 v3, 16, v3
  s_mov_b32 s44, 0xffff0000
  s_waitcnt vmcnt(3)
  v_lshlrev_b32 v12, 16, v4
  v_and_b32 v13, s44, v4
  v_mov_b32 v14, v8
  v_lshlrev_b32 v15, 16, v5
  v_and_b32 v16, s44, v5
  v_mov_b32 v17, v9
  v_lshlrev_b32 v18, 16, v6
  v_and_b32 v20, s44, v6
  v_mov_b32 v22, v10
  v_lshlrev_b32 v19, 16, v7
  v_and_b32 v21, s44, v7
  v_mov_b32 v23, v11
  v_mul_f32 v12, 0x3fb8aa3b, v12
  v_mul_f32 v13, 0x3fb8aa3b, v13
  v_mul_f32 v14, 0x3fb8aa3b, v14
  v_exp_f32 v12, v12
  v_exp_f32 v13, v13
  v_exp_f32 v14, v14
  v_cvt_pk_bf16_f32 v12, v12, v12
  v_lshlrev_b32 v12, 16, v12
  v_cvt_pk_bf16_f32 v13, v13, v13
  v_lshlrev_b32 v13, 16, v13
  v_cvt_pk_bf16_f32 v14, v14, v14
  v_lshlrev_b32 v14, 16, v14
  v_max3_f32 v4, |v18|, |v19|, |v20|
  v_max3_f32 v5, |v21|, |v22|, |v23|
  v_max_f32 v4, v4, v5
  s_nop 1
  v_max_f32_dpp v4, v4, v4 quad_perm:[1,0,3,2] row_mask:0xf bank_mask:0xf
  s_nop 1
  v_max_f32_dpp v4, v4, v4 quad_perm:[2,3,0,1] row_mask:0xf bank_mask:0xf
  s_nop 1
  v_max_f32_dpp v4, v4, v4 row_half_mirror row_mask:0xf bank_mask:0xf
  s_nop 1
  v_max_f32_dpp v4, v4, v4 row_mirror row_mask:0xf bank_mask:0xf
  v_mov_b32 v5, v4
  s_nop 1
  v_permlane16_swap_b32 v4, v5
  v_max_f32 v4, v4, v5
  v_mov_b32 v5, v4
  s_nop 1
  v_permlane32_swap_b32 v4, v5
  v_max_f32 v4, v4, v5
  v_frexp_exp_i32_f32 v4, v4
  v_add_f32 v5, v3, v3
  v_ldexp_f32 v5, v5, v4
  v_sub_u32 v4, 0, v4
  v_readfirstlane_b32 s78, v5
  v_ldexp_f32 v18, v18, v4
  v_ldexp_f32 v19, v19, v4
  v_ldexp_f32 v20, v20, v4
  v_ldexp_f32 v21, v21, v4
  v_ldexp_f32 v22, v22, v4
  v_ldexp_f32 v23, v23, v4
  v_mul_f32 v12, v12, v3
  v_mul_f32 v15, v15, v3
  v_mul_f32 v13, v13, v3
  v_mul_f32 v16, v16, v3
  v_mul_f32 v14, v14, v3
  v_mul_f32 v17, v17, v3
  v_mul_f32 v12, 0xbfb8aa3b, v12
  v_mul_f32 v15, 0.15915494, v15
  v_mul_f32 v13, 0xbfb8aa3b, v13
  v_mul_f32 v16, 0.15915494, v16
  v_mul_f32 v14, 0xbfb8aa3b, v14
  v_mul_f32 v17, 0.15915494, v17
  v_mul_f32 v4, 1.0, v12
  v_mul_f32 v8, 1.0, v15
  v_mul_f32 v5, 1.0, v13
  v_mul_f32 v9, 1.0, v16
  v_mul_f32 v6, 1.0, v14
  v_mul_f32 v10, 1.0, v17
  v_exp_f32 v4, v4
  v_fract_f32 v8, v8
  v_exp_f32 v5, v5
  v_fract_f32 v9, v9
  v_exp_f32 v6, v6
  v_fract_f32 v10, v10
  v_cos_f32 v24, v8
  v_sin_f32 v25, v8
  v_cos_f32 v26, v9
  v_sin_f32 v27, v9
  v_cos_f32 v28, v10
  v_sin_f32 v29, v10
  v_mul_f32 v24, v24, v4
  v_mul_f32 v25, v25, v4
  v_mul_f32 v26, v26, v5
  v_mul_f32 v27, v27, v5
  v_mul_f32 v28, v28, v6
  v_mul_f32 v29, v29, v6
  v_mul_f32 v4, 0x41000000, v12
  v_mul_f32 v8, 0x41000000, v15
  v_mul_f32 v5, 0x41000000, v13
  v_mul_f32 v9, 0x41000000, v16
  v_mul_f32 v6, 0x41000000, v14
  v_mul_f32 v10, 0x41000000, v17
  v_exp_f32 v4, v4
  v_fract_f32 v8, v8
  v_exp_f32 v5, v5
  v_fract_f32 v9, v9
  v_exp_f32 v6, v6
  v_fract_f32 v10, v10
  v_cos_f32 v30, v8
  v_sin_f32 v31, v8
  v_cos_f32 v32, v9
  v_sin_f32 v33, v9
  v_cos_f32 v34, v10
  v_sin_f32 v35, v10
  v_mul_f32 v30, v30, v4
  v_mul_f32_e64 v31, -v31, v4
  v_mul_f32 v32, v32, v5
  v_mul_f32_e64 v33, -v33, v5
  v_mul_f32 v34, v34, v6
  v_mul_f32_e64 v35, -v35, v6
  v_mul_f32 v4, 0x43800000, v12
  v_mul_f32 v8, 0x43800000, v15
  v_mul_f32 v5, 0x43800000, v13
  v_mul_f32 v9, 0x43800000, v16
  v_mul_f32 v6, 0x43800000, v14
  v_mul_f32 v10, 0x43800000, v17
  v_exp_f32 v4, v4
  v_fract_f32 v8, v8
  v_exp_f32 v5, v5
  v_fract_f32 v9, v9
  v_exp_f32 v6, v6
  v_fract_f32 v10, v10
  v_cos_f32 v36, v8
  v_sin_f32 v37, v8
  v_cos_f32 v38, v9
  v_sin_f32 v39, v9
  v_cos_f32 v40, v10
  v_sin_f32 v41, v10
  v_mul_f32 v36, v36, v4
  v_mul_f32 v37, v37, v4
  v_mul_f32 v38, v38, v5
  v_mul_f32 v39, v39, v5
  v_mul_f32 v40, v40, v6
  v_mul_f32 v41, v41, v6
  v_cvt_pk_f16_f32 v68, v18, v19
  v_cvt_pk_f16_f32 v69, v20, v21
  v_cvt_pk_f16_f32 v70, v22, v23
  ds_write_addtid_b32 v68 offset:0
  ds_write_addtid_b32 v69 offset:256
  ds_write_addtid_b32 v70 offset:512
  v_pk_mul_f32 v[60:61], v[18:19], v[24:25] op_sel_hi:[1,0]
  v_pk_mul_f32 v[62:63], v[20:21], v[26:27] op_sel_hi:[1,0]
  v_pk_mul_f32 v[64:65], v[22:23], v[28:29] op_sel_hi:[1,0]
  v_pk_fma_f32 v[54:55], v[18:19], v[24:25], v[60:61] op_sel:[1,1,0] op_sel_hi:[0,1,1] neg_lo:[1,0,0]
  v_pk_fma_f32 v[56:57], v[20:21], v[26:27], v[62:63] op_sel:[1,1,0] op_sel_hi:[0,1,1] neg_lo:[1,0,0]
  v_pk_fma_f32 v[58:59], v[22:23], v[28:29], v[64:65] op_sel:[1,1,0] op_sel_hi:[0,1,1] neg_lo:[1,0,0]
  v_cvt_pk_f16_f32 v72, v54, v55
  v_cvt_pk_f16_f32 v73, v56, v57
  v_cvt_pk_f16_f32 v74, v58, v59
  ds_write_addtid_b32 v72 offset:784
  ds_write_addtid_b32 v73 offset:1040
  ds_write_addtid_b32 v74 offset:1296
  v_pk_mul_f32 v[60:61], v[54:55], v[24:25] op_sel_hi:[1,0]
  v_pk_mul_f32 v[62:63], v[56:57], v[26:27] op_sel_hi:[1,0]
  v_pk_mul_f32 v[64:65], v[58:59], v[28:29] op_sel_hi:[1,0]
  v_pk_fma_f32 v[54:55], v[54:55], v[24:25], v[60:61] op_sel:[1,1,0] op_sel_hi:[0,1,1] neg_lo:[1,0,0]
  v_pk_fma_f32 v[56:57], v[56:57], v[26:27], v[62:63] op_sel:[1,1,0] op_sel_hi:[0,1,1] neg_lo:[1,0,0]
  v_pk_fma_f32 v[58:59], v[58:59], v[28:29], v[64:65] op_sel:[1,1,0] op_sel_hi:[0,1,1] neg_lo:[1,0,0]
  v_cvt_pk_f16_f32 v76, v54, v55
  v_cvt_pk_f16_f32 v77, v56, v57
  v_cvt_pk_f16_f32 v78, v58, v59
  ds_write_addtid_b32 v76 offset:1568
  ds_write_addtid_b32 v77 offset:1824
  ds_write_addtid_b32 v78 offset:2080
  v_pk_mul_f32 v[60:61], v[54:55], v[24:25] op_sel_hi:[1,0]
  v_pk_mul_f32 v[62:63], v[56:57], v[26:27] op_sel_hi:[1,0]
  v_pk_mul_f32 v[64:65], v[58:59], v[28:29] op_sel_hi:[1,0]
  v_pk_fma_f32 v[54:55], v[54:55], v[24:25], v[60:61] op_sel:[1,1,0] op_sel_hi:[0,1,1] neg_lo:[1,0,0]
  v_pk_fma_f32 v[56:57], v[56:57], v[26:27], v[62:63] op_sel:[1,1,0] op_sel_hi:[0,1,1] neg_lo:[1,0,0]
  v_pk_fma_f32 v[58:59], v[58:59], v[28:29], v[64:65] op_sel:[1,1,0] op_sel_hi:[0,1,1] neg_lo:[1,0,0]
  v_cvt_pk_f16_f32 v68, v54, v55
  v_cvt_pk_f16_f32 v69, v56, v57
  v_cvt_pk_f16_f32 v70, v58, v59
  ds_write_addtid_b32 v68 offset:2352
  ds_write_addtid_b32 v69 offset:2608
  ds_write_addtid_b32 v70 offset:2864
  v_pk_mul_f32 v[60:61], v[54:55], v[24:25] op_sel_hi:[1,0]
  v_pk_mul_f32 v[62:63], v[56:57], v[26:27] op_sel_hi:[1,0]
  v_pk_mul_f32 v[64:65], v[58:59], v[28:29] op_sel_hi:[1,0]
  v_pk_fma_f32 v[54:55], v[54:55], v[24:25], v[60:61] op_sel:[1,1,0] op_sel_hi:[0,1,1] neg_lo:[1,0,0]
  v_pk_fma_f32 v[56:57], v[56:57], v[26:27], v[62:63] op_sel:[1,1,0] op_sel_hi:[0,1,1] neg_lo:[1,0,0]
  v_pk_fma_f32 v[58:59], v[58:59], v[28:29], v[64:65] op_sel:[1,1,0] op_sel_hi:[0,1,1] neg_lo:[1,0,0]
  v_cvt_pk_f16_f32 v72, v54, v55
  v_cvt_pk_f16_f32 v73, v56, v57
  v_cvt_pk_f16_f32 v74, v58, v59
  ds_write_addtid_b32 v72 offset:3136
  ds_write_addtid_b32 v73 offset:3392
  ds_write_addtid_b32 v74 offset:3648
  v_pk_mul_f32 v[60:61], v[54:55], v[24:25] op_sel_hi:[1,0]
  v_pk_mul_f32 v[62:63], v[56:57], v[26:27] op_sel_hi:[1,0]
  v_pk_mul_f32 v[64:65], v[58:59], v[28:29] op_sel_hi:[1,0]
  v_pk_fma_f32 v[54:55], v[54:55], v[24:25], v[60:61] op_sel:[1,1,0] op_sel_hi:[0,1,1] neg_lo:[1,0,0]
  v_pk_fma_f32 v[56:57], v[56:57], v[26:27], v[62:63] op_sel:[1,1,0] op_sel_hi:[0,1,1] neg_lo:[1,0,0]
  v_pk_fma_f32 v[58:59], v[58:59], v[28:29], v[64:65] op_sel:[1,1,0] op_sel_hi:[0,1,1] neg_lo:[1,0,0]
  v_cvt_pk_f16_f32 v76, v54, v55
  v_cvt_pk_f16_f32 v77, v56, v57
  v_cvt_pk_f16_f32 v78, v58, v59
  ds_write_addtid_b32 v76 offset:3920
  ds_write_addtid_b32 v77 offset:4176
  ds_write_addtid_b32 v78 offset:4432
  v_pk_mul_f32 v[60:61], v[54:55], v[24:25] op_sel_hi:[1,0]
  v_pk_mul_f32 v[62:63], v[56:57], v[26:27] op_sel_hi:[1,0]
  v_pk_mul_f32 v[64:65], v[58:59], v[28:29] op_sel_hi:[1,0]
  v_pk_fma_f32 v[54:55], v[54:55], v[24:25], v[60:61] op_sel:[1,1,0] op_sel_hi:[0,1,1] neg_lo:[1,0,0]
  v_pk_fma_f32 v[56:57], v[56:57], v[26:27], v[62:63] op_sel:[1,1,0] op_sel_hi:[0,1,1] neg_lo:[1,0,0]
  v_pk_fma_f32 v[58:59], v[58:59], v[28:29], v[64:65] op_sel:[1,1,0] op_sel_hi:[0,1,1] neg_lo:[1,0,0]
  v_cvt_pk_f16_f32 v68, v54, v55
  v_cvt_pk_f16_f32 v69, v56, v57
  v_cvt_pk_f16_f32 v70, v58, v59
  ds_write_addtid_b32 v68 offset:4704
  ds_write_addtid_b32 v69 offset:4960
  ds_write_addtid_b32 v70 offset:5216
  v_pk_mul_f32 v[60:61], v[54:55], v[24:25] op_sel_hi:[1,0]
  v_pk_mul_f32 v[62:63], v[56:57], v[26:27] op_sel_hi:[1,0]
  v_pk_mul_f32 v[64:65], v[58:59], v[28:29] op_sel_hi:[1,0]
  v_pk_fma_f32 v[54:55], v[54:55], v[24:25], v[60:61] op_sel:[1,1,0] op_sel_hi:[0,1,1] neg_lo:[1,0,0]
  v_pk_fma_f32 v[56:57], v[56:57], v[26:27], v[62:63] op_sel:[1,1,0] op_sel_hi:[0,1,1] neg_lo:[1,0,0]
  v_pk_fma_f32 v[58:59], v[58:59], v[28:29], v[64:65] op_sel:[1,1,0] op_sel_hi:[0,1,1] neg_lo:[1,0,0]
  v_cvt_pk_f16_f32 v72, v54, v55
  v_cvt_pk_f16_f32 v73, v56, v57
  v_cvt_pk_f16_f32 v74, v58, v59
  ds_write_addtid_b32 v72 offset:5488
  ds_write_addtid_b32 v73 offset:5744
  ds_write_addtid_b32 v74 offset:6000
  v_pk_mul_f32 v[60:61], v[24:25], v[24:25] op_sel_hi:[1,0]
  v_pk_mul_f32 v[62:63], v[26:27], v[26:27] op_sel_hi:[1,0]
  v_pk_mul_f32 v[64:65], v[28:29], v[28:29] op_sel_hi:[1,0]
  v_pk_fma_f32 v[42:43], v[24:25], v[24:25], v[60:61] op_sel:[1,1,0] op_sel_hi:[0,1,1] neg_lo:[1,0,0]
  v_pk_fma_f32 v[44:45], v[26:27], v[26:27], v[62:63] op_sel:[1,1,0] op_sel_hi:[0,1,1] neg_lo:[1,0,0]
  v_pk_fma_f32 v[46:47], v[28:29], v[28:29], v[64:65] op_sel:[1,1,0] op_sel_hi:[0,1,1] neg_lo:[1,0,0]
  v_pk_mul_f32 v[60:61], v[42:43], v[42:43] op_sel_hi:[1,0]
  v_pk_mul_f32 v[62:63], v[44:45], v[44:45] op_sel_hi:[1,0]
  v_pk_mul_f32 v[64:65], v[46:47], v[46:47] op_sel_hi:[1,0]
  v_pk_fma_f32 v[48:49], v[42:43], v[42:43], v[60:61] op_sel:[1,1,0] op_sel_hi:[0,1,1] neg_lo:[1,0,0]
  v_pk_fma_f32 v[50:51], v[44:45], v[44:45], v[62:63] op_sel:[1,1,0] op_sel_hi:[0,1,1] neg_lo:[1,0,0]
  v_pk_fma_f32 v[52:53], v[46:47], v[46:47], v[64:65] op_sel:[1,1,0] op_sel_hi:[0,1,1] neg_lo:[1,0,0]
  v_pk_mul_f32 v[60:61], v[18:19], v[36:37] op_sel_hi:[1,0]
  v_pk_mul_f32 v[62:63], v[20:21], v[38:39] op_sel_hi:[1,0]
  v_pk_mul_f32 v[64:65], v[22:23], v[40:41] op_sel_hi:[1,0]
  v_pk_fma_f32 v[80:81], v[18:19], v[36:37], v[60:61] op_sel:[1,1,0] op_sel_hi:[0,1,1] neg_lo:[1,0,0]
  v_pk_fma_f32 v[82:83], v[20:21], v[38:39], v[62:63] op_sel:[1,1,0] op_sel_hi:[0,1,1] neg_lo:[1,0,0]
  v_pk_fma_f32 v[84:85], v[22:23], v[40:41], v[64:65] op_sel:[1,1,0] op_sel_hi:[0,1,1] neg_lo:[1,0,0]
  v_cvt_pk_f16_f32 v76, v80, v81
  v_cvt_pk_f16_f32 v77, v82, v83
  v_cvt_pk_f16_f32 v78, v84, v85
  ds_write_addtid_b32 v76 offset:6272
  ds_write_addtid_b32 v77 offset:6528
  ds_write_addtid_b32 v78 offset:6784
  v_pk_mul_f32 v[60:61], v[80:81], v[42:43] op_sel_hi:[1,0]
  v_pk_mul_f32 v[62:63], v[82:83], v[44:45] op_sel_hi:[1,0]
  v_pk_mul_f32 v[64:65], v[84:85], v[46:47] op_sel_hi:[1,0]
  v_pk_fma_f32 v[54:55], v[80:81], v[42:43], v[60:61] op_sel:[1,1,0] op_sel_hi:[0,1,1] neg_lo:[1,0,0]
  v_pk_fma_f32 v[56:57], v[82:83], v[44:45], v[62:63] op_sel:[1,1,0] op_sel_hi:[0,1,1] neg_lo:[1,0,0]
  v_pk_fma_f32 v[58:59], v[84:85], v[46:47], v[64:65] op_sel:[1,1,0] op_sel_hi:[0,1,1] neg_lo:[1,0,0]
  v_cvt_pk_f16_f32 v68, v54, v55
  v_cvt_pk_f16_f32 v69, v56, v57
  v_cvt_pk_f16_f32 v70, v58, v59
  ds_write_addtid_b32 v68 offset:7056
  ds_write_addtid_b32 v69 offset:7312
  ds_write_addtid_b32 v70 offset:7568
  v_pk_mul_f32 v[60:61], v[54:55], v[42:43] op_sel_hi:[1,0]
  v_pk_mul_f32 v[62:63], v[56:57], v[44:45] op_sel_hi:[1,0]
  v_pk_mul_f32 v[64:65], v[58:59], v[46:47] op_sel_hi:[1,0]
  v_pk_fma_f32 v[54:55], v[54:55], v[42:43], v[60:61] op_sel:[1,1,0] op_sel_hi:[0,1,1] neg_lo:[1,0,0]
  v_pk_fma_f32 v[56:57], v[56:57], v[44:45], v[62:63] op_sel:[1,1,0] op_sel_hi:[0,1,1] neg_lo:[1,0,0]
  v_pk_fma_f32 v[58:59], v[58:59], v[46:47], v[64:65] op_sel:[1,1,0] op_sel_hi:[0,1,1] neg_lo:[1,0,0]
  v_cvt_pk_f16_f32 v72, v54, v55
  v_cvt_pk_f16_f32 v73, v56, v57
  v_cvt_pk_f16_f32 v74, v58, v59
  ds_write_addtid_b32 v72 offset:7840
  ds_write_addtid_b32 v73 offset:8096
  ds_write_addtid_b32 v74 offset:8352
  v_pk_mul_f32 v[60:61], v[54:55], v[42:43] op_sel_hi:[1,0]
  v_pk_mul_f32 v[62:63], v[56:57], v[44:45] op_sel_hi:[1,0]
  v_pk_mul_f32 v[64:65], v[58:59], v[46:47] op_sel_hi:[1,0]
  v_pk_fma_f32 v[54:55], v[54:55], v[42:43], v[60:61] op_sel:[1,1,0] op_sel_hi:[0,1,1] neg_lo:[1,0,0]
  v_pk_fma_f32 v[56:57], v[56:57], v[44:45], v[62:63] op_sel:[1,1,0] op_sel_hi:[0,1,1] neg_lo:[1,0,0]
  v_pk_fma_f32 v[58:59], v[58:59], v[46:47], v[64:65] op_sel:[1,1,0] op_sel_hi:[0,1,1] neg_lo:[1,0,0]
  v_cvt_pk_f16_f32 v76, v54, v55
  v_cvt_pk_f16_f32 v77, v56, v57
  v_cvt_pk_f16_f32 v78, v58, v59
  ds_write_addtid_b32 v76 offset:8624
  ds_write_addtid_b32 v77 offset:8880
  ds_write_addtid_b32 v78 offset:9136
  v_pk_mul_f32 v[60:61], v[80:81], v[36:37] op_sel_hi:[1,0]
  v_pk_mul_f32 v[62:63], v[82:83], v[38:39] op_sel_hi:[1,0]
  v_pk_mul_f32 v[64:65], v[84:85], v[40:41] op_sel_hi:[1,0]
  v_pk_fma_f32 v[80:81], v[80:81], v[36:37], v[60:61] op_sel:[1,1,0] op_sel_hi:[0,1,1] neg_lo:[1,0,0]
  v_pk_fma_f32 v[82:83], v[82:83], v[38:39], v[62:63] op_sel:[1,1,0] op_sel_hi:[0,1,1] neg_lo:[1,0,0]
  v_pk_fma_f32 v[84:85], v[84:85], v[40:41], v[64:65] op_sel:[1,1,0] op_sel_hi:[0,1,1] neg_lo:[1,0,0]
  v_cvt_pk_f16_f32 v68, v80, v81
  v_cvt_pk_f16_f32 v69, v82, v83
  v_cvt_pk_f16_f32 v70, v84, v85
  ds_write_addtid_b32 v68 offset:9408
  ds_write_addtid_b32 v69 offset:9664
  ds_write_addtid_b32 v70 offset:9920
  v_pk_mul_f32 v[60:61], v[80:81], v[48:49] op_sel_hi:[1,0]
  v_pk_mul_f32 v[62:63], v[82:83], v[50:51] op_sel_hi:[1,0]
  v_pk_mul_f32 v[64:65], v[84:85], v[52:53] op_sel_hi:[1,0]
  v_pk_fma_f32 v[54:55], v[80:81], v[48:49], v[60:61] op_sel:[1,1,0] op_sel_hi:[0,1,1] neg_lo:[1,0,0]
  v_pk_fma_f32 v[56:57], v[82:83], v[50:51], v[62:63] op_sel:[1,1,0] op_sel_hi:[0,1,1] neg_lo:[1,0,0]
  v_pk_fma_f32 v[58:59], v[84:85], v[52:53], v[64:65] op_sel:[1,1,0] op_sel_hi:[0,1,1] neg_lo:[1,0,0]
  v_cvt_pk_f16_f32 v72, v54, v55
  v_cvt_pk_f16_f32 v73, v56, v57
  v_cvt_pk_f16_f32 v74, v58, v59
  ds_write_addtid_b32 v72 offset:10192
  ds_write_addtid_b32 v73 offset:10448
  ds_write_addtid_b32 v74 offset:10704
  v_pk_mul_f32 v[60:61], v[80:81], v[36:37] op_sel_hi:[1,0]
  v_pk_mul_f32 v[62:63], v[82:83], v[38:39] op_sel_hi:[1,0]
  v_pk_mul_f32 v[64:65], v[84:85], v[40:41] op_sel_hi:[1,0]
  v_pk_fma_f32 v[80:81], v[80:81], v[36:37], v[60:61] op_sel:[1,1,0] op_sel_hi:[0,1,1] neg_lo:[1,0,0]
  v_pk_fma_f32 v[82:83], v[82:83], v[38:39], v[62:63] op_sel:[1,1,0] op_sel_hi:[0,1,1] neg_lo:[1,0,0]
  v_pk_fma_f32 v[84:85], v[84:85], v[40:41], v[64:65] op_sel:[1,1,0] op_sel_hi:[0,1,1] neg_lo:[1,0,0]
  v_cvt_pk_f16_f32 v76, v80, v81
  v_cvt_pk_f16_f32 v77, v82, v83
  v_cvt_pk_f16_f32 v78, v84, v85
  ds_write_addtid_b32 v76 offset:10976
  ds_write_addtid_b32 v77 offset:11232
  ds_write_addtid_b32 v78 offset:11488
  v_pk_mul_f32 v[60:61], v[80:81], v[48:49] op_sel_hi:[1,0]
  v_pk_mul_f32 v[62:63], v[82:83], v[50:51] op_sel_hi:[1,0]
  v_pk_mul_f32 v[64:65], v[84:85], v[52:53] op_sel_hi:[1,0]
  v_pk_fma_f32 v[54:55], v[80:81], v[48:49], v[60:61] op_sel:[1,1,0] op_sel_hi:[0,1,1] neg_lo:[1,0,0]
  v_pk_fma_f32 v[56:57], v[82:83], v[50:51], v[62:63] op_sel:[1,1,0] op_sel_hi:[0,1,1] neg_lo:[1,0,0]
  v_pk_fma_f32 v[58:59], v[84:85], v[52:53], v[64:65] op_sel:[1,1,0] op_sel_hi:[0,1,1] neg_lo:[1,0,0]
  v_cvt_pk_f16_f32 v68, v54, v55
  v_cvt_pk_f16_f32 v69, v56, v57
  v_cvt_pk_f16_f32 v70, v58, v59
  ds_write_addtid_b32 v68 offset:11760
  ds_write_addtid_b32 v69 offset:12016
  ds_write_addtid_b32 v70 offset:12272
  v_pk_mul_f32 v[60:61], v[80:81], v[36:37] op_sel_hi:[1,0]
  v_pk_mul_f32 v[62:63], v[82:83], v[38:39] op_sel_hi:[1,0]
  v_pk_mul_f32 v[64:65], v[84:85], v[40:41] op_sel_hi:[1,0]
  v_pk_fma_f32 v[80:81], v[80:81], v[36:37], v[60:61] op_sel:[1,1,0] op_sel_hi:[0,1,1] neg_lo:[1,0,0]
  v_pk_fma_f32 v[82:83], v[82:83], v[38:39], v[62:63] op_sel:[1,1,0] op_sel_hi:[0,1,1] neg_lo:[1,0,0]
  v_pk_fma_f32 v[84:85], v[84:85], v[40:41], v[64:65] op_sel:[1,1,0] op_sel_hi:[0,1,1] neg_lo:[1,0,0]
  v_cvt_pk_f16_f32 v72, v80, v81
  v_cvt_pk_f16_f32 v73, v82, v83
  v_cvt_pk_f16_f32 v74, v84, v85
  ds_write_addtid_b32 v72 offset:12544
  ds_write_addtid_b32 v73 offset:12800
  ds_write_addtid_b32 v74 offset:13056
  v_pk_mul_f32 v[60:61], v[80:81], v[36:37] op_sel_hi:[1,0]
  v_pk_mul_f32 v[62:63], v[82:83], v[38:39] op_sel_hi:[1,0]
  v_pk_mul_f32 v[64:65], v[84:85], v[40:41] op_sel_hi:[1,0]
  v_pk_fma_f32 v[80:81], v[80:81], v[36:37], v[60:61] op_sel:[1,1,0] op_sel_hi:[0,1,1] neg_lo:[1,0,0]
  v_pk_fma_f32 v[82:83], v[82:83], v[38:39], v[62:63] op_sel:[1,1,0] op_sel_hi:[0,1,1] neg_lo:[1,0,0]
  v_pk_fma_f32 v[84:85], v[84:85], v[40:41], v[64:65] op_sel:[1,1,0] op_sel_hi:[0,1,1] neg_lo:[1,0,0]
  v_cvt_pk_f16_f32 v76, v80, v81
  v_cvt_pk_f16_f32 v77, v82, v83
  v_cvt_pk_f16_f32 v78, v84, v85
  ds_write_addtid_b32 v76 offset:13328
  ds_write_addtid_b32 v77 offset:13584
  ds_write_addtid_b32 v78 offset:13840
  v_pk_mul_f32 v[60:61], v[80:81], v[36:37] op_sel_hi:[1,0]
  v_pk_mul_f32 v[62:63], v[82:83], v[38:39] op_sel_hi:[1,0]
  v_pk_mul_f32 v[64:65], v[84:85], v[40:41] op_sel_hi:[1,0]
  v_pk_fma_f32 v[80:81], v[80:81], v[36:37], v[60:61] op_sel:[1,1,0] op_sel_hi:[0,1,1] neg_lo:[1,0,0]
  v_pk_fma_f32 v[82:83], v[82:83], v[38:39], v[62:63] op_sel:[1,1,0] op_sel_hi:[0,1,1] neg_lo:[1,0,0]
  v_pk_fma_f32 v[84:85], v[84:85], v[40:41], v[64:65] op_sel:[1,1,0] op_sel_hi:[0,1,1] neg_lo:[1,0,0]
  v_cvt_pk_f16_f32 v68, v80, v81
  v_cvt_pk_f16_f32 v69, v82, v83
  v_cvt_pk_f16_f32 v70, v84, v85
  ds_write_addtid_b32 v68 offset:14112
  ds_write_addtid_b32 v69 offset:14368
  ds_write_addtid_b32 v70 offset:14624
  v_pk_mul_f32 v[60:61], v[80:81], v[36:37] op_sel_hi:[1,0]
  v_pk_mul_f32 v[62:63], v[82:83], v[38:39] op_sel_hi:[1,0]
  v_pk_mul_f32 v[64:65], v[84:85], v[40:41] op_sel_hi:[1,0]
  v_pk_fma_f32 v[80:81], v[80:81], v[36:37], v[60:61] op_sel:[1,1,0] op_sel_hi:[0,1,1] neg_lo:[1,0,0]
  v_pk_fma_f32 v[82:83], v[82:83], v[38:39], v[62:63] op_sel:[1,1,0] op_sel_hi:[0,1,1] neg_lo:[1,0,0]
  v_pk_fma_f32 v[84:85], v[84:85], v[40:41], v[64:65] op_sel:[1,1,0] op_sel_hi:[0,1,1] neg_lo:[1,0,0]
  v_cvt_pk_f16_f32 v72, v80, v81
  v_cvt_pk_f16_f32 v73, v82, v83
  v_cvt_pk_f16_f32 v74, v84, v85
  ds_write_addtid_b32 v72 offset:14896
  ds_write_addtid_b32 v73 offset:15152
  ds_write_addtid_b32 v74 offset:15408
  v_pk_mul_f32 v[60:61], v[80:81], v[36:37] op_sel_hi:[1,0]
  v_pk_mul_f32 v[62:63], v[82:83], v[38:39] op_sel_hi:[1,0]
  v_pk_mul_f32 v[64:65], v[84:85], v[40:41] op_sel_hi:[1,0]
  v_pk_fma_f32 v[80:81], v[80:81], v[36:37], v[60:61] op_sel:[1,1,0] op_sel_hi:[0,1,1] neg_lo:[1,0,0]
  v_pk_fma_f32 v[82:83], v[82:83], v[38:39], v[62:63] op_sel:[1,1,0] op_sel_hi:[0,1,1] neg_lo:[1,0,0]
  v_pk_fma_f32 v[84:85], v[84:85], v[40:41], v[64:65] op_sel:[1,1,0] op_sel_hi:[0,1,1] neg_lo:[1,0,0]
  v_cvt_pk_f16_f32 v76, v80, v81
  v_cvt_pk_f16_f32 v77, v82, v83
  v_cvt_pk_f16_f32 v78, v84, v85
  ds_write_addtid_b32 v76 offset:15680
  ds_write_addtid_b32 v77 offset:15936
  ds_write_addtid_b32 v78 offset:16192
  v_mov_b32 v86, 0x00003c00
  s_sub_u32 m0, s79, 36864
  s_nop 0
  ds_write_addtid_b32 v86 offset:36864
  ds_write_addtid_b32 v86 offset:37120
  ds_write_addtid_b32 v86 offset:37376
  v_cvt_pk_f16_f32 v68, v30, v31
  v_cvt_pk_f16_f32 v69, v32, v33
  v_cvt_pk_f16_f32 v70, v34, v35
  ds_write_addtid_b32 v68 offset:37648
  ds_write_addtid_b32 v69 offset:37904
  ds_write_addtid_b32 v70 offset:38160
  v_pk_mul_f32 v[60:61], v[30:31], v[30:31] op_sel_hi:[1,0]
  v_pk_mul_f32 v[62:63], v[32:33], v[32:33] op_sel_hi:[1,0]
  v_pk_mul_f32 v[64:65], v[34:35], v[34:35] op_sel_hi:[1,0]
  v_pk_fma_f32 v[54:55], v[30:31], v[30:31], v[60:61] op_sel:[1,1,0] op_sel_hi:[0,1,1] neg_lo:[1,0,0]
  v_pk_fma_f32 v[56:57], v[32:33], v[32:33], v[62:63] op_sel:[1,1,0] op_sel_hi:[0,1,1] neg_lo:[1,0,0]
  v_pk_fma_f32 v[58:59], v[34:35], v[34:35], v[64:65] op_sel:[1,1,0] op_sel_hi:[0,1,1] neg_lo:[1,0,0]
  v_cvt_pk_f16_f32 v72, v54, v55
  v_cvt_pk_f16_f32 v73, v56, v57
  v_cvt_pk_f16_f32 v74, v58, v59
  ds_write_addtid_b32 v72 offset:38432
  ds_write_addtid_b32 v73 offset:38688
  ds_write_addtid_b32 v74 offset:38944
  v_pk_mul_f32 v[60:61], v[54:55], v[30:31] op_sel_hi:[1,0]
  v_pk_mul_f32 v[62:63], v[56:57], v[32:33] op_sel_hi:[1,0]
  v_pk_mul_f32 v[64:65], v[58:59], v[34:35] op_sel_hi:[1,0]
  v_pk_fma_f32 v[54:55], v[54:55], v[30:31], v[60:61] op_sel:[1,1,0] op_sel_hi:[0,1,1] neg_lo:[1,0,0]
  v_pk_fma_f32 v[56:57], v[56:57], v[32:33], v[62:63] op_sel:[1,1,0] op_sel_hi:[0,1,1] neg_lo:[1,0,0]
  v_pk_fma_f32 v[58:59], v[58:59], v[34:35], v[64:65] op_sel:[1,1,0] op_sel_hi:[0,1,1] neg_lo:[1,0,0]
  v_cvt_pk_f16_f32 v76, v54, v55
  v_cvt_pk_f16_f32 v77, v56, v57
  v_cvt_pk_f16_f32 v78, v58, v59
  ds_write_addtid_b32 v76 offset:39216
  ds_write_addtid_b32 v77 offset:39472
  ds_write_addtid_b32 v78 offset:39728
  v_pk_mul_f32 v[60:61], v[54:55], v[30:31] op_sel_hi:[1,0]
  v_pk_mul_f32 v[62:63], v[56:57], v[32:33] op_sel_hi:[1,0]
  v_pk_mul_f32 v[64:65], v[58:59], v[34:35] op_sel_hi:[1,0]
  v_pk_fma_f32 v[54:55], v[54:55], v[30:31], v[60:61] op_sel:[1,1,0] op_sel_hi:[0,1,1] neg_lo:[1,0,0]
  v_pk_fma_f32 v[56:57], v[56:57], v[32:33], v[62:63] op_sel:[1,1,0] op_sel_hi:[0,1,1] neg_lo:[1,0,0]
  v_pk_fma_f32 v[58:59], v[58:59], v[34:35], v[64:65] op_sel:[1,1,0] op_sel_hi:[0,1,1] neg_lo:[1,0,0]
  v_cvt_pk_f16_f32 v68, v54, v55
  v_cvt_pk_f16_f32 v69, v56, v57
  v_cvt_pk_f16_f32 v70, v58, v59
  ds_write_addtid_b32 v68 offset:40000
  ds_write_addtid_b32 v69 offset:40256
  ds_write_addtid_b32 v70 offset:40512
  v_pk_mul_f32 v[60:61], v[54:55], v[30:31] op_sel_hi:[1,0]
  v_pk_mul_f32 v[62:63], v[56:57], v[32:33] op_sel_hi:[1,0]
  v_pk_mul_f32 v[64:65], v[58:59], v[34:35] op_sel_hi:[1,0]
  v_pk_fma_f32 v[54:55], v[54:55], v[30:31], v[60:61] op_sel:[1,1,0] op_sel_hi:[0,1,1] neg_lo:[1,0,0]
  v_pk_fma_f32 v[56:57], v[56:57], v[32:33], v[62:63] op_sel:[1,1,0] op_sel_hi:[0,1,1] neg_lo:[1,0,0]
  v_pk_fma_f32 v[58:59], v[58:59], v[34:35], v[64:65] op_sel:[1,1,0] op_sel_hi:[0,1,1] neg_lo:[1,0,0]
  v_cvt_pk_f16_f32 v72, v54, v55
  v_cvt_pk_f16_f32 v73, v56, v57
  v_cvt_pk_f16_f32 v74, v58, v59
  ds_write_addtid_b32 v72 offset:40784
  ds_write_addtid_b32 v73 offset:41040
  ds_write_addtid_b32 v74 offset:41296
  v_pk_mul_f32 v[60:61], v[54:55], v[30:31] op_sel_hi:[1,0]
  v_pk_mul_f32 v[62:63], v[56:57], v[32:33] op_sel_hi:[1,0]
  v_pk_mul_f32 v[64:65], v[58:59], v[34:35] op_sel_hi:[1,0]
  v_pk_fma_f32 v[54:55], v[54:55], v[30:31], v[60:61] op_sel:[1,1,0] op_sel_hi:[0,1,1] neg_lo:[1,0,0]
  v_pk_fma_f32 v[56:57], v[56:57], v[32:33], v[62:63] op_sel:[1,1,0] op_sel_hi:[0,1,1] neg_lo:[1,0,0]
  v_pk_fma_f32 v[58:59], v[58:59], v[34:35], v[64:65] op_sel:[1,1,0] op_sel_hi:[0,1,1] neg_lo:[1,0,0]
  v_cvt_pk_f16_f32 v76, v54, v55
  v_cvt_pk_f16_f32 v77, v56, v57
  v_cvt_pk_f16_f32 v78, v58, v59
  ds_write_addtid_b32 v76 offset:41568
  ds_write_addtid_b32 v77 offset:41824
  ds_write_addtid_b32 v78 offset:42080
  v_pk_mul_f32 v[60:61], v[54:55], v[30:31] op_sel_hi:[1,0]
  v_pk_mul_f32 v[62:63], v[56:57], v[32:33] op_sel_hi:[1,0]
  v_pk_mul_f32 v[64:65], v[58:59], v[34:35] op_sel_hi:[1,0]
  v_pk_fma_f32 v[54:55], v[54:55], v[30:31], v[60:61] op_sel:[1,1,0] op_sel_hi:[0,1,1] neg_lo:[1,0,0]
  v_pk_fma_f32 v[56:57], v[56:57], v[32:33], v[62:63] op_sel:[1,1,0] op_sel_hi:[0,1,1] neg_lo:[1,0,0]
  v_pk_fma_f32 v[58:59], v[58:59], v[34:35], v[64:65] op_sel:[1,1,0] op_sel_hi:[0,1,1] neg_lo:[1,0,0]
  v_cvt_pk_f16_f32 v68, v54, v55
  v_cvt_pk_f16_f32 v69, v56, v57
  v_cvt_pk_f16_f32 v70, v58, v59
  ds_write_addtid_b32 v68 offset:42352
  ds_write_addtid_b32 v69 offset:42608
  ds_write_addtid_b32 v70 offset:42864
  v_pk_mul_f32 v[60:61], v[54:55], v[30:31] op_sel_hi:[1,0]
  v_pk_mul_f32 v[62:63], v[56:57], v[32:33] op_sel_hi:[1,0]
  v_pk_mul_f32 v[64:65], v[58:59], v[34:35] op_sel_hi:[1,0]
  v_pk_fma_f32 v[54:55], v[54:55], v[30:31], v[60:61] op_sel:[1,1,0] op_sel_hi:[0,1,1] neg_lo:[1,0,0]
  v_pk_fma_f32 v[56:57], v[56:57], v[32:33], v[62:63] op_sel:[1,1,0] op_sel_hi:[0,1,1] neg_lo:[1,0,0]
  v_pk_fma_f32 v[58:59], v[58:59], v[34:35], v[64:65] op_sel:[1,1,0] op_sel_hi:[0,1,1] neg_lo:[1,0,0]
  v_cvt_pk_f16_f32 v72, v54, v55
  v_cvt_pk_f16_f32 v73, v56, v57
  v_cvt_pk_f16_f32 v74, v58, v59
  ds_write_addtid_b32 v72 offset:43136
  ds_write_addtid_b32 v73 offset:43392
  ds_write_addtid_b32 v74 offset:43648
  v_pk_mul_f32 v[60:61], v[54:55], v[30:31] op_sel_hi:[1,0]
  v_pk_mul_f32 v[62:63], v[56:57], v[32:33] op_sel_hi:[1,0]
  v_pk_mul_f32 v[64:65], v[58:59], v[34:35] op_sel_hi:[1,0]
  v_pk_fma_f32 v[54:55], v[54:55], v[30:31], v[60:61] op_sel:[1,1,0] op_sel_hi:[0,1,1] neg_lo:[1,0,0]
  v_pk_fma_f32 v[56:57], v[56:57], v[32:33], v[62:63] op_sel:[1,1,0] op_sel_hi:[0,1,1] neg_lo:[1,0,0]
  v_pk_fma_f32 v[58:59], v[58:59], v[34:35], v[64:65] op_sel:[1,1,0] op_sel_hi:[0,1,1] neg_lo:[1,0,0]
  v_cvt_pk_f16_f32 v76, v54, v55
  v_cvt_pk_f16_f32 v77, v56, v57
  v_cvt_pk_f16_f32 v78, v58, v59
  ds_write_addtid_b32 v76 offset:43920
  ds_write_addtid_b32 v77 offset:44176
  ds_write_addtid_b32 v78 offset:44432
  v_pk_mul_f32 v[60:61], v[54:55], v[30:31] op_sel_hi:[1,0]
  v_pk_mul_f32 v[62:63], v[56:57], v[32:33] op_sel_hi:[1,0]
  v_pk_mul_f32 v[64:65], v[58:59], v[34:35] op_sel_hi:[1,0]
  v_pk_fma_f32 v[54:55], v[54:55], v[30:31], v[60:61] op_sel:[1,1,0] op_sel_hi:[0,1,1] neg_lo:[1,0,0]
  v_pk_fma_f32 v[56:57], v[56:57], v[32:33], v[62:63] op_sel:[1,1,0] op_sel_hi:[0,1,1] neg_lo:[1,0,0]
  v_pk_fma_f32 v[58:59], v[58:59], v[34:35], v[64:65] op_sel:[1,1,0] op_sel_hi:[0,1,1] neg_lo:[1,0,0]
  v_cvt_pk_f16_f32 v68, v54, v55
  v_cvt_pk_f16_f32 v69, v56, v57
  v_cvt_pk_f16_f32 v70, v58, v59
  ds_write_addtid_b32 v68 offset:44704
  ds_write_addtid_b32 v69 offset:44960
  ds_write_addtid_b32 v70 offset:45216
  v_pk_mul_f32 v[60:61], v[54:55], v[30:31] op_sel_hi:[1,0]
  v_pk_mul_f32 v[62:63], v[56:57], v[32:33] op_sel_hi:[1,0]
  v_pk_mul_f32 v[64:65], v[58:59], v[34:35] op_sel_hi:[1,0]
  v_pk_fma_f32 v[54:55], v[54:55], v[30:31], v[60:61] op_sel:[1,1,0] op_sel_hi:[0,1,1] neg_lo:[1,0,0]
  v_pk_fma_f32 v[56:57], v[56:57], v[32:33], v[62:63] op_sel:[1,1,0] op_sel_hi:[0,1,1] neg_lo:[1,0,0]
  v_pk_fma_f32 v[58:59], v[58:59], v[34:35], v[64:65] op_sel:[1,1,0] op_sel_hi:[0,1,1] neg_lo:[1,0,0]
  v_cvt_pk_f16_f32 v72, v54, v55
  v_cvt_pk_f16_f32 v73, v56, v57
  v_cvt_pk_f16_f32 v74, v58, v59
  ds_write_addtid_b32 v72 offset:45488
  ds_write_addtid_b32 v73 offset:45744
  ds_write_addtid_b32 v74 offset:46000
  v_pk_mul_f32 v[60:61], v[54:55], v[30:31] op_sel_hi:[1,0]
  v_pk_mul_f32 v[62:63], v[56:57], v[32:33] op_sel_hi:[1,0]
  v_pk_mul_f32 v[64:65], v[58:59], v[34:35] op_sel_hi:[1,0]
  v_pk_fma_f32 v[54:55], v[54:55], v[30:31], v[60:61] op_sel:[1,1,0] op_sel_hi:[0,1,1] neg_lo:[1,0,0]
  v_pk_fma_f32 v[56:57], v[56:57], v[32:33], v[62:63] op_sel:[1,1,0] op_sel_hi:[0,1,1] neg_lo:[1,0,0]
  v_pk_fma_f32 v[58:59], v[58:59], v[34:35], v[64:65] op_sel:[1,1,0] op_sel_hi:[0,1,1] neg_lo:[1,0,0]
  v_cvt_pk_f16_f32 v76, v54, v55
  v_cvt_pk_f16_f32 v77, v56, v57
  v_cvt_pk_f16_f32 v78, v58, v59
  ds_write_addtid_b32 v76 offset:46272
  ds_write_addtid_b32 v77 offset:46528
  ds_write_addtid_b32 v78 offset:46784
  v_pk_mul_f32 v[60:61], v[54:55], v[30:31] op_sel_hi:[1,0]
  v_pk_mul_f32 v[62:63], v[56:57], v[32:33] op_sel_hi:[1,0]
  v_pk_mul_f32 v[64:65], v[58:59], v[34:35] op_sel_hi:[1,0]
  v_pk_fma_f32 v[54:55], v[54:55], v[30:31], v[60:61] op_sel:[1,1,0] op_sel_hi:[0,1,1] neg_lo:[1,0,0]
  v_pk_fma_f32 v[56:57], v[56:57], v[32:33], v[62:63] op_sel:[1,1,0] op_sel_hi:[0,1,1] neg_lo:[1,0,0]
  v_pk_fma_f32 v[58:59], v[58:59], v[34:35], v[64:65] op_sel:[1,1,0] op_sel_hi:[0,1,1] neg_lo:[1,0,0]
  v_cvt_pk_f16_f32 v68, v54, v55
  v_cvt_pk_f16_f32 v69, v56, v57
  v_cvt_pk_f16_f32 v70, v58, v59
  ds_write_addtid_b32 v68 offset:47056
  ds_write_addtid_b32 v69 offset:47312
  ds_write_addtid_b32 v70 offset:47568
  v_pk_mul_f32 v[60:61], v[54:55], v[30:31] op_sel_hi:[1,0]
  v_pk_mul_f32 v[62:63], v[56:57], v[32:33] op_sel_hi:[1,0]
  v_pk_mul_f32 v[64:65], v[58:59], v[34:35] op_sel_hi:[1,0]
  v_pk_fma_f32 v[54:55], v[54:55], v[30:31], v[60:61] op_sel:[1,1,0] op_sel_hi:[0,1,1] neg_lo:[1,0,0]
  v_pk_fma_f32 v[56:57], v[56:57], v[32:33], v[62:63] op_sel:[1,1,0] op_sel_hi:[0,1,1] neg_lo:[1,0,0]
  v_pk_fma_f32 v[58:59], v[58:59], v[34:35], v[64:65] op_sel:[1,1,0] op_sel_hi:[0,1,1] neg_lo:[1,0,0]
  v_cvt_pk_f16_f32 v72, v54, v55
  v_cvt_pk_f16_f32 v73, v56, v57
  v_cvt_pk_f16_f32 v74, v58, v59
  ds_write_addtid_b32 v72 offset:47840
  ds_write_addtid_b32 v73 offset:48096
  ds_write_addtid_b32 v74 offset:48352
  v_pk_mul_f32 v[60:61], v[54:55], v[30:31] op_sel_hi:[1,0]
  v_pk_mul_f32 v[62:63], v[56:57], v[32:33] op_sel_hi:[1,0]
  v_pk_mul_f32 v[64:65], v[58:59], v[34:35] op_sel_hi:[1,0]
  v_pk_fma_f32 v[54:55], v[54:55], v[30:31], v[60:61] op_sel:[1,1,0] op_sel_hi:[0,1,1] neg_lo:[1,0,0]
  v_pk_fma_f32 v[56:57], v[56:57], v[32:33], v[62:63] op_sel:[1,1,0] op_sel_hi:[0,1,1] neg_lo:[1,0,0]
  v_pk_fma_f32 v[58:59], v[58:59], v[34:35], v[64:65] op_sel:[1,1,0] op_sel_hi:[0,1,1] neg_lo:[1,0,0]
  v_cvt_pk_f16_f32 v76, v54, v55
  v_cvt_pk_f16_f32 v77, v56, v57
  v_cvt_pk_f16_f32 v78, v58, v59
  ds_write_addtid_b32 v76 offset:48624
  ds_write_addtid_b32 v77 offset:48880
  ds_write_addtid_b32 v78 offset:49136
  v_pk_mul_f32 v[60:61], v[54:55], v[30:31] op_sel_hi:[1,0]
  v_pk_mul_f32 v[62:63], v[56:57], v[32:33] op_sel_hi:[1,0]
  v_pk_mul_f32 v[64:65], v[58:59], v[34:35] op_sel_hi:[1,0]
  v_pk_fma_f32 v[54:55], v[54:55], v[30:31], v[60:61] op_sel:[1,1,0] op_sel_hi:[0,1,1] neg_lo:[1,0,0]
  v_pk_fma_f32 v[56:57], v[56:57], v[32:33], v[62:63] op_sel:[1,1,0] op_sel_hi:[0,1,1] neg_lo:[1,0,0]
  v_pk_fma_f32 v[58:59], v[58:59], v[34:35], v[64:65] op_sel:[1,1,0] op_sel_hi:[0,1,1] neg_lo:[1,0,0]
  v_cvt_pk_f16_f32 v68, v54, v55
  v_cvt_pk_f16_f32 v69, v56, v57
  v_cvt_pk_f16_f32 v70, v58, v59
  ds_write_addtid_b32 v68 offset:49408
  ds_write_addtid_b32 v69 offset:49664
  ds_write_addtid_b32 v70 offset:49920
  v_pk_mul_f32 v[60:61], v[54:55], v[30:31] op_sel_hi:[1,0]
  v_pk_mul_f32 v[62:63], v[56:57], v[32:33] op_sel_hi:[1,0]
  v_pk_mul_f32 v[64:65], v[58:59], v[34:35] op_sel_hi:[1,0]
  v_pk_fma_f32 v[54:55], v[54:55], v[30:31], v[60:61] op_sel:[1,1,0] op_sel_hi:[0,1,1] neg_lo:[1,0,0]
  v_pk_fma_f32 v[56:57], v[56:57], v[32:33], v[62:63] op_sel:[1,1,0] op_sel_hi:[0,1,1] neg_lo:[1,0,0]
  v_pk_fma_f32 v[58:59], v[58:59], v[34:35], v[64:65] op_sel:[1,1,0] op_sel_hi:[0,1,1] neg_lo:[1,0,0]
  v_cvt_pk_f16_f32 v72, v54, v55
  v_cvt_pk_f16_f32 v73, v56, v57
  v_cvt_pk_f16_f32 v74, v58, v59
  ds_write_addtid_b32 v72 offset:50192
  ds_write_addtid_b32 v73 offset:50448
  ds_write_addtid_b32 v74 offset:50704
  v_pk_mul_f32 v[60:61], v[54:55], v[30:31] op_sel_hi:[1,0]
  v_pk_mul_f32 v[62:63], v[56:57], v[32:33] op_sel_hi:[1,0]
  v_pk_mul_f32 v[64:65], v[58:59], v[34:35] op_sel_hi:[1,0]
  v_pk_fma_f32 v[54:55], v[54:55], v[30:31], v[60:61] op_sel:[1,1,0] op_sel_hi:[0,1,1] neg_lo:[1,0,0]
  v_pk_fma_f32 v[56:57], v[56:57], v[32:33], v[62:63] op_sel:[1,1,0] op_sel_hi:[0,1,1] neg_lo:[1,0,0]
  v_pk_fma_f32 v[58:59], v[58:59], v[34:35], v[64:65] op_sel:[1,1,0] op_sel_hi:[0,1,1] neg_lo:[1,0,0]
  v_cvt_pk_f16_f32 v76, v54, v55
  v_cvt_pk_f16_f32 v77, v56, v57
  v_cvt_pk_f16_f32 v78, v58, v59
  ds_write_addtid_b32 v76 offset:50976
  ds_write_addtid_b32 v77 offset:51232
  ds_write_addtid_b32 v78 offset:51488
  v_pk_mul_f32 v[60:61], v[54:55], v[30:31] op_sel_hi:[1,0]
  v_pk_mul_f32 v[62:63], v[56:57], v[32:33] op_sel_hi:[1,0]
  v_pk_mul_f32 v[64:65], v[58:59], v[34:35] op_sel_hi:[1,0]
  v_pk_fma_f32 v[54:55], v[54:55], v[30:31], v[60:61] op_sel:[1,1,0] op_sel_hi:[0,1,1] neg_lo:[1,0,0]
  v_pk_fma_f32 v[56:57], v[56:57], v[32:33], v[62:63] op_sel:[1,1,0] op_sel_hi:[0,1,1] neg_lo:[1,0,0]
  v_pk_fma_f32 v[58:59], v[58:59], v[34:35], v[64:65] op_sel:[1,1,0] op_sel_hi:[0,1,1] neg_lo:[1,0,0]
  v_cvt_pk_f16_f32 v68, v54, v55
  v_cvt_pk_f16_f32 v69, v56, v57
  v_cvt_pk_f16_f32 v70, v58, v59
  ds_write_addtid_b32 v68 offset:51760
  ds_write_addtid_b32 v69 offset:52016
  ds_write_addtid_b32 v70 offset:52272
  v_pk_mul_f32 v[60:61], v[54:55], v[30:31] op_sel_hi:[1,0]
  v_pk_mul_f32 v[62:63], v[56:57], v[32:33] op_sel_hi:[1,0]
  v_pk_mul_f32 v[64:65], v[58:59], v[34:35] op_sel_hi:[1,0]
  v_pk_fma_f32 v[54:55], v[54:55], v[30:31], v[60:61] op_sel:[1,1,0] op_sel_hi:[0,1,1] neg_lo:[1,0,0]
  v_pk_fma_f32 v[56:57], v[56:57], v[32:33], v[62:63] op_sel:[1,1,0] op_sel_hi:[0,1,1] neg_lo:[1,0,0]
  v_pk_fma_f32 v[58:59], v[58:59], v[34:35], v[64:65] op_sel:[1,1,0] op_sel_hi:[0,1,1] neg_lo:[1,0,0]
  v_cvt_pk_f16_f32 v72, v54, v55
  v_cvt_pk_f16_f32 v73, v56, v57
  v_cvt_pk_f16_f32 v74, v58, v59
  ds_write_addtid_b32 v72 offset:52544
  ds_write_addtid_b32 v73 offset:52800
  ds_write_addtid_b32 v74 offset:53056
  v_pk_mul_f32 v[60:61], v[54:55], v[30:31] op_sel_hi:[1,0]
  v_pk_mul_f32 v[62:63], v[56:57], v[32:33] op_sel_hi:[1,0]
  v_pk_mul_f32 v[64:65], v[58:59], v[34:35] op_sel_hi:[1,0]
  v_pk_fma_f32 v[54:55], v[54:55], v[30:31], v[60:61] op_sel:[1,1,0] op_sel_hi:[0,1,1] neg_lo:[1,0,0]
  v_pk_fma_f32 v[56:57], v[56:57], v[32:33], v[62:63] op_sel:[1,1,0] op_sel_hi:[0,1,1] neg_lo:[1,0,0]
  v_pk_fma_f32 v[58:59], v[58:59], v[34:35], v[64:65] op_sel:[1,1,0] op_sel_hi:[0,1,1] neg_lo:[1,0,0]
  v_cvt_pk_f16_f32 v76, v54, v55
  v_cvt_pk_f16_f32 v77, v56, v57
  v_cvt_pk_f16_f32 v78, v58, v59
  ds_write_addtid_b32 v76 offset:53328
  ds_write_addtid_b32 v77 offset:53584
  ds_write_addtid_b32 v78 offset:53840
  v_pk_mul_f32 v[60:61], v[54:55], v[30:31] op_sel_hi:[1,0]
  v_pk_mul_f32 v[62:63], v[56:57], v[32:33] op_sel_hi:[1,0]
  v_pk_mul_f32 v[64:65], v[58:59], v[34:35] op_sel_hi:[1,0]
  v_pk_fma_f32 v[54:55], v[54:55], v[30:31], v[60:61] op_sel:[1,1,0] op_sel_hi:[0,1,1] neg_lo:[1,0,0]
  v_pk_fma_f32 v[56:57], v[56:57], v[32:33], v[62:63] op_sel:[1,1,0] op_sel_hi:[0,1,1] neg_lo:[1,0,0]
  v_pk_fma_f32 v[58:59], v[58:59], v[34:35], v[64:65] op_sel:[1,1,0] op_sel_hi:[0,1,1] neg_lo:[1,0,0]
  v_cvt_pk_f16_f32 v68, v54, v55
  v_cvt_pk_f16_f32 v69, v56, v57
  v_cvt_pk_f16_f32 v70, v58, v59
  ds_write_addtid_b32 v68 offset:54112
  ds_write_addtid_b32 v69 offset:54368
  ds_write_addtid_b32 v70 offset:54624
  v_pk_mul_f32 v[60:61], v[54:55], v[30:31] op_sel_hi:[1,0]
  v_pk_mul_f32 v[62:63], v[56:57], v[32:33] op_sel_hi:[1,0]
  v_pk_mul_f32 v[64:65], v[58:59], v[34:35] op_sel_hi:[1,0]
  v_pk_fma_f32 v[54:55], v[54:55], v[30:31], v[60:61] op_sel:[1,1,0] op_sel_hi:[0,1,1] neg_lo:[1,0,0]
  v_pk_fma_f32 v[56:57], v[56:57], v[32:33], v[62:63] op_sel:[1,1,0] op_sel_hi:[0,1,1] neg_lo:[1,0,0]
  v_pk_fma_f32 v[58:59], v[58:59], v[34:35], v[64:65] op_sel:[1,1,0] op_sel_hi:[0,1,1] neg_lo:[1,0,0]
  v_cvt_pk_f16_f32 v72, v54, v55
  v_cvt_pk_f16_f32 v73, v56, v57
  v_cvt_pk_f16_f32 v74, v58, v59
  ds_write_addtid_b32 v72 offset:54896
  ds_write_addtid_b32 v73 offset:55152
  ds_write_addtid_b32 v74 offset:55408
  v_pk_mul_f32 v[60:61], v[54:55], v[30:31] op_sel_hi:[1,0]
  v_pk_mul_f32 v[62:63], v[56:57], v[32:33] op_sel_hi:[1,0]
  v_pk_mul_f32 v[64:65], v[58:59], v[34:35] op_sel_hi:[1,0]
  v_pk_fma_f32 v[54:55], v[54:55], v[30:31], v[60:61] op_sel:[1,1,0] op_sel_hi:[0,1,1] neg_lo:[1,0,0]
  v_pk_fma_f32 v[56:57], v[56:57], v[32:33], v[62:63] op_sel:[1,1,0] op_sel_hi:[0,1,1] neg_lo:[1,0,0]
  v_pk_fma_f32 v[58:59], v[58:59], v[34:35], v[64:65] op_sel:[1,1,0] op_sel_hi:[0,1,1] neg_lo:[1,0,0]
  v_cvt_pk_f16_f32 v76, v54, v55
  v_cvt_pk_f16_f32 v77, v56, v57
  v_cvt_pk_f16_f32 v78, v58, v59
  ds_write_addtid_b32 v76 offset:55680
  ds_write_addtid_b32 v77 offset:55936
  ds_write_addtid_b32 v78 offset:56192
  v_pk_mul_f32 v[60:61], v[54:55], v[30:31] op_sel_hi:[1,0]
  v_pk_mul_f32 v[62:63], v[56:57], v[32:33] op_sel_hi:[1,0]
  v_pk_mul_f32 v[64:65], v[58:59], v[34:35] op_sel_hi:[1,0]
  v_pk_fma_f32 v[54:55], v[54:55], v[30:31], v[60:61] op_sel:[1,1,0] op_sel_hi:[0,1,1] neg_lo:[1,0,0]
  v_pk_fma_f32 v[56:57], v[56:57], v[32:33], v[62:63] op_sel:[1,1,0] op_sel_hi:[0,1,1] neg_lo:[1,0,0]
  v_pk_fma_f32 v[58:59], v[58:59], v[34:35], v[64:65] op_sel:[1,1,0] op_sel_hi:[0,1,1] neg_lo:[1,0,0]
  v_cvt_pk_f16_f32 v68, v54, v55
  v_cvt_pk_f16_f32 v69, v56, v57
  v_cvt_pk_f16_f32 v70, v58, v59
  ds_write_addtid_b32 v68 offset:56464
  ds_write_addtid_b32 v69 offset:56720
  ds_write_addtid_b32 v70 offset:56976
  v_pk_mul_f32 v[60:61], v[54:55], v[30:31] op_sel_hi:[1,0]
  v_pk_mul_f32 v[62:63], v[56:57], v[32:33] op_sel_hi:[1,0]
  v_pk_mul_f32 v[64:65], v[58:59], v[34:35] op_sel_hi:[1,0]
  v_pk_fma_f32 v[54:55], v[54:55], v[30:31], v[60:61] op_sel:[1,1,0] op_sel_hi:[0,1,1] neg_lo:[1,0,0]
  v_pk_fma_f32 v[56:57], v[56:57], v[32:33], v[62:63] op_sel:[1,1,0] op_sel_hi:[0,1,1] neg_lo:[1,0,0]
  v_pk_fma_f32 v[58:59], v[58:59], v[34:35], v[64:65] op_sel:[1,1,0] op_sel_hi:[0,1,1] neg_lo:[1,0,0]
  v_cvt_pk_f16_f32 v72, v54, v55
  v_cvt_pk_f16_f32 v73, v56, v57
  v_cvt_pk_f16_f32 v74, v58, v59
  ds_write_addtid_b32 v72 offset:57248
  ds_write_addtid_b32 v73 offset:57504
  ds_write_addtid_b32 v74 offset:57760
  v_pk_mul_f32 v[60:61], v[54:55], v[30:31] op_sel_hi:[1,0]
  v_pk_mul_f32 v[62:63], v[56:57], v[32:33] op_sel_hi:[1,0]
  v_pk_mul_f32 v[64:65], v[58:59], v[34:35] op_sel_hi:[1,0]
  v_pk_fma_f32 v[54:55], v[54:55], v[30:31], v[60:61] op_sel:[1,1,0] op_sel_hi:[0,1,1] neg_lo:[1,0,0]
  v_pk_fma_f32 v[56:57], v[56:57], v[32:33], v[62:63] op_sel:[1,1,0] op_sel_hi:[0,1,1] neg_lo:[1,0,0]
  v_pk_fma_f32 v[58:59], v[58:59], v[34:35], v[64:65] op_sel:[1,1,0] op_sel_hi:[0,1,1] neg_lo:[1,0,0]
  v_cvt_pk_f16_f32 v76, v54, v55
  v_cvt_pk_f16_f32 v77, v56, v57
  v_cvt_pk_f16_f32 v78, v58, v59
  ds_write_addtid_b32 v76 offset:58032
  ds_write_addtid_b32 v77 offset:58288
  ds_write_addtid_b32 v78 offset:58544
  v_pk_mul_f32 v[60:61], v[54:55], v[30:31] op_sel_hi:[1,0]
  v_pk_mul_f32 v[62:63], v[56:57], v[32:33] op_sel_hi:[1,0]
  v_pk_mul_f32 v[64:65], v[58:59], v[34:35] op_sel_hi:[1,0]
  v_pk_fma_f32 v[54:55], v[54:55], v[30:31], v[60:61] op_sel:[1,1,0] op_sel_hi:[0,1,1] neg_lo:[1,0,0]
  v_pk_fma_f32 v[56:57], v[56:57], v[32:33], v[62:63] op_sel:[1,1,0] op_sel_hi:[0,1,1] neg_lo:[1,0,0]
  v_pk_fma_f32 v[58:59], v[58:59], v[34:35], v[64:65] op_sel:[1,1,0] op_sel_hi:[0,1,1] neg_lo:[1,0,0]
  v_cvt_pk_f16_f32 v68, v54, v55
  v_cvt_pk_f16_f32 v69, v56, v57
  v_cvt_pk_f16_f32 v70, v58, v59
  ds_write_addtid_b32 v68 offset:58816
  ds_write_addtid_b32 v69 offset:59072
  ds_write_addtid_b32 v70 offset:59328
  v_pk_mul_f32 v[60:61], v[54:55], v[30:31] op_sel_hi:[1,0]
  v_pk_mul_f32 v[62:63], v[56:57], v[32:33] op_sel_hi:[1,0]
  v_pk_mul_f32 v[64:65], v[58:59], v[34:35] op_sel_hi:[1,0]
  v_pk_fma_f32 v[54:55], v[54:55], v[30:31], v[60:61] op_sel:[1,1,0] op_sel_hi:[0,1,1] neg_lo:[1,0,0]
  v_pk_fma_f32 v[56:57], v[56:57], v[32:33], v[62:63] op_sel:[1,1,0] op_sel_hi:[0,1,1] neg_lo:[1,0,0]
  v_pk_fma_f32 v[58:59], v[58:59], v[34:35], v[64:65] op_sel:[1,1,0] op_sel_hi:[0,1,1] neg_lo:[1,0,0]
  v_cvt_pk_f16_f32 v72, v54, v55
  v_cvt_pk_f16_f32 v73, v56, v57
  v_cvt_pk_f16_f32 v74, v58, v59
  ds_write_addtid_b32 v72 offset:59600
  ds_write_addtid_b32 v73 offset:59856
  ds_write_addtid_b32 v74 offset:60112
  v_pk_mul_f32 v[60:61], v[54:55], v[30:31] op_sel_hi:[1,0]
  v_pk_mul_f32 v[62:63], v[56:57], v[32:33] op_sel_hi:[1,0]
  v_pk_mul_f32 v[64:65], v[58:59], v[34:35] op_sel_hi:[1,0]
  v_pk_fma_f32 v[54:55], v[54:55], v[30:31], v[60:61] op_sel:[1,1,0] op_sel_hi:[0,1,1] neg_lo:[1,0,0]
  v_pk_fma_f32 v[56:57], v[56:57], v[32:33], v[62:63] op_sel:[1,1,0] op_sel_hi:[0,1,1] neg_lo:[1,0,0]
  v_pk_fma_f32 v[58:59], v[58:59], v[34:35], v[64:65] op_sel:[1,1,0] op_sel_hi:[0,1,1] neg_lo:[1,0,0]
  v_cvt_pk_f16_f32 v76, v54, v55
  v_cvt_pk_f16_f32 v77, v56, v57
  v_cvt_pk_f16_f32 v78, v58, v59
  ds_write_addtid_b32 v76 offset:60384
  ds_write_addtid_b32 v77 offset:60640
  ds_write_addtid_b32 v78 offset:60896
  v_pk_mul_f32 v[60:61], v[54:55], v[30:31] op_sel_hi:[1,0]
  v_pk_mul_f32 v[62:63], v[56:57], v[32:33] op_sel_hi:[1,0]
  v_pk_mul_f32 v[64:65], v[58:59], v[34:35] op_sel_hi:[1,0]
  v_pk_fma_f32 v[54:55], v[54:55], v[30:31], v[60:61] op_sel:[1,1,0] op_sel_hi:[0,1,1] neg_lo:[1,0,0]
  v_pk_fma_f32 v[56:57], v[56:57], v[32:33], v[62:63] op_sel:[1,1,0] op_sel_hi:[0,1,1] neg_lo:[1,0,0]
  v_pk_fma_f32 v[58:59], v[58:59], v[34:35], v[64:65] op_sel:[1,1,0] op_sel_hi:[0,1,1] neg_lo:[1,0,0]
  v_cvt_pk_f16_f32 v68, v54, v55
  v_cvt_pk_f16_f32 v69, v56, v57
  v_cvt_pk_f16_f32 v70, v58, v59
  ds_write_addtid_b32 v68 offset:61168
  ds_write_addtid_b32 v69 offset:61424
  ds_write_addtid_b32 v70 offset:61680
  v_and_b32 v4, 31, v0
  v_mul_u32_u24 v4, 784, v4
  v_lshrrev_b32 v5, 5, v0
  v_lshlrev_b32 v5, 4, v5
  v_add_u32 v4, v4, v5
  v_add_u32 v16, s79, v4
  v_add_u32 v4, s46, v4
  ds_read_b128 v[32:35], v4 offset:0
  ds_read_b128 v[36:39], v16 offset:0
  ds_read_b128 v[40:43], v4 offset:32
  ds_read_b128 v[44:47], v16 offset:32
  ds_read_b128 v[48:51], v4 offset:64
  ds_read_b128 v[52:55], v16 offset:64
  ds_read_b128 v[56:59], v4 offset:96
  ds_read_b128 v[60:63], v16 offset:96
  ds_read_b128 v[64:67], v4 offset:128
  ds_read_b128 v[68:71], v16 offset:128
  ds_read_b128 v[72:75], v4 offset:160
  ds_read_b128 v[76:79], v16 offset:160
  v_and_b32 v5, 31, v0
  v_lshrrev_b32 v6, 5, v0
  s_add_u32 s41, s79, 16656
  v_lshlrev_b32 v7, 5, v5
  v_lshlrev_b32 v8, 4, v6
  v_add_u32 v7, v7, v8
  v_add_u32 v7, s41, v7
  v_cmp_eq_u32 vcc, 0, v6
  v_lshlrev_b32 v8, 4, v5
  v_add_u32 v8, 1024, v8
  v_lshlrev_b32 v9, 3, v5
  v_add_u32 v9, 1536, v9
  v_cndmask_b32 v8, v9, v8, vcc
  v_add_u32 v8, s41, v8
  v_mov_b32 v9, 256
  v_cndmask_b32 v9, v9, 8, vcc
  v_add_u32 v9, v8, v9
  v_lshlrev_b32 v10, 9, v6
  v_lshlrev_b32 v11, 2, v5
  v_add_u32 v10, v10, v11
  v_add_u32 v10, 2048, v10
  v_add_u32 v10, s41, v10
  v_lshlrev_b32 v11, 4, v0
  v_add_u32 v11, s41, v11
  v_lshlrev_b32 v12, 3, v0
  v_add_u32 v12, s41, v12
  v_cmp_eq_u32 vcc, 0, v0
  v_mov_b32 v13, 1016
  v_mov_b32 v14, 1012
  v_cndmask_b32 v13, v13, v14, vcc
  v_add_u32 v13, v13, v12
  v_lshlrev_b32 v14, 3, v0
  v_add_u32 v14, s79, v14
  v_lshlrev_b32 v15, 4, v0
  v_add_u32 v15, s79, v15
  v_lshlrev_b32 v28, 5, v0
  v_add_u32 v28, s79, v28
  v_lshrrev_b32 v29, 1, v0
  v_and_b32 v29, 3, v29
  v_mul_u32_u24 v29, 4160, v29
  v_and_b32 v30, 1, v0
  v_lshlrev_b32 v30, 4, v30
  v_add_u32 v29, v29, v30
  v_add_u32 v29, s79, v29
  v_mov_b32 v24, 0
  v_mov_b32 v25, 0
  v_mov_b32 v26, 0
  v_mov_b32 v27, 0
  v_mov_b32 v30, s41
  s_waitcnt lgkmcnt(10)
  v_mfma_f32_32x32x16_f16 v[94:109], v[32:35], v[36:39], 0
  ds_read_b128 v[32:35], v4 offset:192
  ds_read_b128 v[36:39], v16 offset:192
  s_waitcnt lgkmcnt(10)
  v_mfma_f32_32x32x16_f16 v[94:109], v[40:43], v[44:47], v[94:109]
  ds_read_b128 v[40:43], v4 offset:224
  ds_read_b128 v[44:47], v16 offset:224
  s_waitcnt lgkmcnt(10)
  v_mfma_f32_32x32x16_f16 v[94:109], v[48:51], v[52:55], v[94:109]
  ds_read_b128 v[48:51], v4 offset:256
  ds_read_b128 v[52:55], v16 offset:256
  s_waitcnt lgkmcnt(10)
  v_mfma_f32_32x32x16_f16 v[94:109], v[56:59], v[60:63], v[94:109]
  ds_read_b128 v[56:59], v4 offset:288
  ds_read_b128 v[60:63], v16 offset:288
  s_waitcnt lgkmcnt(10)
  v_mfma_f32_32x32x16_f16 v[94:109], v[64:67], v[68:71], v[94:109]
  ds_read_b128 v[64:67], v4 offset:320
  ds_read_b128 v[68:71], v16 offset:320
  s_waitcnt lgkmcnt(10)
  v_mfma_f32_32x32x16_f16 v[94:109], v[72:75], v[76:79], v[94:109]
  ds_read_b128 v[72:75], v4 offset:352
  ds_read_b128 v[76:79], v16 offset:352
  s_waitcnt lgkmcnt(10)
  v_mfma_f32_32x32x16_f16 v[94:109], v[32:35], v[36:39], v[94:109]
  ds_read_b128 v[32:35], v4 offset:384
  ds_read_b128 v[36:39], v16 offset:384
  s_waitcnt lgkmcnt(10)
  v_mfma_f32_32x32x16_f16 v[94:109], v[40:43], v[44:47], v[94:109]
  ds_read_b128 v[40:43], v4 offset:416
  ds_read_b128 v[44:47], v16 offset:416
  s_waitcnt lgkmcnt(10)
  v_mfma_f32_32x32x16_f16 v[94:109], v[48:51], v[52:55], v[94:109]
  ds_read_b128 v[48:51], v4 offset:448
  ds_read_b128 v[52:55], v16 offset:448
  s_waitcnt lgkmcnt(10)
  v_mfma_f32_32x32x16_f16 v[94:109], v[56:59], v[60:63], v[94:109]
  ds_read_b128 v[56:59], v4 offset:480
  ds_read_b128 v[60:63], v16 offset:480
  s_waitcnt lgkmcnt(10)
  v_mfma_f32_32x32x16_f16 v[94:109], v[64:67], v[68:71], v[94:109]
  ds_read_b128 v[64:67], v4 offset:512
  ds_read_b128 v[68:71], v16 offset:512
  s_waitcnt lgkmcnt(10)
  v_mfma_f32_32x32x16_f16 v[94:109], v[72:75], v[76:79], v[94:109]
  ds_read_b128 v[72:75], v4 offset:544
  ds_read_b128 v[76:79], v16 offset:544
  s_waitcnt lgkmcnt(10)
  v_mfma_f32_32x32x16_f16 v[94:109], v[32:35], v[36:39], v[94:109]
  ds_read_b128 v[32:35], v4 offset:576
  ds_read_b128 v[36:39], v16 offset:576
  s_waitcnt lgkmcnt(10)
  v_mfma_f32_32x32x16_f16 v[94:109], v[40:43], v[44:47], v[94:109]
  ds_read_b128 v[40:43], v4 offset:608
  ds_read_b128 v[44:47], v16 offset:608
  s_waitcnt lgkmcnt(10)
  v_mfma_f32_32x32x16_f16 v[94:109], v[48:51], v[52:55], v[94:109]
  ds_read_b128 v[48:51], v4 offset:640
  ds_read_b128 v[52:55], v16 offset:640
  s_waitcnt lgkmcnt(10)
  v_mfma_f32_32x32x16_f16 v[94:109], v[56:59], v[60:63], v[94:109]
  ds_read_b128 v[56:59], v4 offset:672
  ds_read_b128 v[60:63], v16 offset:672
  s_waitcnt lgkmcnt(10)
  v_mfma_f32_32x32x16_f16 v[94:109], v[64:67], v[68:71], v[94:109]
  ds_read_b128 v[64:67], v4 offset:704
  ds_read_b128 v[68:71], v16 offset:704
  s_waitcnt lgkmcnt(10)
  v_mfma_f32_32x32x16_f16 v[94:109], v[72:75], v[76:79], v[94:109]
  ds_read_b128 v[72:75], v4 offset:736
  ds_read_b128 v[76:79], v16 offset:736
  s_waitcnt lgkmcnt(10)
  v_mfma_f32_32x32x16_f16 v[94:109], v[32:35], v[36:39], v[94:109]
  s_waitcnt lgkmcnt(8)
  v_mfma_f32_32x32x16_f16 v[94:109], v[40:43], v[44:47], v[94:109]
  s_waitcnt lgkmcnt(6)
  v_mfma_f32_32x32x16_f16 v[94:109], v[48:51], v[52:55], v[94:109]
  s_waitcnt lgkmcnt(4)
  v_mfma_f32_32x32x16_f16 v[94:109], v[56:59], v[60:63], v[94:109]
  s_waitcnt lgkmcnt(2)
  v_mfma_f32_32x32x16_f16 v[94:109], v[64:67], v[68:71], v[94:109]
  s_waitcnt lgkmcnt(0)
  v_mfma_f32_32x32x16_f16 v[94:109], v[72:75], v[76:79], v[94:109]
  s_waitcnt vmcnt(0)
  ds_read_b64_tr_b16 v[112:113], v93 offset:0
  ds_read_b64_tr_b16 v[114:115], v93 offset:1536
  ds_read_b64_tr_b16 v[116:117], v93 offset:32
  ds_read_b64_tr_b16 v[118:119], v93 offset:1568
  ds_read_b64_tr_b16 v[120:121], v93 offset:64
  ds_read_b64_tr_b16 v[122:123], v93 offset:1600
  v_subrev_u32 v30, 16, v30
  ds_write_b128 v30, v[24:27]
  ds_write_b128 v29, v[24:27]
  s_nop 1
  ds_write_b64 v7, v[94:95]
  ds_write_b64 v7, v[96:97] offset:8
  ds_write_b64 v8, v[98:99]
  ds_write_b64 v9, v[100:101]
  ds_write_b32 v10, v102 offset:0
  ds_write_b32 v10, v103 offset:128
  ds_write_b32 v10, v104 offset:256
  ds_write_b32 v10, v105 offset:384
  v_subrev_u32 v31, 16, v11
  ds_read_b128 v[32:35], v31
  ds_read_b128 v[36:39], v11
  ds_read2_b32 v[40:41], v13 offset0:0 offset1:1
  ds_read_b32 v42, v13 offset:8
  ds_read_b64 v[44:45], v12 offset:1024
  ds_read_b32 v46, v12 offset:1032
  ds_read2_b32 v[48:49], v13 offset0:129 offset1:130
  ds_read_b64 v[50:51], v12 offset:1536
  ds_read_b32 v52, v12 offset:1544
  ds_read_b32 v54, v13 offset:1032
  ds_read_b64 v[56:57], v12 offset:2048
  ds_read_b32 v58, v12 offset:2056
  s_waitcnt lgkmcnt(15)
  buffer_store_dwordx4 v[112:115], v110, s[8:11], s100 offen offset:0 sc1
  buffer_store_dwordx4 v[116:119], v110, s[8:11], s100 offen offset:1024 sc1
  buffer_store_dwordx4 v[120:123], v110, s[8:11], s100 offen offset:2048 sc1
  s_mov_b32 s24, s101
  s_waitcnt lgkmcnt(10)
  v_cvt_pk_f16_f32 v60, v36, v37
  v_cvt_pk_f16_f32 v61, v38, v39
  ds_write_b64 v14, v[60:61] offset:32
  v_cvt_pk_f16_f32 v62, v35, v36
  v_cvt_pk_f16_f32 v63, v37, v38
  ds_write_b64 v14, v[62:63] offset:4192
  v_cvt_pk_f16_f32 v64, v34, v35
  v_cvt_pk_f16_f32 v65, v36, v37
  ds_write_b64 v14, v[64:65] offset:8352
  v_cvt_pk_f16_f32 v66, v33, v34
  v_cvt_pk_f16_f32 v67, v35, v36
  ds_write_b64 v14, v[66:67] offset:12512
  s_waitcnt lgkmcnt(10)
  v_cvt_pk_f16_f32 v68, v44, v44
  v_cvt_pk_f16_f32 v69, v45, v46
  ds_write_b64 v14, v[68:69] offset:544
  v_cvt_pk_f16_f32 v70, v42, v44
  v_cvt_pk_f16_f32 v71, v44, v45
  ds_write_b64 v14, v[70:71] offset:4704
  v_cvt_pk_f16_f32 v72, v41, v42
  v_cvt_pk_f16_f32 v73, v44, v44
  ds_write_b64 v14, v[72:73] offset:8864
  v_cvt_pk_f16_f32 v74, v40, v41
  v_cvt_pk_f16_f32 v75, v42, v44
  ds_write_b64 v14, v[74:75] offset:13024
  s_waitcnt lgkmcnt(11)
  v_cvt_pk_f16_f32 v76, v50, v50
  v_cvt_pk_f16_f32 v77, v50, v51
  v_cvt_pk_f16_f32 v78, v51, v51
  v_cvt_pk_f16_f32 v79, v52, v52
  ds_write_b128 v15, v[76:79] offset:1056
  v_cvt_pk_f16_f32 v80, v50, v50
  v_cvt_pk_f16_f32 v81, v50, v50
  v_cvt_pk_f16_f32 v82, v51, v51
  v_cvt_pk_f16_f32 v83, v51, v52
  ds_write_b128 v15, v[80:83] offset:5216
  v_cvt_pk_f16_f32 v84, v49, v50
  v_cvt_pk_f16_f32 v85, v50, v50
  v_cvt_pk_f16_f32 v86, v50, v51
  v_cvt_pk_f16_f32 v87, v51, v51
  ds_write_b128 v15, v[84:87] offset:9376
  v_cvt_pk_f16_f32 v60, v48, v49
  v_cvt_pk_f16_f32 v61, v50, v50
  v_cvt_pk_f16_f32 v62, v50, v50
  v_cvt_pk_f16_f32 v63, v51, v51
  ds_write_b128 v15, v[60:63] offset:13536
  s_waitcnt lgkmcnt(12)
  v_cvt_pk_f16_f32 v64, v56, v56
  v_cvt_pk_f16_f32 v65, v56, v56
  v_cvt_pk_f16_f32 v66, v56, v57
  v_cvt_pk_f16_f32 v67, v57, v57
  v_cvt_pk_f16_f32 v68, v57, v57
  v_cvt_pk_f16_f32 v69, v57, v57
  v_cvt_pk_f16_f32 v70, v58, v58
  v_cvt_pk_f16_f32 v71, v58, v58
  ds_write_b128 v28, v[64:67] offset:2080
  ds_write_b128 v28, v[68:71] offset:2096
  v_cvt_pk_f16_f32 v72, v56, v56
  v_cvt_pk_f16_f32 v73, v56, v56
  v_cvt_pk_f16_f32 v74, v56, v56
  v_cvt_pk_f16_f32 v75, v57, v57
  v_cvt_pk_f16_f32 v76, v57, v57
  v_cvt_pk_f16_f32 v77, v57, v57
  v_cvt_pk_f16_f32 v78, v57, v58
  v_cvt_pk_f16_f32 v79, v58, v58
  ds_write_b128 v28, v[72:75] offset:6240
  ds_write_b128 v28, v[76:79] offset:6256
  v_cvt_pk_f16_f32 v80, v56, v56
  v_cvt_pk_f16_f32 v81, v56, v56
  v_cvt_pk_f16_f32 v82, v56, v56
  v_cvt_pk_f16_f32 v83, v56, v57
  v_cvt_pk_f16_f32 v84, v57, v57
  v_cvt_pk_f16_f32 v85, v57, v57
  v_cvt_pk_f16_f32 v86, v57, v57
  v_cvt_pk_f16_f32 v87, v58, v58
  ds_write_b128 v28, v[80:83] offset:10400
  ds_write_b128 v28, v[84:87] offset:10416
  v_cvt_pk_f16_f32 v60, v54, v56
  v_cvt_pk_f16_f32 v61, v56, v56
  v_cvt_pk_f16_f32 v62, v56, v56
  v_cvt_pk_f16_f32 v63, v56, v56
  v_cvt_pk_f16_f32 v64, v57, v57
  v_cvt_pk_f16_f32 v65, v57, v57
  v_cvt_pk_f16_f32 v66, v57, v57
  v_cvt_pk_f16_f32 v67, v57, v58
  ds_write_b128 v28, v[60:63] offset:14560
  ds_write_b128 v28, v[64:67] offset:14576
  v_and_b32 v1, 15, v0
  v_lshrrev_b32 v2, 4, v0
  v_sub_u32 v3, 15, v1
  v_and_b32 v3, 3, v3
  v_mul_u32_u24 v4, 4160, v3
  v_add_u32 v3, v3, v1
  v_lshlrev_b32 v5, 3, v2
  v_add_u32 v3, v3, v5
  v_add_u32 v3, 1, v3
  v_lshlrev_b32 v3, 1, v3
  v_add_u32 v3, v3, v4
  v_add_u32 v104, s79, v3
  s_mul_i32 s40, s6, 4608
  s_add_u32 s40, s40, 134912
  v_lshlrev_b32 v3, 5, v1
  v_lshlrev_b32 v4, 4, v2
  v_sub_u32 v5, v4, v3
  v_add_u32 v5, 480, v5
  v_add_u32 v105, s40, v5
  s_lshl_b32 s40, s6, 13
  s_add_u32 s40, s40, 0
  v_lshlrev_b32 v3, 6, v1
  v_add_u32 v3, v3, v4
  v_add_u32 v106, s40, v3
  s_add_u32 s41, s94, s6
  s_lshr_b32 s42, s41, 2
  s_and_b32 s42, s42, 1
  s_and_b32 s43, s41, 3
  s_xor_b32 s42, s42, s43
  s_lshl_b32 s41, s41, 7
  s_add_u32 s41, s41, 3145728
  v_lshrrev_b32 v3, 2, v1
  v_mul_u32_u24 v3, 81920, v3
  v_lshlrev_b32 v4, 3, v2
  v_add_u32 v3, v3, v4
  v_and_b32 v4, 3, v1
  v_xor_b32 v4, s42, v4
  v_lshlrev_b32 v4, 5, v4
  v_add_u32 v107, v3, v4
  v_and_b32 v3, 7, v0
  v_lshlrev_b32 v3, 7, v3
  s_lshl_b32 s7, s98, 10
  s_add_u32 s7, s7, 4096
  v_add_u32 v3, s7, v3
  v_and_b32 v4, 31, v0
  v_min_u32 v4, 19, v4
  v_lshlrev_b32 v4, 7, v4
  v_mov_b32 v5, s89
  v_mul_u32_u24 v5, 2560, v5
  v_add_u32 v4, 425984, v4
  v_add_u32 v4, v5, v4
  v_and_b32 v108, 1, v0
  v_lshlrev_b32 v108, 7, v108
  v_and_b32 v109, 2, v0
  v_lshlrev_b32 v109, 12, v109
  v_add_u32 v108, v108, v109
  v_mov_b32 v109, s89
  v_lshlrev_b32 v109, 8, v109
  v_add_u32 v108, 393216, v108
  v_add_u32 v108, v109, v108
  s_waitcnt lgkmcnt(0)
  s_barrier
  ds_read_b128 v[72:75], v105 offset:3584
  ds_read_b64 v[68:69], v104 offset:3584
  ds_read_b64 v[70:71], v104 offset:3592
  ds_read_b128 v[76:79], v105 offset:3072
  ds_read_b64 v[64:65], v104 offset:3072
  ds_read_b64 v[66:67], v104 offset:3080
  ds_read_b128 v[80:83], v105 offset:2560
  ds_read_b64 v[60:61], v104 offset:2560
  ds_read_b64 v[62:63], v104 offset:2568
  ds_read_b128 v[84:87], v105 offset:2048
  ds_read_b64 v[56:57], v104 offset:2048
  ds_read_b64 v[58:59], v104 offset:2056
  ds_read_b128 v[88:91], v105 offset:1536
  ds_read_b64 v[52:53], v104 offset:1536
  ds_read_b64 v[54:55], v104 offset:1544
  ds_read_b128 v[92:95], v105 offset:1024
  ds_read_b64 v[48:49], v104 offset:1024
  ds_read_b64 v[50:51], v104 offset:1032
  ds_read_b128 v[96:99], v105 offset:512
  ds_read_b64 v[44:45], v104 offset:512
  ds_read_b64 v[46:47], v104 offset:520
  ds_read_b128 v[100:103], v105 offset:0
  ds_read_b64 v[40:41], v104 offset:0
  ds_read_b64 v[42:43], v104 offset:8
  buffer_load_dword v5, v3, s[8:11], 0 offen sc1
  s_waitcnt lgkmcnt(15)
  v_mfma_f32_16x16x32_f16 v[36:39], v[68:71], v[72:75], 0
  ds_read_b64 v[68:69], v104 offset:3648
  ds_read_b64 v[70:71], v104 offset:3656
  v_mfma_f32_16x16x32_f16 v[32:35], v[64:67], v[72:75], 0
  v_mfma_f32_16x16x32_f16 v[36:39], v[64:67], v[76:79], v[36:39]
  ds_read_b64 v[64:65], v104 offset:3136
  ds_read_b64 v[66:67], v104 offset:3144
  v_mfma_f32_16x16x32_f16 v[28:31], v[60:63], v[72:75], 0
  v_mfma_f32_16x16x32_f16 v[32:35], v[60:63], v[76:79], v[32:35]
  v_mfma_f32_16x16x32_f16 v[36:39], v[60:63], v[80:83], v[36:39]
  ds_read_b64 v[60:61], v104 offset:2624
  ds_read_b64 v[62:63], v104 offset:2632
  s_waitcnt lgkmcnt(15)
  v_mfma_f32_16x16x32_f16 v[24:27], v[56:59], v[72:75], 0
  v_mfma_f32_16x16x32_f16 v[28:31], v[56:59], v[76:79], v[28:31]
  v_mfma_f32_16x16x32_f16 v[32:35], v[56:59], v[80:83], v[32:35]
  v_mfma_f32_16x16x32_f16 v[36:39], v[56:59], v[84:87], v[36:39]
  ds_read_b64 v[56:57], v104 offset:2112
  ds_read_b64 v[58:59], v104 offset:2120
  v_mfma_f32_16x16x32_f16 v[20:23], v[52:55], v[72:75], 0
  v_mfma_f32_16x16x32_f16 v[24:27], v[52:55], v[76:79], v[24:27]
  v_mfma_f32_16x16x32_f16 v[28:31], v[52:55], v[80:83], v[28:31]
  v_mfma_f32_16x16x32_f16 v[32:35], v[52:55], v[84:87], v[32:35]
  v_mfma_f32_16x16x32_f16 v[36:39], v[52:55], v[88:91], v[36:39]
  ds_read_b64 v[52:53], v104 offset:1600
  ds_read_b64 v[54:55], v104 offset:1608
  s_waitcnt lgkmcnt(15)
  v_mfma_f32_16x16x32_f16 v[16:19], v[48:51], v[72:75], 0
  v_mfma_f32_16x16x32_f16 v[20:23], v[48:51], v[76:79], v[20:23]
  v_mfma_f32_16x16x32_f16 v[24:27], v[48:51], v[80:83], v[24:27]
  v_mfma_f32_16x16x32_f16 v[28:31], v[48:51], v[84:87], v[28:31]
  v_mfma_f32_16x16x32_f16 v[32:35], v[48:51], v[88:91], v[32:35]
  v_mfma_f32_16x16x32_f16 v[36:39], v[48:51], v[92:95], v[36:39]
  ds_read_b64 v[48:49], v104 offset:1088
  ds_read_b64 v[50:51], v104 offset:1096
  s_waitcnt lgkmcnt(15)
  v_mfma_f32_16x16x32_f16 v[12:15], v[44:47], v[72:75], 0
  v_mfma_f32_16x16x32_f16 v[16:19], v[44:47], v[76:79], v[16:19]
  v_mfma_f32_16x16x32_f16 v[20:23], v[44:47], v[80:83], v[20:23]
  v_mfma_f32_16x16x32_f16 v[24:27], v[44:47], v[84:87], v[24:27]
  v_mfma_f32_16x16x32_f16 v[28:31], v[44:47], v[88:91], v[28:31]
  v_mfma_f32_16x16x32_f16 v[32:35], v[44:47], v[92:95], v[32:35]
  v_mfma_f32_16x16x32_f16 v[36:39], v[44:47], v[96:99], v[36:39]
  ds_read_b64 v[44:45], v104 offset:576
  ds_read_b64 v[46:47], v104 offset:584
  s_waitcnt lgkmcnt(14)
  v_mfma_f32_16x16x32_f16 v[8:11], v[40:43], v[72:75], 0
  ds_read_b128 v[72:75], v105 offset:3648
  v_mfma_f32_16x16x32_f16 v[12:15], v[40:43], v[76:79], v[12:15]
  ds_read_b128 v[76:79], v105 offset:3136
  v_mfma_f32_16x16x32_f16 v[16:19], v[40:43], v[80:83], v[16:19]
  ds_read_b128 v[80:83], v105 offset:2624
  v_mfma_f32_16x16x32_f16 v[20:23], v[40:43], v[84:87], v[20:23]
  ds_read_b128 v[84:87], v105 offset:2112
  v_mfma_f32_16x16x32_f16 v[24:27], v[40:43], v[88:91], v[24:27]
  ds_read_b128 v[88:91], v105 offset:1600
  v_mfma_f32_16x16x32_f16 v[28:31], v[40:43], v[92:95], v[28:31]
  ds_read_b128 v[92:95], v105 offset:1088
  v_mfma_f32_16x16x32_f16 v[32:35], v[40:43], v[96:99], v[32:35]
  ds_read_b128 v[96:99], v105 offset:576
  v_mfma_f32_16x16x32_f16 v[36:39], v[40:43], v[100:103], v[36:39]
  ds_read_b128 v[100:103], v105 offset:64
  ds_read_b64 v[40:41], v104 offset:64
  ds_read_b64 v[42:43], v104 offset:72
  buffer_load_dword v7, v108, s[8:11], 0 offen sc1
  s_waitcnt vmcnt(2)
  v_mov_b32 v1, s3
  v_mov_b32 v2, 0
  s_mov_b64 exec, 1
  buffer_store_dword v1, v2, s[8:11], s24 offen sc1
  s_mov_b64 exec, -1
  s_waitcnt lgkmcnt(9)
  v_mfma_f32_16x16x32_f16 v[36:39], v[68:71], v[72:75], v[36:39]
  ds_read_b64 v[68:69], v104 offset:3712
  ds_read_b64 v[70:71], v104 offset:3720
  v_mfma_f32_16x16x32_f16 v[32:35], v[64:67], v[72:75], v[32:35]
  s_waitcnt lgkmcnt(10)
  v_mfma_f32_16x16x32_f16 v[36:39], v[64:67], v[76:79], v[36:39]
  ds_read_b64 v[64:65], v104 offset:3200
  ds_read_b64 v[66:67], v104 offset:3208
  v_mfma_f32_16x16x32_f16 v[28:31], v[60:63], v[72:75], v[28:31]
  v_mfma_f32_16x16x32_f16 v[32:35], v[60:63], v[76:79], v[32:35]
  s_waitcnt lgkmcnt(11)
  v_mfma_f32_16x16x32_f16 v[36:39], v[60:63], v[80:83], v[36:39]
  ds_read_b64 v[60:61], v104 offset:2688
  ds_read_b64 v[62:63], v104 offset:2696
  v_mfma_f32_16x16x32_f16 v[24:27], v[56:59], v[72:75], v[24:27]
  v_mfma_f32_16x16x32_f16 v[28:31], v[56:59], v[76:79], v[28:31]
  v_mfma_f32_16x16x32_f16 v[32:35], v[56:59], v[80:83], v[32:35]
  s_waitcnt lgkmcnt(12)
  v_mfma_f32_16x16x32_f16 v[36:39], v[56:59], v[84:87], v[36:39]
  ds_read_b64 v[56:57], v104 offset:2176
  ds_read_b64 v[58:59], v104 offset:2184
  v_mfma_f32_16x16x32_f16 v[20:23], v[52:55], v[72:75], v[20:23]
  v_mfma_f32_16x16x32_f16 v[24:27], v[52:55], v[76:79], v[24:27]
  v_mfma_f32_16x16x32_f16 v[28:31], v[52:55], v[80:83], v[28:31]
  v_mfma_f32_16x16x32_f16 v[32:35], v[52:55], v[84:87], v[32:35]
  s_waitcnt lgkmcnt(13)
  v_mfma_f32_16x16x32_f16 v[36:39], v[52:55], v[88:91], v[36:39]
  ds_read_b64 v[52:53], v104 offset:1664
  ds_read_b64 v[54:55], v104 offset:1672
  v_mfma_f32_16x16x32_f16 v[16:19], v[48:51], v[72:75], v[16:19]
  v_mfma_f32_16x16x32_f16 v[20:23], v[48:51], v[76:79], v[20:23]
  v_mfma_f32_16x16x32_f16 v[24:27], v[48:51], v[80:83], v[24:27]
  v_mfma_f32_16x16x32_f16 v[28:31], v[48:51], v[84:87], v[28:31]
  v_mfma_f32_16x16x32_f16 v[32:35], v[48:51], v[88:91], v[32:35]
  s_waitcnt lgkmcnt(14)
  v_mfma_f32_16x16x32_f16 v[36:39], v[48:51], v[92:95], v[36:39]
  ds_read_b64 v[48:49], v104 offset:1152
  ds_read_b64 v[50:51], v104 offset:1160
  v_mfma_f32_16x16x32_f16 v[12:15], v[44:47], v[72:75], v[12:15]
  v_mfma_f32_16x16x32_f16 v[16:19], v[44:47], v[76:79], v[16:19]
  v_mfma_f32_16x16x32_f16 v[20:23], v[44:47], v[80:83], v[20:23]
  v_mfma_f32_16x16x32_f16 v[24:27], v[44:47], v[84:87], v[24:27]
  v_mfma_f32_16x16x32_f16 v[28:31], v[44:47], v[88:91], v[28:31]
  v_mfma_f32_16x16x32_f16 v[32:35], v[44:47], v[92:95], v[32:35]
  s_waitcnt lgkmcnt(15)
  v_mfma_f32_16x16x32_f16 v[36:39], v[44:47], v[96:99], v[36:39]
  ds_read_b64 v[44:45], v104 offset:640
  ds_read_b64 v[46:47], v104 offset:648
  s_waitcnt lgkmcnt(14)
  v_mfma_f32_16x16x32_f16 v[8:11], v[40:43], v[72:75], v[8:11]
  ds_read_b128 v[72:75], v105 offset:3712
  v_mfma_f32_16x16x32_f16 v[12:15], v[40:43], v[76:79], v[12:15]
  ds_read_b128 v[76:79], v105 offset:3200
  v_mfma_f32_16x16x32_f16 v[16:19], v[40:43], v[80:83], v[16:19]
  ds_read_b128 v[80:83], v105 offset:2688
  v_mfma_f32_16x16x32_f16 v[20:23], v[40:43], v[84:87], v[20:23]
  ds_read_b128 v[84:87], v105 offset:2176
  v_mfma_f32_16x16x32_f16 v[24:27], v[40:43], v[88:91], v[24:27]
  ds_read_b128 v[88:91], v105 offset:1664
  v_mfma_f32_16x16x32_f16 v[28:31], v[40:43], v[92:95], v[28:31]
  ds_read_b128 v[92:95], v105 offset:1152
  v_mfma_f32_16x16x32_f16 v[32:35], v[40:43], v[96:99], v[32:35]
  ds_read_b128 v[96:99], v105 offset:640
  v_mfma_f32_16x16x32_f16 v[36:39], v[40:43], v[100:103], v[36:39]
  ds_read_b128 v[100:103], v105 offset:128
  ds_read_b64 v[40:41], v104 offset:128
  ds_read_b64 v[42:43], v104 offset:136
  s_waitcnt vmcnt(1)
  v_cmp_ne_u32 vcc, s3, v7
  s_nop 1
  s_cbranch_vccz ok_4
  s_mov_b32 s97, 0x20000
  s_branch polls_6
poll_5:
  s_sleep 4
polls_6:
  s_sub_u32 s97, s97, 1
  s_cbranch_scc1 END
  buffer_load_dword v7, v108, s[8:11], 0 offen sc1
  s_waitcnt vmcnt(0)
  v_cmp_ne_u32 vcc, s3, v7
  s_nop 1
  s_cbranch_vccnz poll_5
ok_4:
  s_waitcnt lgkmcnt(9)
  v_mfma_f32_16x16x32_f16 v[36:39], v[68:71], v[72:75], v[36:39]
  ds_read_b64 v[68:69], v104 offset:3776
  ds_read_b64 v[70:71], v104 offset:3784
  v_mfma_f32_16x16x32_f16 v[32:35], v[64:67], v[72:75], v[32:35]
  s_mul_i32 s100, s89, 25600
  s_add_u32 s101, s100, 9863168
  s_add_u32 s100, s100, 9043968
  buffer_load_dwordx4 a[0:3], v110, s[8:11], s100 offen offset:0 sc1
  s_waitcnt lgkmcnt(10)
  v_mfma_f32_16x16x32_f16 v[36:39], v[64:67], v[76:79], v[36:39]
  ds_read_b64 v[64:65], v104 offset:3264
  ds_read_b64 v[66:67], v104 offset:3272
  v_mfma_f32_16x16x32_f16 v[28:31], v[60:63], v[72:75], v[28:31]
  v_mfma_f32_16x16x32_f16 v[32:35], v[60:63], v[76:79], v[32:35]
  buffer_load_dwordx4 a[4:7], v110, s[8:11], s100 offen offset:1024 sc1
  s_waitcnt lgkmcnt(11)
  v_mfma_f32_16x16x32_f16 v[36:39], v[60:63], v[80:83], v[36:39]
  ds_read_b64 v[60:61], v104 offset:2752
  ds_read_b64 v[62:63], v104 offset:2760
  v_mfma_f32_16x16x32_f16 v[24:27], v[56:59], v[72:75], v[24:27]
  v_mfma_f32_16x16x32_f16 v[28:31], v[56:59], v[76:79], v[28:31]
  buffer_load_dwordx4 a[8:11], v110, s[8:11], s100 offen offset:2048 sc1
  v_mfma_f32_16x16x32_f16 v[32:35], v[56:59], v[80:83], v[32:35]
  s_waitcnt lgkmcnt(12)
  v_mfma_f32_16x16x32_f16 v[36:39], v[56:59], v[84:87], v[36:39]
  ds_read_b64 v[56:57], v104 offset:2240
  ds_read_b64 v[58:59], v104 offset:2248
  v_mfma_f32_16x16x32_f16 v[20:23], v[52:55], v[72:75], v[20:23]
  buffer_load_dwordx4 a[12:15], v110, s[8:11], s100 offen offset:3072 sc1
  v_mfma_f32_16x16x32_f16 v[24:27], v[52:55], v[76:79], v[24:27]
  v_mfma_f32_16x16x32_f16 v[28:31], v[52:55], v[80:83], v[28:31]
  s_add_u32 s100, s100, 4096
  buffer_load_dwordx4 a[16:19], v110, s[8:11], s100 offen offset:0 sc1
  v_mfma_f32_16x16x32_f16 v[32:35], v[52:55], v[84:87], v[32:35]
  s_waitcnt lgkmcnt(13)
  v_mfma_f32_16x16x32_f16 v[36:39], v[52:55], v[88:91], v[36:39]
  ds_read_b64 v[52:53], v104 offset:1728
  ds_read_b64 v[54:55], v104 offset:1736
  v_mfma_f32_16x16x32_f16 v[16:19], v[48:51], v[72:75], v[16:19]
  buffer_load_dwordx4 a[20:23], v110, s[8:11], s100 offen offset:1024 sc1
  v_mfma_f32_16x16x32_f16 v[20:23], v[48:51], v[76:79], v[20:23]
  v_mfma_f32_16x16x32_f16 v[24:27], v[48:51], v[80:83], v[24:27]
  buffer_load_dwordx4 a[24:27], v110, s[8:11], s100 offen offset:2048 sc1
  v_mfma_f32_16x16x32_f16 v[28:31], v[48:51], v[84:87], v[28:31]
  v_mfma_f32_16x16x32_f16 v[32:35], v[48:51], v[88:91], v[32:35]
  buffer_load_dwordx4 a[28:31], v110, s[8:11], s100 offen offset:3072 sc1
  s_waitcnt lgkmcnt(14)
  v_mfma_f32_16x16x32_f16 v[36:39], v[48:51], v[92:95], v[36:39]
  ds_read_b64 v[48:49], v104 offset:1216
  ds_read_b64 v[50:51], v104 offset:1224
  v_mfma_f32_16x16x32_f16 v[12:15], v[44:47], v[72:75], v[12:15]
  v_mfma_f32_16x16x32_f16 v[16:19], v[44:47], v[76:79], v[16:19]
  s_add_u32 s100, s100, 4096
  buffer_load_dwordx4 a[32:35], v110, s[8:11], s100 offen offset:0 sc1
  v_mfma_f32_16x16x32_f16 v[20:23], v[44:47], v[80:83], v[20:23]
  v_mfma_f32_16x16x32_f16 v[24:27], v[44:47], v[84:87], v[24:27]
  buffer_load_dwordx4 a[36:39], v110, s[8:11], s100 offen offset:1024 sc1
  v_mfma_f32_16x16x32_f16 v[28:31], v[44:47], v[88:91], v[28:31]
  v_mfma_f32_16x16x32_f16 v[32:35], v[44:47], v[92:95], v[32:35]
  buffer_load_dwordx4 a[40:43], v110, s[8:11], s100 offen offset:2048 sc1
  s_waitcnt lgkmcnt(15)
  v_mfma_f32_16x16x32_f16 v[36:39], v[44:47], v[96:99], v[36:39]
  ds_read_b64 v[44:45], v104 offset:704
  ds_read_b64 v[46:47], v104 offset:712
  s_waitcnt lgkmcnt(14)
  v_mfma_f32_16x16x32_f16 v[8:11], v[40:43], v[72:75], v[8:11]
  ds_read_b128 v[72:75], v105 offset:3776
  v_mfma_f32_16x16x32_f16 v[12:15], v[40:43], v[76:79], v[12:15]
  ds_read_b128 v[76:79], v105 offset:3264
  v_mfma_f32_16x16x32_f16 v[16:19], v[40:43], v[80:83], v[16:19]
  ds_read_b128 v[80:83], v105 offset:2752
  v_mfma_f32_16x16x32_f16 v[20:23], v[40:43], v[84:87], v[20:23]
  ds_read_b128 v[84:87], v105 offset:2240
  v_mfma_f32_16x16x32_f16 v[24:27], v[40:43], v[88:91], v[24:27]
  ds_read_b128 v[88:91], v105 offset:1728
  v_mfma_f32_16x16x32_f16 v[28:31], v[40:43], v[92:95], v[28:31]
  ds_read_b128 v[92:95], v105 offset:1216
  v_mfma_f32_16x16x32_f16 v[32:35], v[40:43], v[96:99], v[32:35]
  ds_read_b128 v[96:99], v105 offset:704
  v_mfma_f32_16x16x32_f16 v[36:39], v[40:43], v[100:103], v[36:39]
  ds_read_b128 v[100:103], v105 offset:192
  ds_read_b64 v[40:41], v104 offset:192
  ds_read_b64 v[42:43], v104 offset:200
  s_waitcnt lgkmcnt(9)
  v_mfma_f32_16x16x32_f16 v[36:39], v[68:71], v[72:75], v[36:39]
  ds_read_b64 v[68:69], v104 offset:3840
  ds_read_b64 v[70:71], v104 offset:3848
  v_mfma_f32_16x16x32_f16 v[32:35], v[64:67], v[72:75], v[32:35]
  s_waitcnt lgkmcnt(10)
  v_mfma_f32_16x16x32_f16 v[36:39], v[64:67], v[76:79], v[36:39]
  ds_read_b64 v[64:65], v104 offset:3328
  ds_read_b64 v[66:67], v104 offset:3336
  v_mfma_f32_16x16x32_f16 v[28:31], v[60:63], v[72:75], v[28:31]
  buffer_load_dwordx4 a[44:47], v110, s[8:11], s100 offen offset:3072 sc1
  v_mfma_f32_16x16x32_f16 v[32:35], v[60:63], v[76:79], v[32:35]
  s_waitcnt lgkmcnt(11)
  v_mfma_f32_16x16x32_f16 v[36:39], v[60:63], v[80:83], v[36:39]
  ds_read_b64 v[60:61], v104 offset:2816
  ds_read_b64 v[62:63], v104 offset:2824
  v_mfma_f32_16x16x32_f16 v[24:27], v[56:59], v[72:75], v[24:27]
  s_add_u32 s100, s100, 4096
  buffer_load_dwordx4 a[48:51], v110, s[8:11], s100 offen offset:0 sc1
  v_mfma_f32_16x16x32_f16 v[28:31], v[56:59], v[76:79], v[28:31]
  v_mfma_f32_16x16x32_f16 v[32:35], v[56:59], v[80:83], v[32:35]
  buffer_load_dwordx4 a[52:55], v110, s[8:11], s100 offen offset:1024 sc1
  s_waitcnt lgkmcnt(12)
  v_mfma_f32_16x16x32_f16 v[36:39], v[56:59], v[84:87], v[36:39]
  ds_read_b64 v[56:57], v104 offset:2304
  ds_read_b64 v[58:59], v104 offset:2312
  v_mfma_f32_16x16x32_f16 v[20:23], v[52:55], v[72:75], v[20:23]
  v_mfma_f32_16x16x32_f16 v[24:27], v[52:55], v[76:79], v[24:27]
  buffer_load_dwordx4 a[56:59], v110, s[8:11], s100 offen offset:2048 sc1
  v_mfma_f32_16x16x32_f16 v[28:31], v[52:55], v[80:83], v[28:31]
  v_mfma_f32_16x16x32_f16 v[32:35], v[52:55], v[84:87], v[32:35]
  buffer_load_dwordx4 a[60:63], v110, s[8:11], s100 offen offset:3072 sc1
  s_waitcnt lgkmcnt(13)
  v_mfma_f32_16x16x32_f16 v[36:39], v[52:55], v[88:91], v[36:39]
  ds_read_b64 v[52:53], v104 offset:1792
  ds_read_b64 v[54:55], v104 offset:1800
  v_mfma_f32_16x16x32_f16 v[16:19], v[48:51], v[72:75], v[16:19]
  v_mfma_f32_16x16x32_f16 v[20:23], v[48:51], v[76:79], v[20:23]
  s_add_u32 s100, s100, 4096
  buffer_load_dwordx4 a[64:67], v110, s[8:11], s100 offen offset:0 sc1
  v_mfma_f32_16x16x32_f16 v[24:27], v[48:51], v[80:83], v[24:27]
  v_mfma_f32_16x16x32_f16 v[28:31], v[48:51], v[84:87], v[28:31]
  buffer_load_dwordx4 a[68:71], v110, s[8:11], s100 offen offset:1024 sc1
  v_mfma_f32_16x16x32_f16 v[32:35], v[48:51], v[88:91], v[32:35]
  s_waitcnt lgkmcnt(14)
  v_mfma_f32_16x16x32_f16 v[36:39], v[48:51], v[92:95], v[36:39]
  ds_read_b64 v[48:49], v104 offset:1280
  ds_read_b64 v[50:51], v104 offset:1288
  v_mfma_f32_16x16x32_f16 v[12:15], v[44:47], v[72:75], v[12:15]
  buffer_load_dwordx4 a[72:75], v110, s[8:11], s100 offen offset:2048 sc1
  v_mfma_f32_16x16x32_f16 v[16:19], v[44:47], v[76:79], v[16:19]
  v_mfma_f32_16x16x32_f16 v[20:23], v[44:47], v[80:83], v[20:23]
  buffer_load_dwordx4 a[76:79], v110, s[8:11], s100 offen offset:3072 sc1
  v_mfma_f32_16x16x32_f16 v[24:27], v[44:47], v[84:87], v[24:27]
  v_mfma_f32_16x16x32_f16 v[28:31], v[44:47], v[88:91], v[28:31]
  s_add_u32 s100, s100, 4096
  buffer_load_dwordx4 a[80:83], v110, s[8:11], s100 offen offset:0 sc1
  v_mfma_f32_16x16x32_f16 v[32:35], v[44:47], v[92:95], v[32:35]
  s_waitcnt lgkmcnt(15)
  v_mfma_f32_16x16x32_f16 v[36:39], v[44:47], v[96:99], v[36:39]
  ds_read_b64 v[44:45], v104 offset:768
  ds_read_b64 v[46:47], v104 offset:776
  s_waitcnt lgkmcnt(14)
  v_mfma_f32_16x16x32_f16 v[8:11], v[40:43], v[72:75], v[8:11]
  ds_read_b128 v[72:75], v105 offset:3840
  v_mfma_f32_16x16x32_f16 v[12:15], v[40:43], v[76:79], v[12:15]
  ds_read_b128 v[76:79], v105 offset:3328
  v_mfma_f32_16x16x32_f16 v[16:19], v[40:43], v[80:83], v[16:19]
  ds_read_b128 v[80:83], v105 offset:2816
  v_mfma_f32_16x16x32_f16 v[20:23], v[40:43], v[84:87], v[20:23]
  ds_read_b128 v[84:87], v105 offset:2304
  v_mfma_f32_16x16x32_f16 v[24:27], v[40:43], v[88:91], v[24:27]
  ds_read_b128 v[88:91], v105 offset:1792
  v_mfma_f32_16x16x32_f16 v[28:31], v[40:43], v[92:95], v[28:31]
  ds_read_b128 v[92:95], v105 offset:1280
  v_mfma_f32_16x16x32_f16 v[32:35], v[40:43], v[96:99], v[32:35]
  ds_read_b128 v[96:99], v105 offset:768
  v_mfma_f32_16x16x32_f16 v[36:39], v[40:43], v[100:103], v[36:39]
  ds_read_b128 v[100:103], v105 offset:256
  ds_read_b64 v[40:41], v104 offset:256
  ds_read_b64 v[42:43], v104 offset:264
  s_waitcnt lgkmcnt(9)
  v_mfma_f32_16x16x32_f16 v[36:39], v[68:71], v[72:75], v[36:39]
  ds_read_b64 v[68:69], v104 offset:3904
  ds_read_b64 v[70:71], v104 offset:3912
  v_mfma_f32_16x16x32_f16 v[32:35], v[64:67], v[72:75], v[32:35]
  buffer_load_dwordx4 a[84:87], v110, s[8:11], s100 offen offset:1024 sc1
  s_waitcnt lgkmcnt(10)
  v_mfma_f32_16x16x32_f16 v[36:39], v[64:67], v[76:79], v[36:39]
  ds_read_b64 v[64:65], v104 offset:3392
  ds_read_b64 v[66:67], v104 offset:3400
  v_mfma_f32_16x16x32_f16 v[28:31], v[60:63], v[72:75], v[28:31]
  v_mfma_f32_16x16x32_f16 v[32:35], v[60:63], v[76:79], v[32:35]
  buffer_load_dwordx4 a[88:91], v110, s[8:11], s100 offen offset:2048 sc1
  s_waitcnt lgkmcnt(11)
  v_mfma_f32_16x16x32_f16 v[36:39], v[60:63], v[80:83], v[36:39]
  ds_read_b64 v[60:61], v104 offset:2880
  ds_read_b64 v[62:63], v104 offset:2888
  v_mfma_f32_16x16x32_f16 v[24:27], v[56:59], v[72:75], v[24:27]
  v_mfma_f32_16x16x32_f16 v[28:31], v[56:59], v[76:79], v[28:31]
  buffer_load_dwordx4 a[92:95], v110, s[8:11], s100 offen offset:3072 sc1
  v_mfma_f32_16x16x32_f16 v[32:35], v[56:59], v[80:83], v[32:35]
  s_waitcnt lgkmcnt(12)
  v_mfma_f32_16x16x32_f16 v[36:39], v[56:59], v[84:87], v[36:39]
  ds_read_b64 v[56:57], v104 offset:2368
  ds_read_b64 v[58:59], v104 offset:2376
  v_mfma_f32_16x16x32_f16 v[20:23], v[52:55], v[72:75], v[20:23]
  s_add_u32 s100, s100, 4096
  buffer_load_dwordx4 a[96:99], v110, s[8:11], s100 offen offset:0 sc1
  v_mfma_f32_16x16x32_f16 v[24:27], v[52:55], v[76:79], v[24:27]
  v_mfma_f32_16x16x32_f16 v[28:31], v[52:55], v[80:83], v[28:31]
  buffer_load_dwordx4 a[100:103], v110, s[8:11], s101 offen offset:0 sc1
  v_mfma_f32_16x16x32_f16 v[32:35], v[52:55], v[84:87], v[32:35]
  s_waitcnt lgkmcnt(13)
  v_mfma_f32_16x16x32_f16 v[36:39], v[52:55], v[88:91], v[36:39]
  ds_read_b64 v[52:53], v104 offset:1856
  ds_read_b64 v[54:55], v104 offset:1864
  v_mfma_f32_16x16x32_f16 v[16:19], v[48:51], v[72:75], v[16:19]
  buffer_load_dwordx4 a[104:107], v110, s[8:11], s101 offen offset:1024 sc1
  v_mfma_f32_16x16x32_f16 v[20:23], v[48:51], v[76:79], v[20:23]
  v_mfma_f32_16x16x32_f16 v[24:27], v[48:51], v[80:83], v[24:27]
  buffer_load_dwordx4 a[108:111], v110, s[8:11], s101 offen offset:2048 sc1
  v_mfma_f32_16x16x32_f16 v[28:31], v[48:51], v[84:87], v[28:31]
  v_mfma_f32_16x16x32_f16 v[32:35], v[48:51], v[88:91], v[32:35]
  buffer_load_dwordx4 a[112:115], v110, s[8:11], s101 offen offset:3072 sc1
  s_waitcnt lgkmcnt(14)
  v_mfma_f32_16x16x32_f16 v[36:39], v[48:51], v[92:95], v[36:39]
  ds_read_b64 v[48:49], v104 offset:1344
  ds_read_b64 v[50:51], v104 offset:1352
  v_mfma_f32_16x16x32_f16 v[12:15], v[44:47], v[72:75], v[12:15]
  v_mfma_f32_16x16x32_f16 v[16:19], v[44:47], v[76:79], v[16:19]
  s_add_u32 s101, s101, 4096
  buffer_load_dwordx4 a[116:119], v110, s[8:11], s101 offen offset:0 sc1
  v_mfma_f32_16x16x32_f16 v[20:23], v[44:47], v[80:83], v[20:23]
  v_mfma_f32_16x16x32_f16 v[24:27], v[44:47], v[84:87], v[24:27]
  buffer_load_dwordx4 a[120:123], v110, s[8:11], s101 offen offset:1024 sc1
  v_mfma_f32_16x16x32_f16 v[28:31], v[44:47], v[88:91], v[28:31]
  v_mfma_f32_16x16x32_f16 v[32:35], v[44:47], v[92:95], v[32:35]
  buffer_load_dwordx4 a[124:127], v110, s[8:11], s101 offen offset:2048 sc1
  s_waitcnt lgkmcnt(15)
  v_mfma_f32_16x16x32_f16 v[36:39], v[44:47], v[96:99], v[36:39]
  ds_read_b64 v[44:45], v104 offset:832
  ds_read_b64 v[46:47], v104 offset:840
  s_waitcnt lgkmcnt(14)
  v_mfma_f32_16x16x32_f16 v[8:11], v[40:43], v[72:75], v[8:11]
  ds_read_b128 v[72:75], v105 offset:3904
  v_mfma_f32_16x16x32_f16 v[12:15], v[40:43], v[76:79], v[12:15]
  ds_read_b128 v[76:79], v105 offset:3392
  v_mfma_f32_16x16x32_f16 v[16:19], v[40:43], v[80:83], v[16:19]
  ds_read_b128 v[80:83], v105 offset:2880
  v_mfma_f32_16x16x32_f16 v[20:23], v[40:43], v[84:87], v[20:23]
  ds_read_b128 v[84:87], v105 offset:2368
  v_mfma_f32_16x16x32_f16 v[24:27], v[40:43], v[88:91], v[24:27]
  ds_read_b128 v[88:91], v105 offset:1856
  v_mfma_f32_16x16x32_f16 v[28:31], v[40:43], v[92:95], v[28:31]
  ds_read_b128 v[92:95], v105 offset:1344
  v_mfma_f32_16x16x32_f16 v[32:35], v[40:43], v[96:99], v[32:35]
  ds_read_b128 v[96:99], v105 offset:832
  v_mfma_f32_16x16x32_f16 v[36:39], v[40:43], v[100:103], v[36:39]
  ds_read_b128 v[100:103], v105 offset:320
  ds_read_b64 v[40:41], v104 offset:320
  ds_read_b64 v[42:43], v104 offset:328
  s_barrier
  s_waitcnt lgkmcnt(9)
  v_mfma_f32_16x16x32_f16 v[36:39], v[68:71], v[72:75], v[36:39]
  ds_read_b64 v[68:69], v104 offset:3968
  ds_read_b64 v[70:71], v104 offset:3976
  v_mfma_f32_16x16x32_f16 v[32:35], v[64:67], v[72:75], v[32:35]
  s_waitcnt lgkmcnt(10)
  v_mfma_f32_16x16x32_f16 v[36:39], v[64:67], v[76:79], v[36:39]
  ds_read_b64 v[64:65], v104 offset:3456
  ds_read_b64 v[66:67], v104 offset:3464
  v_mfma_f32_16x16x32_f16 v[28:31], v[60:63], v[72:75], v[28:31]
  buffer_load_dwordx4 a[128:131], v110, s[8:11], s101 offen offset:3072 sc1
  v_mfma_f32_16x16x32_f16 v[32:35], v[60:63], v[76:79], v[32:35]
  s_waitcnt lgkmcnt(11)
  v_mfma_f32_16x16x32_f16 v[36:39], v[60:63], v[80:83], v[36:39]
  ds_read_b64 v[60:61], v104 offset:2944
  ds_read_b64 v[62:63], v104 offset:2952
  v_mfma_f32_16x16x32_f16 v[24:27], v[56:59], v[72:75], v[24:27]
  s_add_u32 s101, s101, 4096
  buffer_load_dwordx4 a[132:135], v110, s[8:11], s101 offen offset:0 sc1
  v_mfma_f32_16x16x32_f16 v[28:31], v[56:59], v[76:79], v[28:31]
  v_mfma_f32_16x16x32_f16 v[32:35], v[56:59], v[80:83], v[32:35]
  buffer_load_dwordx4 a[136:139], v110, s[8:11], s101 offen offset:1024 sc1
  s_waitcnt lgkmcnt(12)
  v_mfma_f32_16x16x32_f16 v[36:39], v[56:59], v[84:87], v[36:39]
  ds_read_b64 v[56:57], v104 offset:2432
  ds_read_b64 v[58:59], v104 offset:2440
  v_mfma_f32_16x16x32_f16 v[20:23], v[52:55], v[72:75], v[20:23]
  v_mfma_f32_16x16x32_f16 v[24:27], v[52:55], v[76:79], v[24:27]
  buffer_load_dwordx4 a[140:143], v110, s[8:11], s101 offen offset:2048 sc1
  v_mfma_f32_16x16x32_f16 v[28:31], v[52:55], v[80:83], v[28:31]
  v_mfma_f32_16x16x32_f16 v[32:35], v[52:55], v[84:87], v[32:35]
  buffer_load_dwordx4 a[144:147], v110, s[8:11], s101 offen offset:3072 sc1
  s_waitcnt lgkmcnt(13)
  v_mfma_f32_16x16x32_f16 v[36:39], v[52:55], v[88:91], v[36:39]
  ds_read_b64 v[52:53], v104 offset:1920
  ds_read_b64 v[54:55], v104 offset:1928
  v_mfma_f32_16x16x32_f16 v[16:19], v[48:51], v[72:75], v[16:19]
  v_mfma_f32_16x16x32_f16 v[20:23], v[48:51], v[76:79], v[20:23]
  s_add_u32 s101, s101, 4096
  buffer_load_dwordx4 a[148:151], v110, s[8:11], s101 offen offset:0 sc1
  v_mfma_f32_16x16x32_f16 v[24:27], v[48:51], v[80:83], v[24:27]
  v_mfma_f32_16x16x32_f16 v[28:31], v[48:51], v[84:87], v[28:31]
  buffer_load_dwordx4 a[152:155], v110, s[8:11], s101 offen offset:1024 sc1
  v_mfma_f32_16x16x32_f16 v[32:35], v[48:51], v[88:91], v[32:35]
  s_waitcnt lgkmcnt(14)
  v_mfma_f32_16x16x32_f16 v[36:39], v[48:51], v[92:95], v[36:39]
  ds_read_b64 v[48:49], v104 offset:1408
  ds_read_b64 v[50:51], v104 offset:1416
  v_mfma_f32_16x16x32_f16 v[12:15], v[44:47], v[72:75], v[12:15]
  buffer_load_dwordx4 a[156:159], v110, s[8:11], s101 offen offset:2048 sc1
  v_mfma_f32_16x16x32_f16 v[16:19], v[44:47], v[76:79], v[16:19]
  v_mfma_f32_16x16x32_f16 v[20:23], v[44:47], v[80:83], v[20:23]
  buffer_load_dwordx4 a[160:163], v110, s[8:11], s101 offen offset:3072 sc1
  v_mfma_f32_16x16x32_f16 v[24:27], v[44:47], v[84:87], v[24:27]
  v_mfma_f32_16x16x32_f16 v[28:31], v[44:47], v[88:91], v[28:31]
  s_add_u32 s101, s101, 4096
  buffer_load_dwordx4 a[164:167], v110, s[8:11], s101 offen offset:0 sc1
  v_mfma_f32_16x16x32_f16 v[32:35], v[44:47], v[92:95], v[32:35]
  s_waitcnt lgkmcnt(15)
  v_mfma_f32_16x16x32_f16 v[36:39], v[44:47], v[96:99], v[36:39]
  ds_read_b64 v[44:45], v104 offset:896
  ds_read_b64 v[46:47], v104 offset:904
  s_waitcnt lgkmcnt(14)
  v_mfma_f32_16x16x32_f16 v[8:11], v[40:43], v[72:75], v[8:11]
  ds_read_b128 v[72:75], v105 offset:3968
  v_mfma_f32_16x16x32_f16 v[12:15], v[40:43], v[76:79], v[12:15]
  ds_read_b128 v[76:79], v105 offset:3456
  v_mfma_f32_16x16x32_f16 v[16:19], v[40:43], v[80:83], v[16:19]
  ds_read_b128 v[80:83], v105 offset:2944
  v_mfma_f32_16x16x32_f16 v[20:23], v[40:43], v[84:87], v[20:23]
  ds_read_b128 v[84:87], v105 offset:2432
  v_mfma_f32_16x16x32_f16 v[24:27], v[40:43], v[88:91], v[24:27]
  ds_read_b128 v[88:91], v105 offset:1920
  v_mfma_f32_16x16x32_f16 v[28:31], v[40:43], v[92:95], v[28:31]
  ds_read_b128 v[92:95], v105 offset:1408
  v_mfma_f32_16x16x32_f16 v[32:35], v[40:43], v[96:99], v[32:35]
  ds_read_b128 v[96:99], v105 offset:896
  v_mfma_f32_16x16x32_f16 v[36:39], v[40:43], v[100:103], v[36:39]
  ds_read_b128 v[100:103], v105 offset:384
  ds_read_b64 v[40:41], v104 offset:384
  ds_read_b64 v[42:43], v104 offset:392
  buffer_load_dword v6, v4, s[8:11], 0 offen sc1
  s_waitcnt lgkmcnt(9)
  v_mfma_f32_16x16x32_f16 v[36:39], v[68:71], v[72:75], v[36:39]
  ds_read_b64 v[68:69], v104 offset:4032
  ds_read_b64 v[70:71], v104 offset:4040
  v_mfma_f32_16x16x32_f16 v[32:35], v[64:67], v[72:75], v[32:35]
  buffer_load_dwordx4 a[168:171], v110, s[8:11], s101 offen offset:1024 sc1
  s_waitcnt lgkmcnt(10)
  v_mfma_f32_16x16x32_f16 v[36:39], v[64:67], v[76:79], v[36:39]
  ds_read_b64 v[64:65], v104 offset:3520
  ds_read_b64 v[66:67], v104 offset:3528
  v_mfma_f32_16x16x32_f16 v[28:31], v[60:63], v[72:75], v[28:31]
  v_mfma_f32_16x16x32_f16 v[32:35], v[60:63], v[76:79], v[32:35]
  buffer_load_dwordx4 a[172:175], v110, s[8:11], s101 offen offset:2048 sc1
  s_waitcnt lgkmcnt(11)
  v_mfma_f32_16x16x32_f16 v[36:39], v[60:63], v[80:83], v[36:39]
  ds_read_b64 v[60:61], v104 offset:3008
  ds_read_b64 v[62:63], v104 offset:3016
  v_mfma_f32_16x16x32_f16 v[24:27], v[56:59], v[72:75], v[24:27]
  v_mfma_f32_16x16x32_f16 v[28:31], v[56:59], v[76:79], v[28:31]
  buffer_load_dwordx4 a[176:179], v110, s[8:11], s101 offen offset:3072 sc1
  v_mfma_f32_16x16x32_f16 v[32:35], v[56:59], v[80:83], v[32:35]
  s_waitcnt lgkmcnt(12)
  v_mfma_f32_16x16x32_f16 v[36:39], v[56:59], v[84:87], v[36:39]
  ds_read_b64 v[56:57], v104 offset:2496
  ds_read_b64 v[58:59], v104 offset:2504
  v_mfma_f32_16x16x32_f16 v[20:23], v[52:55], v[72:75], v[20:23]
  s_add_u32 s101, s101, 4096
  buffer_load_dwordx4 a[180:183], v110, s[8:11], s101 offen offset:0 sc1
  v_mfma_f32_16x16x32_f16 v[24:27], v[52:55], v[76:79], v[24:27]
  v_mfma_f32_16x16x32_f16 v[28:31], v[52:55], v[80:83], v[28:31]
  buffer_load_dwordx4 a[184:187], v110, s[8:11], s101 offen offset:1024 sc1
  v_mfma_f32_16x16x32_f16 v[32:35], v[52:55], v[84:87], v[32:35]
  s_waitcnt lgkmcnt(13)
  v_mfma_f32_16x16x32_f16 v[36:39], v[52:55], v[88:91], v[36:39]
  ds_read_b64 v[52:53], v104 offset:1984
  ds_read_b64 v[54:55], v104 offset:1992
  v_mfma_f32_16x16x32_f16 v[16:19], v[48:51], v[72:75], v[16:19]
  buffer_load_dwordx4 a[188:191], v110, s[8:11], s101 offen offset:2048 sc1
  v_mfma_f32_16x16x32_f16 v[20:23], v[48:51], v[76:79], v[20:23]
  v_mfma_f32_16x16x32_f16 v[24:27], v[48:51], v[80:83], v[24:27]
  buffer_load_dwordx4 a[192:195], v110, s[8:11], s101 offen offset:3072 sc1
  v_mfma_f32_16x16x32_f16 v[28:31], v[48:51], v[84:87], v[28:31]
  v_mfma_f32_16x16x32_f16 v[32:35], v[48:51], v[88:91], v[32:35]
  s_add_u32 s101, s101, 4096
  buffer_load_dwordx4 a[196:199], v110, s[8:11], s101 offen offset:0 sc1
  s_waitcnt lgkmcnt(14)
  v_mfma_f32_16x16x32_f16 v[36:39], v[48:51], v[92:95], v[36:39]
  ds_read_b64 v[48:49], v104 offset:1472
  ds_read_b64 v[50:51], v104 offset:1480
  v_mfma_f32_16x16x32_f16 v[12:15], v[44:47], v[72:75], v[12:15]
  v_mfma_f32_16x16x32_f16 v[16:19], v[44:47], v[76:79], v[16:19]
  v_mfma_f32_16x16x32_f16 v[20:23], v[44:47], v[80:83], v[20:23]
  v_mfma_f32_16x16x32_f16 v[24:27], v[44:47], v[84:87], v[24:27]
  v_mfma_f32_16x16x32_f16 v[28:31], v[44:47], v[88:91], v[28:31]
  v_mfma_f32_16x16x32_f16 v[32:35], v[44:47], v[92:95], v[32:35]
  s_waitcnt lgkmcnt(15)
  v_mfma_f32_16x16x32_f16 v[36:39], v[44:47], v[96:99], v[36:39]
  ds_read_b64 v[44:45], v104 offset:960
  ds_read_b64 v[46:47], v104 offset:968
  s_waitcnt lgkmcnt(14)
  v_mfma_f32_16x16x32_f16 v[8:11], v[40:43], v[72:75], v[8:11]
  ds_read_b128 v[72:75], v105 offset:4032
  v_mfma_f32_16x16x32_f16 v[12:15], v[40:43], v[76:79], v[12:15]
  ds_read_b128 v[76:79], v105 offset:3520
  v_mfma_f32_16x16x32_f16 v[16:19], v[40:43], v[80:83], v[16:19]
  ds_read_b128 v[80:83], v105 offset:3008
  v_mfma_f32_16x16x32_f16 v[20:23], v[40:43], v[84:87], v[20:23]
  ds_read_b128 v[84:87], v105 offset:2496
  v_mfma_f32_16x16x32_f16 v[24:27], v[40:43], v[88:91], v[24:27]
  ds_read_b128 v[88:91], v105 offset:1984
  v_mfma_f32_16x16x32_f16 v[28:31], v[40:43], v[92:95], v[28:31]
  ds_read_b128 v[92:95], v105 offset:1472
  v_mfma_f32_16x16x32_f16 v[32:35], v[40:43], v[96:99], v[32:35]
  ds_read_b128 v[96:99], v105 offset:960
  v_mfma_f32_16x16x32_f16 v[36:39], v[40:43], v[100:103], v[36:39]
  ds_read_b128 v[100:103], v105 offset:448
  ds_read_b64 v[40:41], v104 offset:448
  ds_read_b64 v[42:43], v104 offset:456
  s_waitcnt lgkmcnt(9)
  v_mfma_f32_16x16x32_f16 v[36:39], v[68:71], v[72:75], v[36:39]
  v_mfma_f32_16x16x32_f16 v[32:35], v[64:67], v[72:75], v[32:35]
  s_waitcnt lgkmcnt(8)
  v_mfma_f32_16x16x32_f16 v[36:39], v[64:67], v[76:79], v[36:39]
  v_mfma_f32_16x16x32_f16 v[28:31], v[60:63], v[72:75], v[28:31]
  v_mfma_f32_16x16x32_f16 v[32:35], v[60:63], v[76:79], v[32:35]
  s_waitcnt lgkmcnt(7)
  v_mfma_f32_16x16x32_f16 v[36:39], v[60:63], v[80:83], v[36:39]
  v_mfma_f32_16x16x32_f16 v[24:27], v[56:59], v[72:75], v[24:27]
  v_mfma_f32_16x16x32_f16 v[28:31], v[56:59], v[76:79], v[28:31]
  v_mfma_f32_16x16x32_f16 v[32:35], v[56:59], v[80:83], v[32:35]
  s_waitcnt lgkmcnt(6)
  v_mfma_f32_16x16x32_f16 v[36:39], v[56:59], v[84:87], v[36:39]
  v_mfma_f32_16x16x32_f16 v[20:23], v[52:55], v[72:75], v[20:23]
  v_mfma_f32_16x16x32_f16 v[24:27], v[52:55], v[76:79], v[24:27]
  v_mfma_f32_16x16x32_f16 v[28:31], v[52:55], v[80:83], v[28:31]
  v_mfma_f32_16x16x32_f16 v[32:35], v[52:55], v[84:87], v[32:35]
  s_waitcnt lgkmcnt(5)
  v_mfma_f32_16x16x32_f16 v[36:39], v[52:55], v[88:91], v[36:39]
  v_mfma_f32_16x16x32_f16 v[16:19], v[48:51], v[72:75], v[16:19]
  v_mfma_f32_16x16x32_f16 v[20:23], v[48:51], v[76:79], v[20:23]
  v_mfma_f32_16x16x32_f16 v[24:27], v[48:51], v[80:83], v[24:27]
  v_mfma_f32_16x16x32_f16 v[28:31], v[48:51], v[84:87], v[28:31]
  v_mfma_f32_16x16x32_f16 v[32:35], v[48:51], v[88:91], v[32:35]
  s_waitcnt lgkmcnt(4)
  v_mfma_f32_16x16x32_f16 v[36:39], v[48:51], v[92:95], v[36:39]
  v_mfma_f32_16x16x32_f16 v[12:15], v[44:47], v[72:75], v[12:15]
  v_mfma_f32_16x16x32_f16 v[16:19], v[44:47], v[76:79], v[16:19]
  v_mfma_f32_16x16x32_f16 v[20:23], v[44:47], v[80:83], v[20:23]
  v_mfma_f32_16x16x32_f16 v[24:27], v[44:47], v[84:87], v[24:27]
  v_mfma_f32_16x16x32_f16 v[28:31], v[44:47], v[88:91], v[28:31]
  v_mfma_f32_16x16x32_f16 v[32:35], v[44:47], v[92:95], v[32:35]
  s_waitcnt lgkmcnt(3)
  v_mfma_f32_16x16x32_f16 v[36:39], v[44:47], v[96:99], v[36:39]
  s_waitcnt lgkmcnt(0)
  v_mfma_f32_16x16x32_f16 v[8:11], v[40:43], v[72:75], v[8:11]
  v_mfma_f32_16x16x32_f16 v[12:15], v[40:43], v[76:79], v[12:15]
  v_mfma_f32_16x16x32_f16 v[16:19], v[40:43], v[80:83], v[16:19]
  v_mfma_f32_16x16x32_f16 v[20:23], v[40:43], v[84:87], v[20:23]
  v_mfma_f32_16x16x32_f16 v[24:27], v[40:43], v[88:91], v[24:27]
  v_mfma_f32_16x16x32_f16 v[28:31], v[40:43], v[92:95], v[28:31]
  v_mfma_f32_16x16x32_f16 v[32:35], v[40:43], v[96:99], v[32:35]
  v_mfma_f32_16x16x32_f16 v[36:39], v[40:43], v[100:103], v[36:39]
  ds_read_b128 v[40:43], v106 offset:0
  ds_read_b128 v[44:47], v106 offset:1024
  ds_read_b128 v[48:51], v106 offset:2048
  ds_read_b128 v[52:55], v106 offset:3072
  ds_read_b128 v[56:59], v106 offset:4096
  ds_read_b128 v[60:63], v106 offset:5120
  ds_read_b128 v[64:67], v106 offset:6144
  ds_read_b128 v[68:71], v106 offset:7168
  s_mov_b32 s44, s78
  s_mov_b32 s45, s78
  v_cmp_ne_u32 vcc, s88, v5
  s_nop 1
  s_cmp_eq_u64 vcc, 0
  s_cselect_b32 s14, 14614528, 0
  s_cselect_b32 s18, 0, 14614528
  s_mov_b32 s12, s8
  s_mov_b32 s13, s9
  s_mov_b32 s15, 0x00020000
  s_mov_b32 s16, s8
  s_mov_b32 s17, s9
  s_mov_b32 s19, 0x00020000
  s_waitcnt vmcnt(8)
  v_cmp_ne_u32 vcc, s3, v6
  s_nop 1
  s_cbranch_vccz ok_7
  s_mov_b32 s97, 0x20000
  s_branch polls_9
poll_8:
  s_sleep 4
polls_9:
  s_sub_u32 s97, s97, 1
  s_cbranch_scc1 END
  buffer_load_dword v6, v4, s[8:11], 0 offen sc1
  s_waitcnt vmcnt(0)
  v_cmp_ne_u32 vcc, s3, v6
  s_nop 1
  s_cbranch_vccnz poll_8
ok_7:
  s_waitcnt lgkmcnt(7)
  v_pk_fma_f32 v[40:41], v[8:9], s[44:45], v[40:41]
  v_pk_fma_f32 v[42:43], v[10:11], s[44:45], v[42:43]
  v_cvt_pk_bf16_f32 v72, v40, v41
  v_cvt_pk_bf16_f32 v73, v42, v43
  buffer_store_dwordx2 v[72:73], v107, s[8:11], s41 offen sc1
  s_add_u32 s41, s41, 327680
  s_waitcnt lgkmcnt(6)
  v_pk_fma_f32 v[44:45], v[12:13], s[44:45], v[44:45]
  v_pk_fma_f32 v[46:47], v[14:15], s[44:45], v[46:47]
  v_cvt_pk_bf16_f32 v74, v44, v45
  v_cvt_pk_bf16_f32 v75, v46, v47
  buffer_store_dwordx2 v[74:75], v107, s[8:11], s41 offen sc1
  s_add_u32 s41, s41, 327680
  s_waitcnt lgkmcnt(5)
  v_pk_fma_f32 v[48:49], v[16:17], s[44:45], v[48:49]
  v_pk_fma_f32 v[50:51], v[18:19], s[44:45], v[50:51]
  v_cvt_pk_bf16_f32 v76, v48, v49
  v_cvt_pk_bf16_f32 v77, v50, v51
  buffer_store_dwordx2 v[76:77], v107, s[8:11], s41 offen sc1
  s_add_u32 s41, s41, 327680
  s_waitcnt lgkmcnt(4)
  v_pk_fma_f32 v[52:53], v[20:21], s[44:45], v[52:53]
  v_pk_fma_f32 v[54:55], v[22:23], s[44:45], v[54:55]
  v_cvt_pk_bf16_f32 v78, v52, v53
  v_cvt_pk_bf16_f32 v79, v54, v55
  buffer_store_dwordx2 v[78:79], v107, s[8:11], s41 offen sc1
  s_add_u32 s41, s41, 327680
  s_waitcnt lgkmcnt(3)
  v_pk_fma_f32 v[56:57], v[24:25], s[44:45], v[56:57]
  v_pk_fma_f32 v[58:59], v[26:27], s[44:45], v[58:59]
  v_cvt_pk_bf16_f32 v80, v56, v57
  v_cvt_pk_bf16_f32 v81, v58, v59
  buffer_store_dwordx2 v[80:81], v107, s[8:11], s41 offen sc1
  s_add_u32 s41, s41, 327680
  s_waitcnt lgkmcnt(2)
  v_pk_fma_f32 v[60:61], v[28:29], s[44:45], v[60:61]
  v_pk_fma_f32 v[62:63], v[30:31], s[44:45], v[62:63]
  v_cvt_pk_bf16_f32 v82, v60, v61
  v_cvt_pk_bf16_f32 v83, v62, v63
  buffer_store_dwordx2 v[82:83], v107, s[8:11], s41 offen sc1
  s_add_u32 s41, s41, 327680
  s_waitcnt lgkmcnt(1)
  v_pk_fma_f32 v[64:65], v[32:33], s[44:45], v[64:65]
  v_pk_fma_f32 v[66:67], v[34:35], s[44:45], v[66:67]
  v_cvt_pk_bf16_f32 v84, v64, v65
  v_cvt_pk_bf16_f32 v85, v66, v67
  buffer_store_dwordx2 v[84:85], v107, s[8:11], s41 offen sc1
  s_add_u32 s41, s41, 327680
  s_waitcnt lgkmcnt(0)
  v_pk_fma_f32 v[68:69], v[36:37], s[44:45], v[68:69]
  v_pk_fma_f32 v[70:71], v[38:39], s[44:45], v[70:71]
  v_cvt_pk_bf16_f32 v86, v68, v69
  v_cvt_pk_bf16_f32 v87, v70, v71
  buffer_store_dwordx2 v[86:87], v107, s[8:11], s41 offen sc1
  s_branch merge_3
pre_2:
  s_lshr_b32 s100, s5, 1
  s_lshl_b32 s100, s100, 3
  s_add_u32 s100, s100, s4
  s_lshr_b32 s46, s100, 6
  s_cmp_lg_u32 s46, 0
  s_cselect_b32 s24, s82, s80
  s_cselect_b32 s25, s83, s81
  s_cselect_b32 s47, 819200, 0
  s_add_u32 s47, s47, 9043968
  s_mov_b32 s26, 819200
  s_mov_b32 s27, 0x00020000
  s_mov_b32 s28, s86
  s_mov_b32 s29, s87
  s_mov_b32 s30, 1966080
  s_mov_b32 s31, 0x00020000
  v_add_u32 v2, 0, v0
  v_mul_u32_u24 v3, 205, v2
  v_lshrrev_b32 v3, 11, v3
  v_mul_u32_u24 v4, 10, v3
  v_sub_u32 v4, v2, v4
  v_lshlrev_b32 v4, 4, v4
  v_mul_u32_u24 v3, 1280, v3
  v_add_u32 v10, v3, v4
  v_add_u32 v2, 64, v0
  v_mul_u32_u24 v3, 205, v2
  v_lshrrev_b32 v3, 11, v3
  v_mul_u32_u24 v4, 10, v3
  v_sub_u32 v4, v2, v4
  v_lshlrev_b32 v4, 4, v4
  v_mul_u32_u24 v3, 1280, v3
  v_add_u32 v11, v3, v4
  v_add_u32 v2, 128, v0
  v_mul_u32_u24 v3, 205, v2
  v_lshrrev_b32 v3, 11, v3
  v_mul_u32_u24 v4, 10, v3
  v_sub_u32 v4, v2, v4
  v_lshlrev_b32 v4, 4, v4
  v_mul_u32_u24 v3, 1280, v3
  v_add_u32 v12, v3, v4
  v_add_u32 v2, 192, v0
  v_mul_u32_u24 v3, 205, v2
  v_lshrrev_b32 v3, 11, v3
  v_mul_u32_u24 v4, 10, v3
  v_sub_u32 v4, v2, v4
  v_lshlrev_b32 v4, 4, v4
  v_mul_u32_u24 v3, 1280, v3
  v_add_u32 v13, v3, v4
  v_add_u32 v2, 256, v0
  v_mul_u32_u24 v3, 205, v2
  v_lshrrev_b32 v3, 11, v3
  v_mul_u32_u24 v4, 10, v3
  v_sub_u32 v4, v2, v4
  v_lshlrev_b32 v4, 4, v4
  v_mul_u32_u24 v3, 1280, v3
  v_add_u32 v14, v3, v4
  s_lshr_b32 s40, s100, 1
  s_and_b32 s40, s40, 31
  s_and_b32 s41, s100, 1
  s_mul_i32 s42, s40, 25600
  s_add_u32 s47, s47, s42
  s_mul_i32 s42, s41, 10240
  s_add_u32 s47, s47, s42
  s_and_b32 s42, s40, 3
  s_mul_i32 s42, s42, 204800
  s_mul_i32 s41, s41, 81920
  s_add_u32 s42, s42, s41
  s_lshr_b32 s40, s40, 2
  s_and_b32 s45, s40, 1
  s_mul_i32 s40, s40, 160
  s_add_u32 s40, s40, s42
  s_lshr_b32 s41, s100, 4
  s_mul_i32 s41, s41, 160
  s_and_b32 s42, s100, 15
  s_mul_i32 s42, s42, 122880
  s_add_u32 s41, s41, s42
  s_mov_b32 m0, 32928
  s_nop 0
  buffer_load_dwordx4 v10, s[24:27], s40 offen lds
  s_mov_b32 m0, 33952
  s_nop 0
  buffer_load_dwordx4 v11, s[24:27], s40 offen lds
  s_mov_b32 m0, 34976
  s_nop 0
  buffer_load_dwordx4 v12, s[24:27], s40 offen lds
  s_mov_b32 m0, 36000
  s_nop 0
  buffer_load_dwordx4 v13, s[24:27], s40 offen lds
  s_mov_b32 m0, 37024
  s_nop 0
  buffer_load_dwordx4 v14, s[24:27], s40 offen lds
  s_mov_b32 m0, 38048
  s_add_u32 s40, s40, 40960
  buffer_load_dwordx4 v10, s[24:27], s40 offen lds
  s_mov_b32 m0, 39072
  s_nop 0
  buffer_load_dwordx4 v11, s[24:27], s40 offen lds
  s_mov_b32 m0, 40096
  s_nop 0
  buffer_load_dwordx4 v12, s[24:27], s40 offen lds
  s_mov_b32 m0, 41120
  s_nop 0
  buffer_load_dwordx4 v13, s[24:27], s40 offen lds
  s_mov_b32 m0, 42144
  s_nop 0
  buffer_load_dwordx4 v14, s[24:27], s40 offen lds
  s_mov_b32 m0, 43168
  s_add_u32 s40, s40, 40960
  buffer_load_dwordx4 v10, s[24:27], s40 offen lds
  s_mov_b32 m0, 44192
  s_nop 0
  buffer_load_dwordx4 v11, s[24:27], s40 offen lds
  s_mov_b32 m0, 45216
  s_nop 0
  buffer_load_dwordx4 v12, s[24:27], s40 offen lds
  s_mov_b32 m0, 46240
  s_nop 0
  buffer_load_dwordx4 v13, s[24:27], s40 offen lds
  s_mov_b32 m0, 47264
  s_nop 0
  buffer_load_dwordx4 v14, s[24:27], s40 offen lds
  s_waitcnt lgkmcnt(0)
  s_mul_i32 s3, s3, 1664525
  s_add_u32 s3, s3, 1013904223
  s_xor_b32 s88, s88, s3
  v_lshrrev_b32 v2, 4, v0
  v_lshrrev_b32 v3, 2, v0
  v_and_b32 v3, 3, v3
  v_and_b32 v4, 3, v0
  v_lshlrev_b32 v2, 2, v2
  v_add_u32 v2, v2, v3
  v_mul_u32_u24 v2, 160, v2
  v_add_u32 v2, 32928, v2
  v_mul_u32_u24 v3, 40, v4
  v_add_u32 v3, v2, v3
  v_add_u32 v20, 0, v3
  v_add_u32 v25, 66640, v3
  v_add_u32 v21, 8, v3
  v_add_u32 v26, 66648, v3
  v_add_u32 v22, 16, v3
  v_add_u32 v27, 66656, v3
  v_add_u32 v23, 24, v3
  v_add_u32 v28, 66664, v3
  v_add_u32 v24, 32, v3
  v_add_u32 v29, 66672, v3
  s_cmp_lg_u32 s46, 0
  s_cbranch_scc1 w1map_10
  v_lshlrev_b32 v4, 3, v4
  v_add_u32 v2, v2, v4
  s_lshl_b32 s43, s45, 5
  v_add_u32 v3, s43, v2
  v_add_u32 v20, 0, v3
  v_add_u32 v21, 32, v3
  v_add_u32 v22, 64, v3
  v_add_u32 v23, 96, v3
  s_lshl_b32 s43, s45, 7
  s_sub_u32 s43, 128, s43
  v_add_u32 v24, s43, v2
w1map_10:
  v_and_b32 v16, 1, v0
  v_lshlrev_b32 v16, 7, v16
  v_and_b32 v17, 2, v0
  v_lshlrev_b32 v17, 12, v17
  v_add_u32 v16, v16, v17
  v_mov_b32 v17, s89
  v_lshlrev_b32 v17, 8, v17
  v_add_u32 v16, 393216, v16
  v_add_u32 v16, v17, v16
  v_and_b32 v18, 7, v0
  v_lshlrev_b32 v18, 7, v18
  s_lshl_b32 s7, s98, 10
  s_add_u32 s7, s7, 4096
  v_add_u32 v18, s7, v18
  v_and_b32 v30, 31, v0
  v_min_u32 v30, 19, v30
  v_lshlrev_b32 v30, 7, v30
  v_mov_b32 v31, s89
  v_mul_u32_u24 v31, 2560, v31
  v_add_u32 v30, 425984, v30
  v_add_u32 v30, v31, v30
  s_waitcnt vmcnt(0)
  ds_read_b64_tr_b16 v[32:33], v20 offset:0
  ds_read_b64_tr_b16 v[34:35], v20 offset:2560
  ds_read_b64_tr_b16 v[36:37], v21 offset:0
  ds_read_b64_tr_b16 v[38:39], v21 offset:2560
  ds_read_b64_tr_b16 v[40:41], v22 offset:0
  ds_read_b64_tr_b16 v[42:43], v22 offset:2560
  ds_read_b64_tr_b16 v[44:45], v23 offset:0
  ds_read_b64_tr_b16 v[46:47], v23 offset:2560
  ds_read_b64_tr_b16 v[48:49], v24 offset:0
  ds_read_b64_tr_b16 v[50:51], v24 offset:2560
  s_waitcnt lgkmcnt(8)
  buffer_store_dwordx4 v[32:35], v110, s[8:11], s47 offen offset:0 sc1
  ds_read_b64_tr_b16 v[52:53], v20 offset:5120
  ds_read_b64_tr_b16 v[54:55], v20 offset:7680
  s_waitcnt lgkmcnt(8)
  buffer_store_dwordx4 v[36:39], v110, s[8:11], s47 offen offset:1024 sc1
  ds_read_b64_tr_b16 v[56:57], v21 offset:5120
  ds_read_b64_tr_b16 v[58:59], v21 offset:7680
  s_waitcnt lgkmcnt(8)
  buffer_store_dwordx4 v[40:43], v110, s[8:11], s47 offen offset:2048 sc1
  ds_read_b64_tr_b16 v[60:61], v22 offset:5120
  ds_read_b64_tr_b16 v[62:63], v22 offset:7680
  s_waitcnt lgkmcnt(8)
  buffer_store_dwordx4 v[44:47], v110, s[8:11], s47 offen offset:3072 sc1
  ds_read_b64_tr_b16 v[64:65], v23 offset:5120
  ds_read_b64_tr_b16 v[66:67], v23 offset:7680
  s_waitcnt lgkmcnt(8)
  s_add_u32 s47, s47, 4096
  buffer_store_dwordx4 v[48:51], v110, s[8:11], s47 offen offset:0 sc1
  ds_read_b64_tr_b16 v[68:69], v24 offset:5120
  ds_read_b64_tr_b16 v[70:71], v24 offset:7680
  s_waitcnt lgkmcnt(8)
  buffer_store_dwordx4 v[52:55], v110, s[8:11], s47 offen offset:1024 sc1
  ds_read_b64_tr_b16 v[72:73], v20 offset:10240
  ds_read_b64_tr_b16 v[74:75], v20 offset:12800
  s_waitcnt lgkmcnt(8)
  buffer_store_dwordx4 v[56:59], v110, s[8:11], s47 offen offset:2048 sc1
  ds_read_b64_tr_b16 v[76:77], v21 offset:10240
  ds_read_b64_tr_b16 v[78:79], v21 offset:12800
  s_waitcnt lgkmcnt(8)
  buffer_store_dwordx4 v[60:63], v110, s[8:11], s47 offen offset:3072 sc1
  ds_read_b64_tr_b16 v[80:81], v22 offset:10240
  ds_read_b64_tr_b16 v[82:83], v22 offset:12800
  s_waitcnt lgkmcnt(8)
  s_add_u32 s47, s47, 4096
  buffer_store_dwordx4 v[64:67], v110, s[8:11], s47 offen offset:0 sc1
  ds_read_b64_tr_b16 v[84:85], v23 offset:10240
  ds_read_b64_tr_b16 v[86:87], v23 offset:12800
  s_waitcnt lgkmcnt(8)
  buffer_store_dwordx4 v[68:71], v110, s[8:11], s47 offen offset:1024 sc1
  ds_read_b64_tr_b16 v[88:89], v24 offset:10240
  ds_read_b64_tr_b16 v[90:91], v24 offset:12800
  s_waitcnt lgkmcnt(8)
  buffer_store_dwordx4 v[72:75], v110, s[8:11], s47 offen offset:2048 sc1
  s_waitcnt lgkmcnt(6)
  buffer_store_dwordx4 v[76:79], v110, s[8:11], s47 offen offset:3072 sc1
  s_waitcnt lgkmcnt(4)
  s_add_u32 s47, s47, 4096
  buffer_store_dwordx4 v[80:83], v110, s[8:11], s47 offen offset:0 sc1
  s_waitcnt lgkmcnt(2)
  buffer_store_dwordx4 v[84:87], v110, s[8:11], s47 offen offset:1024 sc1
  s_waitcnt lgkmcnt(0)
  buffer_store_dwordx4 v[88:91], v110, s[8:11], s47 offen offset:2048 sc1
  s_lshl_b32 s40, s100, 7
  s_add_u32 s44, s40, 409600
  s_add_u32 s40, s40, 393216
  s_mul_i32 s47, s100, 15360
  s_add_u32 s47, s47, 12648448
  s_waitcnt vmcnt(0)
  v_mov_b32 v2, s3
  v_mov_b32 v3, 0
  s_mov_b64 exec, 1
  buffer_store_dword v2, v3, s[8:11], s40 offen sc1
  s_mov_b64 exec, -1
  s_waitcnt lgkmcnt(0)
  s_barrier
  s_mov_b32 m0, 99568
  s_nop 0
  buffer_load_dwordx4 v10, s[28:31], s41 offen lds
  s_mov_b32 m0, 100592
  s_nop 0
  buffer_load_dwordx4 v11, s[28:31], s41 offen lds
  s_mov_b32 m0, 101616
  s_nop 0
  buffer_load_dwordx4 v12, s[28:31], s41 offen lds
  s_mov_b32 m0, 102640
  s_nop 0
  buffer_load_dwordx4 v13, s[28:31], s41 offen lds
  s_mov_b32 m0, 103664
  s_nop 0
  buffer_load_dwordx4 v14, s[28:31], s41 offen lds
  s_mov_b32 m0, 104688
  s_add_u32 s41, s41, 40960
  buffer_load_dwordx4 v10, s[28:31], s41 offen lds
  s_mov_b32 m0, 105712
  s_nop 0
  buffer_load_dwordx4 v11, s[28:31], s41 offen lds
  s_mov_b32 m0, 106736
  s_nop 0
  buffer_load_dwordx4 v12, s[28:31], s41 offen lds
  s_mov_b32 m0, 107760
  s_nop 0
  buffer_load_dwordx4 v13, s[28:31], s41 offen lds
  s_mov_b32 m0, 108784
  s_nop 0
  buffer_load_dwordx4 v14, s[28:31], s41 offen lds
  s_mov_b32 m0, 109808
  s_add_u32 s41, s41, 40960
  buffer_load_dwordx4 v10, s[28:31], s41 offen lds
  s_mov_b32 m0, 110832
  s_nop 0
  buffer_load_dwordx4 v11, s[28:31], s41 offen lds
  s_mov_b32 m0, 111856
  s_nop 0
  buffer_load_dwordx4 v12, s[28:31], s41 offen lds
  s_mov_b32 m0, 112880
  s_nop 0
  buffer_load_dwordx4 v13, s[28:31], s41 offen lds
  s_mov_b32 m0, 113904
  s_nop 0
  buffer_load_dwordx4 v14, s[28:31], s41 offen lds
  buffer_load_dword v9, v16, s[8:11], 0 offen sc1
  buffer_load_dword v7, v18, s[8:11], 0 offen sc1
  s_waitcnt vmcnt(2)
  ds_read_b64_tr_b16 v[32:33], v25 offset:0
  ds_read_b64_tr_b16 v[34:35], v25 offset:2560
  ds_read_b64_tr_b16 v[36:37], v26 offset:0
  ds_read_b64_tr_b16 v[38:39], v26 offset:2560
  ds_read_b64_tr_b16 v[40:41], v27 offset:0
  ds_read_b64_tr_b16 v[42:43], v27 offset:2560
  ds_read_b64_tr_b16 v[44:45], v28 offset:0
  ds_read_b64_tr_b16 v[46:47], v28 offset:2560
  ds_read_b64_tr_b16 v[48:49], v29 offset:0
  ds_read_b64_tr_b16 v[50:51], v29 offset:2560
  s_waitcnt lgkmcnt(8)
  buffer_store_dwordx4 v[32:35], v110, s[8:11], s47 offen offset:0 sc1
  ds_read_b64_tr_b16 v[52:53], v25 offset:7680
  ds_read_b64_tr_b16 v[54:55], v25 offset:10240
  s_waitcnt lgkmcnt(8)
  buffer_store_dwordx4 v[36:39], v110, s[8:11], s47 offen offset:1024 sc1
  ds_read_b64_tr_b16 v[56:57], v26 offset:7680
  ds_read_b64_tr_b16 v[58:59], v26 offset:10240
  s_waitcnt lgkmcnt(8)
  buffer_store_dwordx4 v[40:43], v110, s[8:11], s47 offen offset:2048 sc1
  ds_read_b64_tr_b16 v[60:61], v27 offset:7680
  ds_read_b64_tr_b16 v[62:63], v27 offset:10240
  s_waitcnt lgkmcnt(8)
  buffer_store_dwordx4 v[44:47], v110, s[8:11], s47 offen offset:3072 sc1
  ds_read_b64_tr_b16 v[64:65], v28 offset:7680
  ds_read_b64_tr_b16 v[66:67], v28 offset:10240
  s_waitcnt lgkmcnt(8)
  s_add_u32 s47, s47, 4096
  buffer_store_dwordx4 v[48:51], v110, s[8:11], s47 offen offset:0 sc1
  ds_read_b64_tr_b16 v[68:69], v29 offset:7680
  ds_read_b64_tr_b16 v[70:71], v29 offset:10240
  s_waitcnt lgkmcnt(8)
  buffer_store_dwordx4 v[52:55], v110, s[8:11], s47 offen offset:1024 sc1
  ds_read_b64_tr_b16 v[72:73], v25 offset:5120
  ds_read_b64_tr_b16 v[74:75], v25 offset:12800
  s_waitcnt lgkmcnt(8)
  buffer_store_dwordx4 v[56:59], v110, s[8:11], s47 offen offset:2048 sc1
  ds_read_b64_tr_b16 v[76:77], v26 offset:5120
  ds_read_b64_tr_b16 v[78:79], v26 offset:12800
  s_waitcnt lgkmcnt(8)
  buffer_store_dwordx4 v[60:63], v110, s[8:11], s47 offen offset:3072 sc1
  ds_read_b64_tr_b16 v[80:81], v27 offset:5120
  ds_read_b64_tr_b16 v[82:83], v27 offset:12800
  s_waitcnt lgkmcnt(8)
  s_add_u32 s47, s47, 4096
  buffer_store_dwordx4 v[64:67], v110, s[8:11], s47 offen offset:0 sc1
  ds_read_b64_tr_b16 v[84:85], v28 offset:5120
  ds_read_b64_tr_b16 v[86:87], v28 offset:12800
  s_waitcnt lgkmcnt(8)
  buffer_store_dwordx4 v[68:71], v110, s[8:11], s47 offen offset:1024 sc1
  ds_read_b64_tr_b16 v[88:89], v29 offset:5120
  ds_read_b64_tr_b16 v[90:91], v29 offset:12800
  s_waitcnt lgkmcnt(8)
  buffer_store_dwordx4 v[72:75], v110, s[8:11], s47 offen offset:2048 sc1
  s_waitcnt lgkmcnt(6)
  buffer_store_dwordx4 v[76:79], v110, s[8:11], s47 offen offset:3072 sc1
  s_waitcnt lgkmcnt(4)
  s_add_u32 s47, s47, 4096
  buffer_store_dwordx4 v[80:83], v110, s[8:11], s47 offen offset:0 sc1
  s_waitcnt lgkmcnt(2)
  buffer_store_dwordx4 v[84:87], v110, s[8:11], s47 offen offset:1024 sc1
  s_waitcnt lgkmcnt(0)
  buffer_store_dwordx4 v[88:91], v110, s[8:11], s47 offen offset:2048 sc1
  s_waitcnt vmcnt(16)
  v_cmp_ne_u32 vcc, s3, v9
  s_nop 1
  s_cbranch_vccz ok_11
  s_mov_b32 s97, 0x20000
  s_branch polls_13
poll_12:
  s_sleep 4
polls_13:
  s_sub_u32 s97, s97, 1
  s_cbranch_scc1 END
  buffer_load_dword v9, v16, s[8:11], 0 offen sc1
  s_waitcnt vmcnt(0)
  v_cmp_ne_u32 vcc, s3, v9
  s_nop 1
  s_cbranch_vccnz poll_12
ok_11:
  s_mul_i32 s100, s89, 25600
  s_add_u32 s101, s100, 9863168
  s_add_u32 s100, s100, 9043968
  buffer_load_dwordx4 a[0:3], v110, s[8:11], s100 offen offset:0 sc1
  buffer_load_dwordx4 a[4:7], v110, s[8:11], s100 offen offset:1024 sc1
  buffer_load_dwordx4 a[8:11], v110, s[8:11], s100 offen offset:2048 sc1
  buffer_load_dwordx4 a[12:15], v110, s[8:11], s100 offen offset:3072 sc1
  s_add_u32 s100, s100, 4096
  buffer_load_dwordx4 a[16:19], v110, s[8:11], s100 offen offset:0 sc1
  buffer_load_dwordx4 a[20:23], v110, s[8:11], s100 offen offset:1024 sc1
  buffer_load_dwordx4 a[24:27], v110, s[8:11], s100 offen offset:2048 sc1
  buffer_load_dwordx4 a[28:31], v110, s[8:11], s100 offen offset:3072 sc1
  s_add_u32 s100, s100, 4096
  buffer_load_dwordx4 a[32:35], v110, s[8:11], s100 offen offset:0 sc1
  buffer_load_dwordx4 a[36:39], v110, s[8:11], s100 offen offset:1024 sc1
  buffer_load_dwordx4 a[40:43], v110, s[8:11], s100 offen offset:2048 sc1
  buffer_load_dwordx4 a[44:47], v110, s[8:11], s100 offen offset:3072 sc1
  s_add_u32 s100, s100, 4096
  buffer_load_dwordx4 a[48:51], v110, s[8:11], s100 offen offset:0 sc1
  buffer_load_dwordx4 a[52:55], v110, s[8:11], s100 offen offset:1024 sc1
  buffer_load_dwordx4 a[56:59], v110, s[8:11], s100 offen offset:2048 sc1
  buffer_load_dwordx4 a[60:63], v110, s[8:11], s100 offen offset:3072 sc1
  s_add_u32 s100, s100, 4096
  buffer_load_dwordx4 a[64:67], v110, s[8:11], s100 offen offset:0 sc1
  buffer_load_dwordx4 a[68:71], v110, s[8:11], s100 offen offset:1024 sc1
  buffer_load_dwordx4 a[72:75], v110, s[8:11], s100 offen offset:2048 sc1
  buffer_load_dwordx4 a[76:79], v110, s[8:11], s100 offen offset:3072 sc1
  s_add_u32 s100, s100, 4096
  buffer_load_dwordx4 a[80:83], v110, s[8:11], s100 offen offset:0 sc1
  buffer_load_dwordx4 a[84:87], v110, s[8:11], s100 offen offset:1024 sc1
  buffer_load_dwordx4 a[88:91], v110, s[8:11], s100 offen offset:2048 sc1
  buffer_load_dwordx4 a[92:95], v110, s[8:11], s100 offen offset:3072 sc1
  s_add_u32 s100, s100, 4096
  buffer_load_dwordx4 a[96:99], v110, s[8:11], s100 offen offset:0 sc1
  buffer_load_dwordx4 a[100:103], v110, s[8:11], s101 offen offset:0 sc1
  buffer_load_dwordx4 a[104:107], v110, s[8:11], s101 offen offset:1024 sc1
  buffer_load_dwordx4 a[108:111], v110, s[8:11], s101 offen offset:2048 sc1
  buffer_load_dwordx4 a[112:115], v110, s[8:11], s101 offen offset:3072 sc1
  s_add_u32 s101, s101, 4096
  buffer_load_dwordx4 a[116:119], v110, s[8:11], s101 offen offset:0 sc1
  s_waitcnt vmcnt(30)
  v_mov_b32 v2, s3
  v_mov_b32 v3, 0
  s_mov_b64 exec, 1
  buffer_store_dword v2, v3, s[8:11], s44 offen sc1
  s_mov_b64 exec, -1
  buffer_load_dword v8, v30, s[8:11], 0 offen sc1
  s_waitcnt lgkmcnt(0)
  s_barrier
  buffer_load_dwordx4 a[120:123], v110, s[8:11], s101 offen offset:1024 sc1
  buffer_load_dwordx4 a[124:127], v110, s[8:11], s101 offen offset:2048 sc1
  buffer_load_dwordx4 a[128:131], v110, s[8:11], s101 offen offset:3072 sc1
  s_add_u32 s101, s101, 4096
  buffer_load_dwordx4 a[132:135], v110, s[8:11], s101 offen offset:0 sc1
  buffer_load_dwordx4 a[136:139], v110, s[8:11], s101 offen offset:1024 sc1
  buffer_load_dwordx4 a[140:143], v110, s[8:11], s101 offen offset:2048 sc1
  buffer_load_dwordx4 a[144:147], v110, s[8:11], s101 offen offset:3072 sc1
  s_add_u32 s101, s101, 4096
  buffer_load_dwordx4 a[148:151], v110, s[8:11], s101 offen offset:0 sc1
  buffer_load_dwordx4 a[152:155], v110, s[8:11], s101 offen offset:1024 sc1
  buffer_load_dwordx4 a[156:159], v110, s[8:11], s101 offen offset:2048 sc1
  buffer_load_dwordx4 a[160:163], v110, s[8:11], s101 offen offset:3072 sc1
  s_add_u32 s101, s101, 4096
  buffer_load_dwordx4 a[164:167], v110, s[8:11], s101 offen offset:0 sc1
  buffer_load_dwordx4 a[168:171], v110, s[8:11], s101 offen offset:1024 sc1
  buffer_load_dwordx4 a[172:175], v110, s[8:11], s101 offen offset:2048 sc1
  buffer_load_dwordx4 a[176:179], v110, s[8:11], s101 offen offset:3072 sc1
  s_add_u32 s101, s101, 4096
  buffer_load_dwordx4 a[180:183], v110, s[8:11], s101 offen offset:0 sc1
  buffer_load_dwordx4 a[184:187], v110, s[8:11], s101 offen offset:1024 sc1
  buffer_load_dwordx4 a[188:191], v110, s[8:11], s101 offen offset:2048 sc1
  buffer_load_dwordx4 a[192:195], v110, s[8:11], s101 offen offset:3072 sc1
  s_add_u32 s101, s101, 4096
  buffer_load_dwordx4 a[196:199], v110, s[8:11], s101 offen offset:0 sc1
  v_cmp_ne_u32 vcc, s88, v7
  s_nop 1
  s_cmp_eq_u64 vcc, 0
  s_cselect_b32 s14, 14614528, 0
  s_cselect_b32 s18, 0, 14614528
  s_mov_b32 s12, s8
  s_mov_b32 s13, s9
  s_mov_b32 s15, 0x00020000
  s_mov_b32 s16, s8
  s_mov_b32 s17, s9
  s_mov_b32 s19, 0x00020000
  s_waitcnt vmcnt(20)
  v_cmp_ne_u32 vcc, s3, v8
  s_nop 1
  s_cbranch_vccz ok_14
  s_mov_b32 s97, 0x20000
  s_branch polls_16
poll_15:
  s_sleep 4
polls_16:
  s_sub_u32 s97, s97, 1
  s_cbranch_scc1 END
  buffer_load_dword v8, v30, s[8:11], 0 offen sc1
  s_waitcnt vmcnt(0)
  v_cmp_ne_u32 vcc, s3, v8
  s_nop 1
  s_cbranch_vccnz poll_15
ok_14:
  s_branch merge_3
ln0_1:
  s_mov_b32 s24, s64
  s_mov_b32 s25, s65
  s_mov_b32 s26, 2621440
  s_mov_b32 s27, 0x00020000
  s_mov_b32 s28, s76
  s_mov_b32 s29, s77
  s_mov_b32 s30, 1280
  s_mov_b32 s31, 0x00020000
  s_mul_i32 s40, s2, 10240
  s_mov_b32 m0, 124672
  s_nop 0
  buffer_load_dwordx4 v110, s[24:27], s40 offen offset:0 lds
  buffer_load_dwordx4 v110, s[24:27], s40 offen offset:1024 lds
  buffer_load_dwordx4 v110, s[24:27], s40 offen offset:2048 lds
  buffer_load_dwordx4 v110, s[24:27], s40 offen offset:3072 lds
  s_mov_b32 m0, 128768
  s_add_u32 s40, s40, 4096
  buffer_load_dwordx4 v110, s[24:27], s40 offen offset:0 lds
  buffer_load_dwordx4 v110, s[24:27], s40 offen offset:1024 lds
  buffer_load_dwordx4 v110, s[24:27], s40 offen offset:2048 lds
  buffer_load_dwordx4 v110, s[24:27], s40 offen offset:3072 lds
  s_mov_b32 m0, 132864
  s_add_u32 s40, s40, 4096
  buffer_load_dwordx4 v110, s[24:27], s40 offen offset:0 lds
  buffer_load_dwordx4 v110, s[24:27], s40 offen offset:1024 lds
  v_add_u32 v2, s94, v0
  v_lshlrev_b32 v2, 1, v2
  v_mov_b32 v10, 0
  buffer_load_short_d16_hi v10, v2, s[28:31], 0 offen
  s_waitcnt lgkmcnt(0)
  s_mul_i32 s3, s3, 1664525
  s_add_u32 s3, s3, 1013904223
  s_xor_b32 s88, s88, s3
  v_mov_b32 v4, 0
  v_mov_b32 v5, 0
  v_lshlrev_b32 v3, 3, v0
  v_add_u32 v3, 139008, v3
  ds_write_b64 v3, v[4:5] offset:0
  ds_write_b64 v3, v[4:5] offset:4608
  ds_write_b64 v3, v[4:5] offset:9216
  v_lshrrev_b32 v4, 3, v0
  v_mul_u32_u24 v4, 1280, v4
  v_and_b32 v5, 7, v0
  v_lshlrev_b32 v5, 4, v5
  v_add_u32 v4, v4, v5
  v_add_u32 v4, 124672, v4
  v_lshrrev_b32 v5, 2, v0
  v_and_b32 v5, 3, v5
  v_mul_u32_u24 v5, 1280, v5
  v_lshrrev_b32 v6, 4, v0
  v_lshlrev_b32 v6, 5, v6
  v_add_u32 v5, v5, v6
  v_and_b32 v6, 3, v0
  v_lshlrev_b32 v6, 3, v6
  v_add_u32 v5, v5, v6
  v_add_u32 v5, 124672, v5
  s_mov_b32 s41, 0x3f803f80
  v_lshrrev_b32 v2, 2, v0
  v_and_b32 v3, 3, v0
  v_mul_u32_u24 v104, 1280, v2
  v_add_u32 v105, s94, v3
  v_lshlrev_b32 v105, 4, v105
  v_add_u32 v104, v104, v105
  s_mul_i32 s7, s4, 326400
  v_add_u32 v104, s7, v104
  v_add_u32 v152, 0, v0
  v_mul_u32_u24 v6, 205, v152
  v_lshrrev_b32 v6, 14, v6
  v_mul_u32_u24 v6, 326400, v6
  v_lshl_add_u32 v152, v152, 4, v6
  v_add_u32 v153, 64, v0
  v_mul_u32_u24 v6, 205, v153
  v_lshrrev_b32 v6, 14, v6
  v_mul_u32_u24 v6, 326400, v6
  v_lshl_add_u32 v153, v153, 4, v6
  v_add_u32 v154, 128, v0
  v_mul_u32_u24 v6, 205, v154
  v_lshrrev_b32 v6, 14, v6
  v_mul_u32_u24 v6, 326400, v6
  v_lshl_add_u32 v154, v154, 4, v6
  v_add_u32 v155, 192, v0
  v_mul_u32_u24 v6, 205, v155
  v_lshrrev_b32 v6, 14, v6
  v_mul_u32_u24 v6, 326400, v6
  v_lshl_add_u32 v155, v155, 4, v6
  v_add_u32 v156, 256, v0
  v_mul_u32_u24 v6, 205, v156
  v_lshrrev_b32 v6, 14, v6
  v_mul_u32_u24 v6, 326400, v6
  v_lshl_add_u32 v156, v156, 4, v6
  v_add_u32 v157, 320, v0
  v_mul_u32_u24 v6, 205, v157
  v_lshrrev_b32 v6, 14, v6
  v_mul_u32_u24 v6, 326400, v6
  v_lshl_add_u32 v157, v157, 4, v6
  v_add_u32 v158, 384, v0
  v_mul_u32_u24 v6, 205, v158
  v_lshrrev_b32 v6, 14, v6
  v_mul_u32_u24 v6, 326400, v6
  v_lshl_add_u32 v158, v158, 4, v6
  v_add_u32 v159, 448, v0
  v_mul_u32_u24 v6, 205, v159
  v_lshrrev_b32 v6, 14, v6
  v_mul_u32_u24 v6, 326400, v6
  v_lshl_add_u32 v159, v159, 4, v6
  v_add_u32 v160, 512, v0
  v_mul_u32_u24 v6, 205, v160
  v_lshrrev_b32 v6, 14, v6
  v_mul_u32_u24 v6, 326400, v6
  v_lshl_add_u32 v160, v160, 4, v6
  v_add_u32 v161, 576, v0
  v_mul_u32_u24 v6, 205, v161
  v_lshrrev_b32 v6, 14, v6
  v_mul_u32_u24 v6, 326400, v6
  v_lshl_add_u32 v161, v161, 4, v6
  v_mul_u32_u24 v105, 4608, v3
  v_lshlrev_b32 v2, 4, v2
  v_add_u32 v105, 135152, v105
  v_sub_u32 v105, v105, v2
  v_cmp_gt_u32 s[100:101], s95, v3
  v_lshlrev_b32 v107, 7, v0
  v_and_b32 v108, 1, v0
  v_lshlrev_b32 v108, 7, v108
  v_and_b32 v109, 2, v0
  v_lshlrev_b32 v109, 12, v109
  v_add_u32 v108, v108, v109
  v_mov_b32 v109, s89
  v_lshlrev_b32 v109, 8, v109
  v_add_u32 v108, 393216, v108
  v_add_u32 v108, v109, v108
  s_waitcnt vmcnt(1)
  ds_read_b128 v[20:23], v4 offset:0
  ds_read_b128 v[24:27], v4 offset:128
  ds_read_b128 v[28:31], v4 offset:256
  ds_read_b128 v[32:35], v4 offset:384
  ds_read_b128 v[36:39], v4 offset:512
  ds_read_b128 v[40:43], v4 offset:640
  ds_read_b128 v[44:47], v4 offset:768
  ds_read_b128 v[48:51], v4 offset:896
  ds_read_b128 v[52:55], v4 offset:1024
  ds_read_b128 v[56:59], v4 offset:1152
  ds_read_b64_tr_b16 v[60:61], v5 offset:0
  ds_read_b64_tr_b16 v[62:63], v5 offset:5120
  ds_read_b64_tr_b16 v[64:65], v5 offset:128
  ds_read_b64_tr_b16 v[66:67], v5 offset:5248
  ds_read_b64_tr_b16 v[68:69], v5 offset:256
  ds_read_b64_tr_b16 v[70:71], v5 offset:5376
  v_mov_b32 v6, 0
  v_mov_b32 v7, 0
  v_mov_b32 v8, 0
  v_mov_b32 v9, 0
  s_waitcnt lgkmcnt(15)
  v_dot2_f32_bf16 v6, v20, s41, v6
  v_dot2_f32_bf16 v8, v20, v20, v8
  v_dot2_f32_bf16 v7, v21, s41, v7
  v_dot2_f32_bf16 v9, v21, v21, v9
  v_dot2_f32_bf16 v6, v22, s41, v6
  v_dot2_f32_bf16 v8, v22, v22, v8
  v_dot2_f32_bf16 v7, v23, s41, v7
  v_dot2_f32_bf16 v9, v23, v23, v9
  ds_read_b64_tr_b16 v[72:73], v5 offset:384
  ds_read_b64_tr_b16 v[74:75], v5 offset:5504
  s_waitcnt lgkmcnt(15)
  v_dot2_f32_bf16 v6, v24, s41, v6
  v_dot2_f32_bf16 v8, v24, v24, v8
  v_dot2_f32_bf16 v7, v25, s41, v7
  v_dot2_f32_bf16 v9, v25, v25, v9
  v_dot2_f32_bf16 v6, v26, s41, v6
  v_dot2_f32_bf16 v8, v26, v26, v8
  v_dot2_f32_bf16 v7, v27, s41, v7
  v_dot2_f32_bf16 v9, v27, v27, v9
  ds_read_b64_tr_b16 v[76:77], v5 offset:512
  ds_read_b64_tr_b16 v[78:79], v5 offset:5632
  v_dot2_f32_bf16 v6, v28, s41, v6
  v_dot2_f32_bf16 v8, v28, v28, v8
  v_dot2_f32_bf16 v7, v29, s41, v7
  v_dot2_f32_bf16 v9, v29, v29, v9
  v_dot2_f32_bf16 v6, v30, s41, v6
  v_dot2_f32_bf16 v8, v30, v30, v8
  v_dot2_f32_bf16 v7, v31, s41, v7
  v_dot2_f32_bf16 v9, v31, v31, v9
  ds_read_b64_tr_b16 v[80:81], v5 offset:640
  ds_read_b64_tr_b16 v[82:83], v5 offset:5760
  s_waitcnt lgkmcnt(15)
  v_dot2_f32_bf16 v6, v32, s41, v6
  v_dot2_f32_bf16 v8, v32, v32, v8
  v_dot2_f32_bf16 v7, v33, s41, v7
  v_dot2_f32_bf16 v9, v33, v33, v9
  v_dot2_f32_bf16 v6, v34, s41, v6
  v_dot2_f32_bf16 v8, v34, v34, v8
  v_dot2_f32_bf16 v7, v35, s41, v7
  v_dot2_f32_bf16 v9, v35, v35, v9
  ds_read_b64_tr_b16 v[84:85], v5 offset:768
  ds_read_b64_tr_b16 v[86:87], v5 offset:5888
  v_dot2_f32_bf16 v6, v36, s41, v6
  v_dot2_f32_bf16 v8, v36, v36, v8
  v_dot2_f32_bf16 v7, v37, s41, v7
  v_dot2_f32_bf16 v9, v37, v37, v9
  v_dot2_f32_bf16 v6, v38, s41, v6
  v_dot2_f32_bf16 v8, v38, v38, v8
  v_dot2_f32_bf16 v7, v39, s41, v7
  v_dot2_f32_bf16 v9, v39, v39, v9
  ds_read_b64_tr_b16 v[88:89], v5 offset:896
  ds_read_b64_tr_b16 v[90:91], v5 offset:6016
  v_dot2_f32_bf16 v6, v40, s41, v6
  v_dot2_f32_bf16 v8, v40, v40, v8
  v_dot2_f32_bf16 v7, v41, s41, v7
  v_dot2_f32_bf16 v9, v41, v41, v9
  v_dot2_f32_bf16 v6, v42, s41, v6
  v_dot2_f32_bf16 v8, v42, v42, v8
  v_dot2_f32_bf16 v7, v43, s41, v7
  v_dot2_f32_bf16 v9, v43, v43, v9
  ds_read_b64_tr_b16 v[92:93], v5 offset:1024
  ds_read_b64_tr_b16 v[94:95], v5 offset:6144
  v_dot2_f32_bf16 v6, v44, s41, v6
  v_dot2_f32_bf16 v8, v44, v44, v8
  v_dot2_f32_bf16 v7, v45, s41, v7
  v_dot2_f32_bf16 v9, v45, v45, v9
  v_dot2_f32_bf16 v6, v46, s41, v6
  v_dot2_f32_bf16 v8, v46, v46, v8
  v_dot2_f32_bf16 v7, v47, s41, v7
  v_dot2_f32_bf16 v9, v47, v47, v9
  ds_read_b64_tr_b16 v[96:97], v5 offset:1152
  ds_read_b64_tr_b16 v[98:99], v5 offset:6272
  s_waitcnt lgkmcnt(15)
  v_dot2_f32_bf16 v6, v48, s41, v6
  v_dot2_f32_bf16 v8, v48, v48, v8
  v_dot2_f32_bf16 v7, v49, s41, v7
  v_dot2_f32_bf16 v9, v49, v49, v9
  v_dot2_f32_bf16 v6, v50, s41, v6
  v_dot2_f32_bf16 v8, v50, v50, v8
  v_dot2_f32_bf16 v7, v51, s41, v7
  v_dot2_f32_bf16 v9, v51, v51, v9
  v_dot2_f32_bf16 v6, v52, s41, v6
  v_dot2_f32_bf16 v8, v52, v52, v8
  v_dot2_f32_bf16 v7, v53, s41, v7
  v_dot2_f32_bf16 v9, v53, v53, v9
  v_dot2_f32_bf16 v6, v54, s41, v6
  v_dot2_f32_bf16 v8, v54, v54, v8
  v_dot2_f32_bf16 v7, v55, s41, v7
  v_dot2_f32_bf16 v9, v55, v55, v9
  v_dot2_f32_bf16 v6, v56, s41, v6
  v_dot2_f32_bf16 v8, v56, v56, v8
  v_dot2_f32_bf16 v7, v57, s41, v7
  v_dot2_f32_bf16 v9, v57, v57, v9
  v_dot2_f32_bf16 v6, v58, s41, v6
  v_dot2_f32_bf16 v8, v58, v58, v8
  v_dot2_f32_bf16 v7, v59, s41, v7
  v_dot2_f32_bf16 v9, v59, v59, v9
  s_nop 1
  v_add_f32 v6, v6, v7
  v_add_f32 v8, v8, v9
  s_nop 0
  v_add_f32_dpp v6, v6, v6 quad_perm:[1,0,3,2] row_mask:0xf bank_mask:0xf
  v_add_f32_dpp v8, v8, v8 quad_perm:[1,0,3,2] row_mask:0xf bank_mask:0xf
  s_nop 0
  v_add_f32_dpp v6, v6, v6 quad_perm:[2,3,0,1] row_mask:0xf bank_mask:0xf
  v_add_f32_dpp v8, v8, v8 quad_perm:[2,3,0,1] row_mask:0xf bank_mask:0xf
  s_nop 0
  v_add_f32_dpp v6, v6, v6 row_half_mirror row_mask:0xf bank_mask:0xf
  v_add_f32_dpp v8, v8, v8 row_half_mirror row_mask:0xf bank_mask:0xf
  s_mov_b32 s42, 0x3acccccd
  v_mul_f32 v6, s42, v6
  v_mul_f32 v8, s42, v8
  v_fma_f32 v8, -v6, v6, v8
  v_max_f32 v8, 0, v8
  v_cvt_pk_bf16_f32 v6, v6, v6
  v_lshlrev_b32 v6, 16, v6
  v_cvt_pk_bf16_f32 v8, v8, v8
  v_lshlrev_b32 v8, 16, v8
  v_add_f32 v8, 0x3727c5ac, v8
  v_cvt_pk_bf16_f32 v8, v8, v8
  v_lshlrev_b32 v8, 16, v8
  v_sqrt_f32 v8, v8
  s_nop 0
  v_cvt_pk_bf16_f32 v11, v6, v8
  v_and_b32 v8, 0xffff0000, v11
  v_rcp_f32 v8, v8
  s_nop 0
  v_mul_f32 v6, v6, v8
  v_sub_f32 v6, 0, v6
  v_lshrrev_b32 v7, 3, v0
  v_lshlrev_b32 v7, 2, v7
  v_add_u32 v9, 157952, v7
  ds_write_b32 v9, v8
  ds_write_b32 v9, v6 offset:32
  v_mov_b32 v9, 157952
  ds_read_b128 v[20:23], v9 offset:0
  ds_read_b128 v[24:27], v9 offset:16
  ds_read_b128 v[28:31], v9 offset:32
  ds_read_b128 v[32:35], v9 offset:48
  s_mul_i32 s42, s2, 1280
  s_add_u32 s42, s42, 524288
  s_lshl_b32 s43, s2, 5
  s_add_u32 s43, s43, 507904
  s_mov_b32 s44, 0xffff0000
  s_mov_b32 exec_lo, 0x01010101
  s_mov_b32 exec_hi, 0x01010101
  buffer_store_dword v11, v7, s[8:11], s43 offen sc1
  s_mov_b64 exec, -1
  s_waitcnt lgkmcnt(0)
  v_lshlrev_b32 v36, 16, v60
  v_and_b32 v37, s44, v60
  v_lshlrev_b32 v38, 16, v61
  v_and_b32 v39, s44, v61
  v_lshlrev_b32 v40, 16, v62
  v_and_b32 v41, s44, v62
  v_lshlrev_b32 v42, 16, v63
  v_and_b32 v43, s44, v63
  v_pk_fma_f32 v[36:37], v[36:37], v[20:21], v[28:29]
  v_pk_fma_f32 v[38:39], v[38:39], v[22:23], v[30:31]
  v_pk_fma_f32 v[40:41], v[40:41], v[24:25], v[32:33]
  v_pk_fma_f32 v[42:43], v[42:43], v[26:27], v[34:35]
  v_cvt_pk_f16_f32 v112, v43, v42
  v_cvt_pk_f16_f32 v113, v41, v40
  v_cvt_pk_f16_f32 v114, v39, v38
  v_cvt_pk_f16_f32 v115, v37, v36
  buffer_store_dwordx4 v[112:115], v152, s[8:11], s42 offen sc1
  v_lshlrev_b32 v44, 16, v64
  v_and_b32 v45, s44, v64
  v_lshlrev_b32 v46, 16, v65
  v_and_b32 v47, s44, v65
  v_lshlrev_b32 v48, 16, v66
  v_and_b32 v49, s44, v66
  v_lshlrev_b32 v50, 16, v67
  v_and_b32 v51, s44, v67
  v_pk_fma_f32 v[44:45], v[44:45], v[20:21], v[28:29]
  v_pk_fma_f32 v[46:47], v[46:47], v[22:23], v[30:31]
  v_pk_fma_f32 v[48:49], v[48:49], v[24:25], v[32:33]
  v_pk_fma_f32 v[50:51], v[50:51], v[26:27], v[34:35]
  v_cvt_pk_f16_f32 v116, v51, v50
  v_cvt_pk_f16_f32 v117, v49, v48
  v_cvt_pk_f16_f32 v118, v47, v46
  v_cvt_pk_f16_f32 v119, v45, v44
  buffer_store_dwordx4 v[116:119], v153, s[8:11], s42 offen sc1
  v_lshlrev_b32 v36, 16, v68
  v_and_b32 v37, s44, v68
  v_lshlrev_b32 v38, 16, v69
  v_and_b32 v39, s44, v69
  v_lshlrev_b32 v40, 16, v70
  v_and_b32 v41, s44, v70
  v_lshlrev_b32 v42, 16, v71
  v_and_b32 v43, s44, v71
  v_pk_fma_f32 v[36:37], v[36:37], v[20:21], v[28:29]
  v_pk_fma_f32 v[38:39], v[38:39], v[22:23], v[30:31]
  v_pk_fma_f32 v[40:41], v[40:41], v[24:25], v[32:33]
  v_pk_fma_f32 v[42:43], v[42:43], v[26:27], v[34:35]
  v_cvt_pk_f16_f32 v120, v43, v42
  v_cvt_pk_f16_f32 v121, v41, v40
  v_cvt_pk_f16_f32 v122, v39, v38
  v_cvt_pk_f16_f32 v123, v37, v36
  buffer_store_dwordx4 v[120:123], v154, s[8:11], s42 offen sc1
  v_lshlrev_b32 v44, 16, v72
  v_and_b32 v45, s44, v72
  v_lshlrev_b32 v46, 16, v73
  v_and_b32 v47, s44, v73
  v_lshlrev_b32 v48, 16, v74
  v_and_b32 v49, s44, v74
  v_lshlrev_b32 v50, 16, v75
  v_and_b32 v51, s44, v75
  v_pk_fma_f32 v[44:45], v[44:45], v[20:21], v[28:29]
  v_pk_fma_f32 v[46:47], v[46:47], v[22:23], v[30:31]
  v_pk_fma_f32 v[48:49], v[48:49], v[24:25], v[32:33]
  v_pk_fma_f32 v[50:51], v[50:51], v[26:27], v[34:35]
  v_cvt_pk_f16_f32 v124, v51, v50
  v_cvt_pk_f16_f32 v125, v49, v48
  v_cvt_pk_f16_f32 v126, v47, v46
  v_cvt_pk_f16_f32 v127, v45, v44
  buffer_store_dwordx4 v[124:127], v155, s[8:11], s42 offen sc1
  v_lshlrev_b32 v36, 16, v76
  v_and_b32 v37, s44, v76
  v_lshlrev_b32 v38, 16, v77
  v_and_b32 v39, s44, v77
  v_lshlrev_b32 v40, 16, v78
  v_and_b32 v41, s44, v78
  v_lshlrev_b32 v42, 16, v79
  v_and_b32 v43, s44, v79
  v_pk_fma_f32 v[36:37], v[36:37], v[20:21], v[28:29]
  v_pk_fma_f32 v[38:39], v[38:39], v[22:23], v[30:31]
  v_pk_fma_f32 v[40:41], v[40:41], v[24:25], v[32:33]
  v_pk_fma_f32 v[42:43], v[42:43], v[26:27], v[34:35]
  v_cvt_pk_f16_f32 v128, v43, v42
  v_cvt_pk_f16_f32 v129, v41, v40
  v_cvt_pk_f16_f32 v130, v39, v38
  v_cvt_pk_f16_f32 v131, v37, v36
  buffer_store_dwordx4 v[128:131], v156, s[8:11], s42 offen sc1
  v_lshlrev_b32 v44, 16, v80
  v_and_b32 v45, s44, v80
  v_lshlrev_b32 v46, 16, v81
  v_and_b32 v47, s44, v81
  v_lshlrev_b32 v48, 16, v82
  v_and_b32 v49, s44, v82
  v_lshlrev_b32 v50, 16, v83
  v_and_b32 v51, s44, v83
  v_pk_fma_f32 v[44:45], v[44:45], v[20:21], v[28:29]
  v_pk_fma_f32 v[46:47], v[46:47], v[22:23], v[30:31]
  v_pk_fma_f32 v[48:49], v[48:49], v[24:25], v[32:33]
  v_pk_fma_f32 v[50:51], v[50:51], v[26:27], v[34:35]
  v_cvt_pk_f16_f32 v132, v51, v50
  v_cvt_pk_f16_f32 v133, v49, v48
  v_cvt_pk_f16_f32 v134, v47, v46
  v_cvt_pk_f16_f32 v135, v45, v44
  buffer_store_dwordx4 v[132:135], v157, s[8:11], s42 offen sc1
  v_lshlrev_b32 v36, 16, v84
  v_and_b32 v37, s44, v84
  v_lshlrev_b32 v38, 16, v85
  v_and_b32 v39, s44, v85
  v_lshlrev_b32 v40, 16, v86
  v_and_b32 v41, s44, v86
  v_lshlrev_b32 v42, 16, v87
  v_and_b32 v43, s44, v87
  v_pk_fma_f32 v[36:37], v[36:37], v[20:21], v[28:29]
  v_pk_fma_f32 v[38:39], v[38:39], v[22:23], v[30:31]
  v_pk_fma_f32 v[40:41], v[40:41], v[24:25], v[32:33]
  v_pk_fma_f32 v[42:43], v[42:43], v[26:27], v[34:35]
  v_cvt_pk_f16_f32 v136, v43, v42
  v_cvt_pk_f16_f32 v137, v41, v40
  v_cvt_pk_f16_f32 v138, v39, v38
  v_cvt_pk_f16_f32 v139, v37, v36
  buffer_store_dwordx4 v[136:139], v158, s[8:11], s42 offen sc1
  v_lshlrev_b32 v44, 16, v88
  v_and_b32 v45, s44, v88
  v_lshlrev_b32 v46, 16, v89
  v_and_b32 v47, s44, v89
  v_lshlrev_b32 v48, 16, v90
  v_and_b32 v49, s44, v90
  v_lshlrev_b32 v50, 16, v91
  v_and_b32 v51, s44, v91
  v_pk_fma_f32 v[44:45], v[44:45], v[20:21], v[28:29]
  v_pk_fma_f32 v[46:47], v[46:47], v[22:23], v[30:31]
  v_pk_fma_f32 v[48:49], v[48:49], v[24:25], v[32:33]
  v_pk_fma_f32 v[50:51], v[50:51], v[26:27], v[34:35]
  v_cvt_pk_f16_f32 v140, v51, v50
  v_cvt_pk_f16_f32 v141, v49, v48
  v_cvt_pk_f16_f32 v142, v47, v46
  v_cvt_pk_f16_f32 v143, v45, v44
  buffer_store_dwordx4 v[140:143], v159, s[8:11], s42 offen sc1
  v_lshlrev_b32 v36, 16, v92
  v_and_b32 v37, s44, v92
  v_lshlrev_b32 v38, 16, v93
  v_and_b32 v39, s44, v93
  v_lshlrev_b32 v40, 16, v94
  v_and_b32 v41, s44, v94
  v_lshlrev_b32 v42, 16, v95
  v_and_b32 v43, s44, v95
  v_pk_fma_f32 v[36:37], v[36:37], v[20:21], v[28:29]
  v_pk_fma_f32 v[38:39], v[38:39], v[22:23], v[30:31]
  v_pk_fma_f32 v[40:41], v[40:41], v[24:25], v[32:33]
  v_pk_fma_f32 v[42:43], v[42:43], v[26:27], v[34:35]
  v_cvt_pk_f16_f32 v144, v43, v42
  v_cvt_pk_f16_f32 v145, v41, v40
  v_cvt_pk_f16_f32 v146, v39, v38
  v_cvt_pk_f16_f32 v147, v37, v36
  buffer_store_dwordx4 v[144:147], v160, s[8:11], s42 offen sc1
  v_lshlrev_b32 v44, 16, v96
  v_and_b32 v45, s44, v96
  v_lshlrev_b32 v46, 16, v97
  v_and_b32 v47, s44, v97
  v_lshlrev_b32 v48, 16, v98
  v_and_b32 v49, s44, v98
  v_lshlrev_b32 v50, 16, v99
  v_and_b32 v51, s44, v99
  v_pk_fma_f32 v[44:45], v[44:45], v[20:21], v[28:29]
  v_pk_fma_f32 v[46:47], v[46:47], v[22:23], v[30:31]
  v_pk_fma_f32 v[48:49], v[48:49], v[24:25], v[32:33]
  v_pk_fma_f32 v[50:51], v[50:51], v[26:27], v[34:35]
  v_cvt_pk_f16_f32 v148, v51, v50
  v_cvt_pk_f16_f32 v149, v49, v48
  v_cvt_pk_f16_f32 v150, v47, v46
  v_cvt_pk_f16_f32 v151, v45, v44
  buffer_store_dwordx4 v[148:151], v161, s[8:11], s42 offen sc1
  s_lshl_b32 s40, s96, 7
  s_add_u32 s40, s40, 4096
  v_mov_b32 v8, s88
  v_lshlrev_b32 v9, 15, v0
  s_mov_b32 s44, 0
  s_waitcnt vmcnt(11)
  v_readlane_b32 s45, v10, 0
  v_readlane_b32 s46, v10, 1
  v_readlane_b32 s47, v10, 2
  s_waitcnt vmcnt(0)
  s_mov_b64 exec, 0x1
  buffer_store_dword v8, v9, s[8:11], s40 offen sc1
  s_mov_b64 exec, -1
  s_add_u32 s40, s44, 4096
  s_add_u32 s41, s44, 12288
  s_add_u32 s42, s44, 20480
  s_add_u32 s43, s44, 28672
  s_mov_b32 s97, 0x20000
  s_sleep 30
  buffer_load_dword v10, v107, s[8:11], s40 offen sc1
  buffer_load_dword v11, v107, s[8:11], s41 offen sc1
  buffer_load_dword v12, v107, s[8:11], s42 offen sc1
  buffer_load_dword v13, v107, s[8:11], s43 offen sc1
  s_waitcnt vmcnt(3)
  v_xor_b32 v14, s3, v10
  v_cmp_lt_u32 s[28:29], 15, v14
  s_waitcnt vmcnt(2)
  v_xor_b32 v14, s3, v11
  v_cmp_lt_u32 s[30:31], 15, v14
  s_waitcnt vmcnt(1)
  v_xor_b32 v14, s3, v12
  v_cmp_lt_u32 s[32:33], 15, v14
  s_waitcnt vmcnt(0)
  v_xor_b32 v14, s3, v13
  v_cmp_lt_u32 s[34:35], 15, v14
  s_or_b64 vcc, s[28:29], s[30:31]
  s_or_b64 vcc, vcc, s[32:33]
  s_or_b64 vcc, vcc, s[34:35]
  s_cbranch_scc0 ppe_18
pp_17:
  s_sleep 2
  s_sub_u32 s97, s97, 1
  s_cbranch_scc1 END
  s_mov_b64 exec, s[28:29]
  buffer_load_dword v10, v107, s[8:11], s40 offen sc1
  s_mov_b64 exec, s[30:31]
  buffer_load_dword v11, v107, s[8:11], s41 offen sc1
  s_mov_b64 exec, s[32:33]
  buffer_load_dword v12, v107, s[8:11], s42 offen sc1
  s_mov_b64 exec, s[34:35]
  buffer_load_dword v13, v107, s[8:11], s43 offen sc1
  s_mov_b64 exec, -1
  s_waitcnt vmcnt(3)
  v_xor_b32 v14, s3, v10
  v_cmp_lt_u32 s[28:29], 15, v14
  s_waitcnt vmcnt(2)
  v_xor_b32 v14, s3, v11
  v_cmp_lt_u32 s[30:31], 15, v14
  s_waitcnt vmcnt(1)
  v_xor_b32 v14, s3, v12
  v_cmp_lt_u32 s[32:33], 15, v14
  s_waitcnt vmcnt(0)
  v_xor_b32 v14, s3, v13
  v_cmp_lt_u32 s[34:35], 15, v14
  s_or_b64 vcc, s[28:29], s[30:31]
  s_or_b64 vcc, vcc, s[32:33]
  s_or_b64 vcc, vcc, s[34:35]
  s_cbranch_scc1 pp_17
ppe_18:
  s_mov_b64 exec, s[100:101]
  s_mov_b32 s40, 524288
  buffer_load_dwordx4 v[20:23], v104, s[8:11], s40 offen sc1
  s_add_u32 s40, s40, 20480
  buffer_load_dwordx4 v[24:27], v104, s[8:11], s40 offen sc1
  s_add_u32 s40, s40, 20480
  buffer_load_dwordx4 v[28:31], v104, s[8:11], s40 offen sc1
  s_add_u32 s40, s40, 20480
  buffer_load_dwordx4 v[32:35], v104, s[8:11], s40 offen sc1
  s_add_u32 s40, s40, 20480
  buffer_load_dwordx4 v[36:39], v104, s[8:11], s40 offen sc1
  s_add_u32 s40, s40, 20480
  buffer_load_dwordx4 v[40:43], v104, s[8:11], s40 offen sc1
  s_add_u32 s40, s40, 20480
  buffer_load_dwordx4 v[44:47], v104, s[8:11], s40 offen sc1
  s_add_u32 s40, s40, 20480
  buffer_load_dwordx4 v[48:51], v104, s[8:11], s40 offen sc1
  s_add_u32 s40, s40, 20480
  buffer_load_dwordx4 v[52:55], v104, s[8:11], s40 offen sc1
  s_add_u32 s40, s40, 20480
  buffer_load_dwordx4 v[56:59], v104, s[8:11], s40 offen sc1
  s_add_u32 s40, s40, 20480
  buffer_load_dwordx4 v[60:63], v104, s[8:11], s40 offen sc1
  s_add_u32 s40, s40, 20480
  buffer_load_dwordx4 v[64:67], v104, s[8:11], s40 offen sc1
  s_add_u32 s40, s40, 20480
  buffer_load_dwordx4 v[68:71], v104, s[8:11], s40 offen sc1
  s_add_u32 s40, s40, 20480
  buffer_load_dwordx4 v[72:75], v104, s[8:11], s40 offen sc1
  s_add_u32 s40, s40, 20480
  buffer_load_dwordx4 v[76:79], v104, s[8:11], s40 offen sc1
  s_add_u32 s40, s40, 20480
  buffer_load_dwordx4 v[80:83], v104, s[8:11], s40 offen sc1
  s_mov_b64 exec, -1
  s_mov_b32 s40, 507904
  buffer_load_dwordx4 v[112:115], v110, s[8:11], s40 offen offset:0 sc1
  buffer_load_dwordx4 v[116:119], v110, s[8:11], s40 offen offset:1024 sc1
  buffer_load_dwordx4 v[120:123], v110, s[8:11], s40 offen offset:2048 sc1
  buffer_load_dwordx4 v[124:127], v110, s[8:11], s40 offen offset:3072 sc1
  s_add_u32 s40, s40, 4096
  buffer_load_dwordx4 v[128:131], v110, s[8:11], s40 offen offset:0 sc1
  buffer_load_dwordx4 v[132:135], v110, s[8:11], s40 offen offset:1024 sc1
  buffer_load_dwordx4 v[136:139], v110, s[8:11], s40 offen offset:2048 sc1
  buffer_load_dwordx4 v[140:143], v110, s[8:11], s40 offen offset:3072 sc1
  v_and_b32 v3, 7, v0
  v_lshlrev_b32 v3, 7, v3
  s_lshl_b32 s7, s98, 10
  s_add_u32 s7, s7, 4096
  v_add_u32 v3, s7, v3
  buffer_load_dword v7, v3, s[8:11], 0 offen sc1
  buffer_load_dword v2, v108, s[8:11], 0 offen sc1
  s_mov_b64 exec, s[100:101]
  s_waitcnt vmcnt(25)
  ds_write_b128 v105, v[20:23] offset:3840
  s_waitcnt vmcnt(24)
  ds_write_b128 v105, v[24:27] offset:3584
  s_waitcnt vmcnt(23)
  ds_write_b128 v105, v[28:31] offset:3328
  s_waitcnt vmcnt(22)
  ds_write_b128 v105, v[32:35] offset:3072
  s_waitcnt vmcnt(21)
  ds_write_b128 v105, v[36:39] offset:2816
  s_waitcnt vmcnt(20)
  ds_write_b128 v105, v[40:43] offset:2560
  s_waitcnt vmcnt(19)
  ds_write_b128 v105, v[44:47] offset:2304
  s_waitcnt vmcnt(18)
  ds_write_b128 v105, v[48:51] offset:2048
  s_waitcnt vmcnt(17)
  ds_write_b128 v105, v[52:55] offset:1792
  s_waitcnt vmcnt(16)
  ds_write_b128 v105, v[56:59] offset:1536
  s_waitcnt vmcnt(15)
  ds_write_b128 v105, v[60:63] offset:1280
  s_waitcnt vmcnt(14)
  ds_write_b128 v105, v[64:67] offset:1024
  s_waitcnt vmcnt(13)
  ds_write_b128 v105, v[68:71] offset:768
  s_waitcnt vmcnt(12)
  ds_write_b128 v105, v[72:75] offset:512
  s_waitcnt vmcnt(11)
  ds_write_b128 v105, v[76:79] offset:256
  s_waitcnt vmcnt(10)
  ds_write_b128 v105, v[80:83] offset:0
  s_mov_b64 exec, -1
  v_and_b32 v8, 31, v0
  v_min_u32 v8, 19, v8
  v_lshlrev_b32 v8, 7, v8
  v_mov_b32 v9, s89
  v_mul_u32_u24 v9, 2560, v9
  v_add_u32 v8, 425984, v8
  v_add_u32 v8, v9, v8
  v_lshlrev_b32 v3, 7, v0
  v_lshlrev_b32 v5, 3, v0
  v_sub_u32 v5, 135416, v5
  v_add_u32 v6, 0, v110
  s_waitcnt lgkmcnt(0)
  s_barrier
  s_waitcnt vmcnt(0)
  v_cmp_ne_u32 vcc, s3, v2
  s_nop 1
  s_cbranch_vccz ok_19
  s_mov_b32 s97, 0x20000
  s_branch polls_21
poll_20:
  s_sleep 4
polls_21:
  s_sub_u32 s97, s97, 1
  s_cbranch_scc1 END
  buffer_load_dword v2, v108, s[8:11], 0 offen sc1
  s_waitcnt vmcnt(0)
  v_cmp_ne_u32 vcc, s3, v2
  s_nop 1
  s_cbranch_vccnz poll_20
ok_19:
  v_cmp_ne_u32 vcc, s88, v7
  s_nop 1
  s_cmp_eq_u64 vcc, 0
  s_cselect_b32 s14, 14614528, 0
  s_cselect_b32 s18, 0, 14614528
  s_mov_b32 s12, s8
  s_mov_b32 s13, s9
  s_mov_b32 s15, 0x00020000
  s_mov_b32 s16, s8
  s_mov_b32 s17, s9
  s_mov_b32 s19, 0x00020000
  s_lshl_b32 s42, s98, 12
  s_lshl_b32 s43, s99, 7
  s_add_u32 s42, s42, s43
  s_add_u32 s42, s42, 5767168
  s_lshl_b32 s43, s96, 7
  s_add_u32 s43, s43, -32768
  v_lshlrev_b32 v7, 10, v0
  v_add_u32 v7, s42, v7
  s_mov_b64 exec, 0x70
  v_lshlrev_b32 v7, 15, v0
  v_add_u32 v7, s43, v7
  s_mov_b64 exec, 0x7f
  buffer_load_dword v10, v7, s[12:15], 0 offen sc1
  s_mov_b64 exec, -1
  ds_read_b64 v[20:21], v5 offset:3584
  ds_read_b64 v[22:23], v5 offset:8192
  ds_read_b64 v[24:25], v5 offset:12800
  ds_read_b64 v[26:27], v5 offset:3072
  v_and_b32 v32, 0xffff0000, v112
  v_lshlrev_b32 v36, 16, v112
  v_and_b32 v33, 0xffff0000, v113
  v_lshlrev_b32 v37, 16, v113
  v_and_b32 v34, 0xffff0000, v114
  v_lshlrev_b32 v38, 16, v114
  v_and_b32 v35, 0xffff0000, v115
  v_lshlrev_b32 v39, 16, v115
  v_add_f32 v48, s45, v32
  v_add_f32 v49, s45, v33
  v_add_f32 v50, s45, v34
  v_add_f32 v51, s45, v35
  s_mul_i32 s100, s89, 25600
  s_add_u32 s101, s100, 9863168
  s_add_u32 s100, s100, 9043968
  buffer_load_dwordx4 a[0:3], v110, s[8:11], s100 offen offset:0 sc1
  s_waitcnt lgkmcnt(3)
  v_fma_mix_f32 v48, v21, v48, v36 op_sel:[1,0,0] op_sel_hi:[1,0,0]
  v_fma_mix_f32 v49, v21, v49, v37 op_sel:[0,0,0] op_sel_hi:[1,0,0]
  v_fma_mix_f32 v50, v20, v50, v38 op_sel:[1,0,0] op_sel_hi:[1,0,0]
  v_fma_mix_f32 v51, v20, v51, v39 op_sel:[0,0,0] op_sel_hi:[1,0,0]
  ds_read_b64 v[28:29], v5 offset:7680
  ds_write_b128 v6, v[48:51] offset:0
  buffer_load_dwordx4 a[4:7], v110, s[8:11], s100 offen offset:1024 sc1
  v_add_f32 v52, s46, v32
  v_add_f32 v53, s46, v33
  v_add_f32 v54, s46, v34
  v_add_f32 v55, s46, v35
  buffer_load_dwordx4 a[8:11], v110, s[8:11], s100 offen offset:2048 sc1
  s_waitcnt lgkmcnt(4)
  v_fma_mix_f32 v52, v23, v52, v36 op_sel:[1,0,0] op_sel_hi:[1,0,0]
  v_fma_mix_f32 v53, v23, v53, v37 op_sel:[0,0,0] op_sel_hi:[1,0,0]
  v_fma_mix_f32 v54, v22, v54, v38 op_sel:[1,0,0] op_sel_hi:[1,0,0]
  v_fma_mix_f32 v55, v22, v55, v39 op_sel:[0,0,0] op_sel_hi:[1,0,0]
  ds_read_b64 v[30:31], v5 offset:12288
  ds_write_b128 v6, v[52:55] offset:8192
  buffer_load_dwordx4 a[12:15], v110, s[8:11], s100 offen offset:3072 sc1
  v_add_f32 v56, s47, v32
  v_add_f32 v57, s47, v33
  v_add_f32 v58, s47, v34
  v_add_f32 v59, s47, v35
  s_add_u32 s100, s100, 4096
  buffer_load_dwordx4 a[16:19], v110, s[8:11], s100 offen offset:0 sc1
  s_waitcnt lgkmcnt(5)
  v_fma_mix_f32 v56, v25, v56, v36 op_sel:[1,0,0] op_sel_hi:[1,0,0]
  v_fma_mix_f32 v57, v25, v57, v37 op_sel:[0,0,0] op_sel_hi:[1,0,0]
  v_fma_mix_f32 v58, v24, v58, v38 op_sel:[1,0,0] op_sel_hi:[1,0,0]
  v_fma_mix_f32 v59, v24, v59, v39 op_sel:[0,0,0] op_sel_hi:[1,0,0]
  ds_read_b64 v[20:21], v5 offset:2560
  ds_write_b128 v6, v[56:59] offset:16384
  buffer_load_dwordx4 a[20:23], v110, s[8:11], s100 offen offset:1024 sc1
  v_and_b32 v40, 0xffff0000, v116
  v_lshlrev_b32 v44, 16, v116
  v_and_b32 v41, 0xffff0000, v117
  v_lshlrev_b32 v45, 16, v117
  v_and_b32 v42, 0xffff0000, v118
  v_lshlrev_b32 v46, 16, v118
  v_and_b32 v43, 0xffff0000, v119
  v_lshlrev_b32 v47, 16, v119
  v_add_f32 v60, s45, v40
  v_add_f32 v61, s45, v41
  v_add_f32 v62, s45, v42
  v_add_f32 v63, s45, v43
  buffer_load_dwordx4 a[24:27], v110, s[8:11], s100 offen offset:2048 sc1
  s_waitcnt lgkmcnt(6)
  v_fma_mix_f32 v60, v27, v60, v44 op_sel:[1,0,0] op_sel_hi:[1,0,0]
  v_fma_mix_f32 v61, v27, v61, v45 op_sel:[0,0,0] op_sel_hi:[1,0,0]
  v_fma_mix_f32 v62, v26, v62, v46 op_sel:[1,0,0] op_sel_hi:[1,0,0]
  v_fma_mix_f32 v63, v26, v63, v47 op_sel:[0,0,0] op_sel_hi:[1,0,0]
  ds_read_b64 v[22:23], v5 offset:7168
  ds_write_b128 v6, v[60:63] offset:1024
  buffer_load_dwordx4 a[28:31], v110, s[8:11], s100 offen offset:3072 sc1
  v_add_f32 v48, s46, v40
  v_add_f32 v49, s46, v41
  v_add_f32 v50, s46, v42
  v_add_f32 v51, s46, v43
  s_add_u32 s100, s100, 4096
  buffer_load_dwordx4 a[32:35], v110, s[8:11], s100 offen offset:0 sc1
  s_waitcnt lgkmcnt(7)
  v_fma_mix_f32 v48, v29, v48, v44 op_sel:[1,0,0] op_sel_hi:[1,0,0]
  v_fma_mix_f32 v49, v29, v49, v45 op_sel:[0,0,0] op_sel_hi:[1,0,0]
  v_fma_mix_f32 v50, v28, v50, v46 op_sel:[1,0,0] op_sel_hi:[1,0,0]
  v_fma_mix_f32 v51, v28, v51, v47 op_sel:[0,0,0] op_sel_hi:[1,0,0]
  ds_read_b64 v[24:25], v5 offset:11776
  ds_write_b128 v6, v[48:51] offset:9216
  buffer_load_dwordx4 a[36:39], v110, s[8:11], s100 offen offset:1024 sc1
  v_add_f32 v52, s47, v40
  v_add_f32 v53, s47, v41
  v_add_f32 v54, s47, v42
  v_add_f32 v55, s47, v43
  buffer_load_dwordx4 a[40:43], v110, s[8:11], s100 offen offset:2048 sc1
  s_waitcnt lgkmcnt(7)
  v_fma_mix_f32 v52, v31, v52, v44 op_sel:[1,0,0] op_sel_hi:[1,0,0]
  v_fma_mix_f32 v53, v31, v53, v45 op_sel:[0,0,0] op_sel_hi:[1,0,0]
  v_fma_mix_f32 v54, v30, v54, v46 op_sel:[1,0,0] op_sel_hi:[1,0,0]
  v_fma_mix_f32 v55, v30, v55, v47 op_sel:[0,0,0] op_sel_hi:[1,0,0]
  ds_read_b64 v[26:27], v5 offset:2048
  ds_write_b128 v6, v[52:55] offset:17408
  buffer_load_dwordx4 a[44:47], v110, s[8:11], s100 offen offset:3072 sc1
  v_and_b32 v32, 0xffff0000, v120
  v_lshlrev_b32 v36, 16, v120
  v_and_b32 v33, 0xffff0000, v121
  v_lshlrev_b32 v37, 16, v121
  v_and_b32 v34, 0xffff0000, v122
  v_lshlrev_b32 v38, 16, v122
  v_and_b32 v35, 0xffff0000, v123
  v_lshlrev_b32 v39, 16, v123
  v_add_f32 v56, s45, v32
  v_add_f32 v57, s45, v33
  v_add_f32 v58, s45, v34
  v_add_f32 v59, s45, v35
  s_add_u32 s100, s100, 4096
  buffer_load_dwordx4 a[48:51], v110, s[8:11], s100 offen offset:0 sc1
  s_waitcnt lgkmcnt(7)
  v_fma_mix_f32 v56, v21, v56, v36 op_sel:[1,0,0] op_sel_hi:[1,0,0]
  v_fma_mix_f32 v57, v21, v57, v37 op_sel:[0,0,0] op_sel_hi:[1,0,0]
  v_fma_mix_f32 v58, v20, v58, v38 op_sel:[1,0,0] op_sel_hi:[1,0,0]
  v_fma_mix_f32 v59, v20, v59, v39 op_sel:[0,0,0] op_sel_hi:[1,0,0]
  ds_read_b64 v[28:29], v5 offset:6656
  ds_write_b128 v6, v[56:59] offset:2048
  buffer_load_dwordx4 a[52:55], v110, s[8:11], s100 offen offset:1024 sc1
  v_add_f32 v60, s46, v32
  v_add_f32 v61, s46, v33
  v_add_f32 v62, s46, v34
  v_add_f32 v63, s46, v35
  buffer_load_dwordx4 a[56:59], v110, s[8:11], s100 offen offset:2048 sc1
  s_waitcnt lgkmcnt(7)
  v_fma_mix_f32 v60, v23, v60, v36 op_sel:[1,0,0] op_sel_hi:[1,0,0]
  v_fma_mix_f32 v61, v23, v61, v37 op_sel:[0,0,0] op_sel_hi:[1,0,0]
  v_fma_mix_f32 v62, v22, v62, v38 op_sel:[1,0,0] op_sel_hi:[1,0,0]
  v_fma_mix_f32 v63, v22, v63, v39 op_sel:[0,0,0] op_sel_hi:[1,0,0]
  ds_read_b64 v[30:31], v5 offset:11264
  ds_write_b128 v6, v[60:63] offset:10240
  buffer_load_dwordx4 a[60:63], v110, s[8:11], s100 offen offset:3072 sc1
  v_add_f32 v48, s47, v32
  v_add_f32 v49, s47, v33
  v_add_f32 v50, s47, v34
  v_add_f32 v51, s47, v35
  s_add_u32 s100, s100, 4096
  buffer_load_dwordx4 a[64:67], v110, s[8:11], s100 offen offset:0 sc1
  s_waitcnt lgkmcnt(7)
  v_fma_mix_f32 v48, v25, v48, v36 op_sel:[1,0,0] op_sel_hi:[1,0,0]
  v_fma_mix_f32 v49, v25, v49, v37 op_sel:[0,0,0] op_sel_hi:[1,0,0]
  v_fma_mix_f32 v50, v24, v50, v38 op_sel:[1,0,0] op_sel_hi:[1,0,0]
  v_fma_mix_f32 v51, v24, v51, v39 op_sel:[0,0,0] op_sel_hi:[1,0,0]
  ds_read_b64 v[20:21], v5 offset:1536
  ds_write_b128 v6, v[48:51] offset:18432
  buffer_load_dwordx4 a[68:71], v110, s[8:11], s100 offen offset:1024 sc1
  v_and_b32 v40, 0xffff0000, v124
  v_lshlrev_b32 v44, 16, v124
  v_and_b32 v41, 0xffff0000, v125
  v_lshlrev_b32 v45, 16, v125
  v_and_b32 v42, 0xffff0000, v126
  v_lshlrev_b32 v46, 16, v126
  v_and_b32 v43, 0xffff0000, v127
  v_lshlrev_b32 v47, 16, v127
  v_add_f32 v52, s45, v40
  v_add_f32 v53, s45, v41
  v_add_f32 v54, s45, v42
  v_add_f32 v55, s45, v43
  buffer_load_dwordx4 a[72:75], v110, s[8:11], s100 offen offset:2048 sc1
  s_waitcnt lgkmcnt(7)
  v_fma_mix_f32 v52, v27, v52, v44 op_sel:[1,0,0] op_sel_hi:[1,0,0]
  v_fma_mix_f32 v53, v27, v53, v45 op_sel:[0,0,0] op_sel_hi:[1,0,0]
  v_fma_mix_f32 v54, v26, v54, v46 op_sel:[1,0,0] op_sel_hi:[1,0,0]
  v_fma_mix_f32 v55, v26, v55, v47 op_sel:[0,0,0] op_sel_hi:[1,0,0]
  ds_read_b64 v[22:23], v5 offset:6144
  ds_write_b128 v6, v[52:55] offset:3072
  buffer_load_dwordx4 a[76:79], v110, s[8:11], s100 offen offset:3072 sc1
  v_add_f32 v56, s46, v40
  v_add_f32 v57, s46, v41
  v_add_f32 v58, s46, v42
  v_add_f32 v59, s46, v43
  s_add_u32 s100, s100, 4096
  buffer_load_dwordx4 a[80:83], v110, s[8:11], s100 offen offset:0 sc1
  s_waitcnt lgkmcnt(7)
  v_fma_mix_f32 v56, v29, v56, v44 op_sel:[1,0,0] op_sel_hi:[1,0,0]
  v_fma_mix_f32 v57, v29, v57, v45 op_sel:[0,0,0] op_sel_hi:[1,0,0]
  v_fma_mix_f32 v58, v28, v58, v46 op_sel:[1,0,0] op_sel_hi:[1,0,0]
  v_fma_mix_f32 v59, v28, v59, v47 op_sel:[0,0,0] op_sel_hi:[1,0,0]
  ds_read_b64 v[24:25], v5 offset:10752
  ds_write_b128 v6, v[56:59] offset:11264
  buffer_load_dwordx4 a[84:87], v110, s[8:11], s100 offen offset:1024 sc1
  v_add_f32 v60, s47, v40
  v_add_f32 v61, s47, v41
  v_add_f32 v62, s47, v42
  v_add_f32 v63, s47, v43
  buffer_load_dwordx4 a[88:91], v110, s[8:11], s100 offen offset:2048 sc1
  s_waitcnt lgkmcnt(7)
  v_fma_mix_f32 v60, v31, v60, v44 op_sel:[1,0,0] op_sel_hi:[1,0,0]
  v_fma_mix_f32 v61, v31, v61, v45 op_sel:[0,0,0] op_sel_hi:[1,0,0]
  v_fma_mix_f32 v62, v30, v62, v46 op_sel:[1,0,0] op_sel_hi:[1,0,0]
  v_fma_mix_f32 v63, v30, v63, v47 op_sel:[0,0,0] op_sel_hi:[1,0,0]
  ds_read_b64 v[26:27], v5 offset:1024
  ds_write_b128 v6, v[60:63] offset:19456
  buffer_load_dwordx4 a[92:95], v110, s[8:11], s100 offen offset:3072 sc1
  v_and_b32 v32, 0xffff0000, v128
  v_lshlrev_b32 v36, 16, v128
  v_and_b32 v33, 0xffff0000, v129
  v_lshlrev_b32 v37, 16, v129
  v_and_b32 v34, 0xffff0000, v130
  v_lshlrev_b32 v38, 16, v130
  v_and_b32 v35, 0xffff0000, v131
  v_lshlrev_b32 v39, 16, v131
  v_add_f32 v48, s45, v32
  v_add_f32 v49, s45, v33
  v_add_f32 v50, s45, v34
  v_add_f32 v51, s45, v35
  s_add_u32 s100, s100, 4096
  buffer_load_dwordx4 a[96:99], v110, s[8:11], s100 offen offset:0 sc1
  s_waitcnt lgkmcnt(7)
  v_fma_mix_f32 v48, v21, v48, v36 op_sel:[1,0,0] op_sel_hi:[1,0,0]
  v_fma_mix_f32 v49, v21, v49, v37 op_sel:[0,0,0] op_sel_hi:[1,0,0]
  v_fma_mix_f32 v50, v20, v50, v38 op_sel:[1,0,0] op_sel_hi:[1,0,0]
  v_fma_mix_f32 v51, v20, v51, v39 op_sel:[0,0,0] op_sel_hi:[1,0,0]
  ds_read_b64 v[28:29], v5 offset:5632
  ds_write_b128 v6, v[48:51] offset:4096
  buffer_load_dwordx4 a[100:103], v110, s[8:11], s101 offen offset:0 sc1
  v_add_f32 v52, s46, v32
  v_add_f32 v53, s46, v33
  v_add_f32 v54, s46, v34
  v_add_f32 v55, s46, v35
  buffer_load_dwordx4 a[104:107], v110, s[8:11], s101 offen offset:1024 sc1
  s_waitcnt lgkmcnt(7)
  v_fma_mix_f32 v52, v23, v52, v36 op_sel:[1,0,0] op_sel_hi:[1,0,0]
  v_fma_mix_f32 v53, v23, v53, v37 op_sel:[0,0,0] op_sel_hi:[1,0,0]
  v_fma_mix_f32 v54, v22, v54, v38 op_sel:[1,0,0] op_sel_hi:[1,0,0]
  v_fma_mix_f32 v55, v22, v55, v39 op_sel:[0,0,0] op_sel_hi:[1,0,0]
  ds_read_b64 v[30:31], v5 offset:10240
  ds_write_b128 v6, v[52:55] offset:12288
  buffer_load_dwordx4 a[108:111], v110, s[8:11], s101 offen offset:2048 sc1
  v_add_f32 v56, s47, v32
  v_add_f32 v57, s47, v33
  v_add_f32 v58, s47, v34
  v_add_f32 v59, s47, v35
  buffer_load_dwordx4 a[112:115], v110, s[8:11], s101 offen offset:3072 sc1
  s_waitcnt lgkmcnt(7)
  v_fma_mix_f32 v56, v25, v56, v36 op_sel:[1,0,0] op_sel_hi:[1,0,0]
  v_fma_mix_f32 v57, v25, v57, v37 op_sel:[0,0,0] op_sel_hi:[1,0,0]
  v_fma_mix_f32 v58, v24, v58, v38 op_sel:[1,0,0] op_sel_hi:[1,0,0]
  v_fma_mix_f32 v59, v24, v59, v39 op_sel:[0,0,0] op_sel_hi:[1,0,0]
  ds_read_b64 v[20:21], v5 offset:512
  ds_write_b128 v6, v[56:59] offset:20480
  s_add_u32 s101, s101, 4096
  buffer_load_dwordx4 a[116:119], v110, s[8:11], s101 offen offset:0 sc1
  v_and_b32 v40, 0xffff0000, v132
  v_lshlrev_b32 v44, 16, v132
  v_and_b32 v41, 0xffff0000, v133
  v_lshlrev_b32 v45, 16, v133
  v_and_b32 v42, 0xffff0000, v134
  v_lshlrev_b32 v46, 16, v134
  v_and_b32 v43, 0xffff0000, v135
  v_lshlrev_b32 v47, 16, v135
  v_add_f32 v60, s45, v40
  v_add_f32 v61, s45, v41
  v_add_f32 v62, s45, v42
  v_add_f32 v63, s45, v43
  buffer_load_dwordx4 a[120:123], v110, s[8:11], s101 offen offset:1024 sc1
  s_waitcnt lgkmcnt(7)
  v_fma_mix_f32 v60, v27, v60, v44 op_sel:[1,0,0] op_sel_hi:[1,0,0]
  v_fma_mix_f32 v61, v27, v61, v45 op_sel:[0,0,0] op_sel_hi:[1,0,0]
  v_fma_mix_f32 v62, v26, v62, v46 op_sel:[1,0,0] op_sel_hi:[1,0,0]
  v_fma_mix_f32 v63, v26, v63, v47 op_sel:[0,0,0] op_sel_hi:[1,0,0]
  ds_read_b64 v[22:23], v5 offset:5120
  ds_write_b128 v6, v[60:63] offset:5120
  buffer_load_dwordx4 a[124:127], v110, s[8:11], s101 offen offset:2048 sc1
  v_add_f32 v48, s46, v40
  v_add_f32 v49, s46, v41
  v_add_f32 v50, s46, v42
  v_add_f32 v51, s46, v43
  buffer_load_dwordx4 a[128:131], v110, s[8:11], s101 offen offset:3072 sc1
  s_waitcnt lgkmcnt(7)
  v_fma_mix_f32 v48, v29, v48, v44 op_sel:[1,0,0] op_sel_hi:[1,0,0]
  v_fma_mix_f32 v49, v29, v49, v45 op_sel:[0,0,0] op_sel_hi:[1,0,0]
  v_fma_mix_f32 v50, v28, v50, v46 op_sel:[1,0,0] op_sel_hi:[1,0,0]
  v_fma_mix_f32 v51, v28, v51, v47 op_sel:[0,0,0] op_sel_hi:[1,0,0]
  ds_read_b64 v[24:25], v5 offset:9728
  ds_write_b128 v6, v[48:51] offset:13312
  s_add_u32 s101, s101, 4096
  buffer_load_dwordx4 a[132:135], v110, s[8:11], s101 offen offset:0 sc1
  v_add_f32 v52, s47, v40
  v_add_f32 v53, s47, v41
  v_add_f32 v54, s47, v42
  v_add_f32 v55, s47, v43
  buffer_load_dwordx4 a[136:139], v110, s[8:11], s101 offen offset:1024 sc1
  s_waitcnt lgkmcnt(7)
  v_fma_mix_f32 v52, v31, v52, v44 op_sel:[1,0,0] op_sel_hi:[1,0,0]
  v_fma_mix_f32 v53, v31, v53, v45 op_sel:[0,0,0] op_sel_hi:[1,0,0]
  v_fma_mix_f32 v54, v30, v54, v46 op_sel:[1,0,0] op_sel_hi:[1,0,0]
  v_fma_mix_f32 v55, v30, v55, v47 op_sel:[0,0,0] op_sel_hi:[1,0,0]
  ds_read_b64 v[26:27], v5 offset:0
  ds_write_b128 v6, v[52:55] offset:21504
  buffer_load_dwordx4 a[140:143], v110, s[8:11], s101 offen offset:2048 sc1
  v_and_b32 v32, 0xffff0000, v136
  v_lshlrev_b32 v36, 16, v136
  v_and_b32 v33, 0xffff0000, v137
  v_lshlrev_b32 v37, 16, v137
  v_and_b32 v34, 0xffff0000, v138
  v_lshlrev_b32 v38, 16, v138
  v_and_b32 v35, 0xffff0000, v139
  v_lshlrev_b32 v39, 16, v139
  v_add_f32 v56, s45, v32
  v_add_f32 v57, s45, v33
  v_add_f32 v58, s45, v34
  v_add_f32 v59, s45, v35
  buffer_load_dwordx4 a[144:147], v110, s[8:11], s101 offen offset:3072 sc1
  s_waitcnt lgkmcnt(7)
  v_fma_mix_f32 v56, v21, v56, v36 op_sel:[1,0,0] op_sel_hi:[1,0,0]
  v_fma_mix_f32 v57, v21, v57, v37 op_sel:[0,0,0] op_sel_hi:[1,0,0]
  v_fma_mix_f32 v58, v20, v58, v38 op_sel:[1,0,0] op_sel_hi:[1,0,0]
  v_fma_mix_f32 v59, v20, v59, v39 op_sel:[0,0,0] op_sel_hi:[1,0,0]
  ds_read_b64 v[28:29], v5 offset:4608
  ds_write_b128 v6, v[56:59] offset:6144
  s_add_u32 s101, s101, 4096
  buffer_load_dwordx4 a[148:151], v110, s[8:11], s101 offen offset:0 sc1
  v_add_f32 v60, s46, v32
  v_add_f32 v61, s46, v33
  v_add_f32 v62, s46, v34
  v_add_f32 v63, s46, v35
  buffer_load_dwordx4 a[152:155], v110, s[8:11], s101 offen offset:1024 sc1
  s_waitcnt lgkmcnt(7)
  v_fma_mix_f32 v60, v23, v60, v36 op_sel:[1,0,0] op_sel_hi:[1,0,0]
  v_fma_mix_f32 v61, v23, v61, v37 op_sel:[0,0,0] op_sel_hi:[1,0,0]
  v_fma_mix_f32 v62, v22, v62, v38 op_sel:[1,0,0] op_sel_hi:[1,0,0]
  v_fma_mix_f32 v63, v22, v63, v39 op_sel:[0,0,0] op_sel_hi:[1,0,0]
  ds_read_b64 v[30:31], v5 offset:9216
  ds_write_b128 v6, v[60:63] offset:14336
  buffer_load_dwordx4 a[156:159], v110, s[8:11], s101 offen offset:2048 sc1
  v_add_f32 v48, s47, v32
  v_add_f32 v49, s47, v33
  v_add_f32 v50, s47, v34
  v_add_f32 v51, s47, v35
  buffer_load_dwordx4 a[160:163], v110, s[8:11], s101 offen offset:3072 sc1
  s_waitcnt lgkmcnt(7)
  v_fma_mix_f32 v48, v25, v48, v36 op_sel:[1,0,0] op_sel_hi:[1,0,0]
  v_fma_mix_f32 v49, v25, v49, v37 op_sel:[0,0,0] op_sel_hi:[1,0,0]
  v_fma_mix_f32 v50, v24, v50, v38 op_sel:[1,0,0] op_sel_hi:[1,0,0]
  v_fma_mix_f32 v51, v24, v51, v39 op_sel:[0,0,0] op_sel_hi:[1,0,0]
  ds_write_b128 v6, v[48:51] offset:22528
  s_add_u32 s101, s101, 4096
  buffer_load_dwordx4 a[164:167], v110, s[8:11], s101 offen offset:0 sc1
  v_and_b32 v40, 0xffff0000, v140
  v_lshlrev_b32 v44, 16, v140
  v_and_b32 v41, 0xffff0000, v141
  v_lshlrev_b32 v45, 16, v141
  v_and_b32 v42, 0xffff0000, v142
  v_lshlrev_b32 v46, 16, v142
  v_and_b32 v43, 0xffff0000, v143
  v_lshlrev_b32 v47, 16, v143
  v_add_f32 v52, s45, v40
  v_add_f32 v53, s45, v41
  v_add_f32 v54, s45, v42
  v_add_f32 v55, s45, v43
  buffer_load_dwordx4 a[168:171], v110, s[8:11], s101 offen offset:1024 sc1
  s_waitcnt lgkmcnt(6)
  v_fma_mix_f32 v52, v27, v52, v44 op_sel:[1,0,0] op_sel_hi:[1,0,0]
  v_fma_mix_f32 v53, v27, v53, v45 op_sel:[0,0,0] op_sel_hi:[1,0,0]
  v_fma_mix_f32 v54, v26, v54, v46 op_sel:[1,0,0] op_sel_hi:[1,0,0]
  v_fma_mix_f32 v55, v26, v55, v47 op_sel:[0,0,0] op_sel_hi:[1,0,0]
  ds_write_b128 v6, v[52:55] offset:7168
  buffer_load_dwordx4 a[172:175], v110, s[8:11], s101 offen offset:2048 sc1
  v_add_f32 v56, s46, v40
  v_add_f32 v57, s46, v41
  v_add_f32 v58, s46, v42
  v_add_f32 v59, s46, v43
  buffer_load_dwordx4 a[176:179], v110, s[8:11], s101 offen offset:3072 sc1
  s_waitcnt lgkmcnt(5)
  v_fma_mix_f32 v56, v29, v56, v44 op_sel:[1,0,0] op_sel_hi:[1,0,0]
  v_fma_mix_f32 v57, v29, v57, v45 op_sel:[0,0,0] op_sel_hi:[1,0,0]
  v_fma_mix_f32 v58, v28, v58, v46 op_sel:[1,0,0] op_sel_hi:[1,0,0]
  v_fma_mix_f32 v59, v28, v59, v47 op_sel:[0,0,0] op_sel_hi:[1,0,0]
  ds_write_b128 v6, v[56:59] offset:15360
  s_add_u32 s101, s101, 4096
  buffer_load_dwordx4 a[180:183], v110, s[8:11], s101 offen offset:0 sc1
  v_add_f32 v60, s47, v40
  v_add_f32 v61, s47, v41
  v_add_f32 v62, s47, v42
  v_add_f32 v63, s47, v43
  buffer_load_dwordx4 a[184:187], v110, s[8:11], s101 offen offset:1024 sc1
  s_waitcnt lgkmcnt(4)
  v_fma_mix_f32 v60, v31, v60, v44 op_sel:[1,0,0] op_sel_hi:[1,0,0]
  v_fma_mix_f32 v61, v31, v61, v45 op_sel:[0,0,0] op_sel_hi:[1,0,0]
  v_fma_mix_f32 v62, v30, v62, v46 op_sel:[1,0,0] op_sel_hi:[1,0,0]
  v_fma_mix_f32 v63, v30, v63, v47 op_sel:[0,0,0] op_sel_hi:[1,0,0]
  ds_write_b128 v6, v[60:63] offset:23552
  buffer_load_dwordx4 a[188:191], v110, s[8:11], s101 offen offset:2048 sc1
  buffer_load_dword v2, v8, s[8:11], 0 offen sc1
  s_waitcnt lgkmcnt(0)
  s_barrier
  buffer_load_dwordx4 a[192:195], v110, s[8:11], s101 offen offset:3072 sc1
  s_add_u32 s101, s101, 4096
  buffer_load_dwordx4 a[196:199], v110, s[8:11], s101 offen offset:0 sc1
  s_waitcnt vmcnt(2)
  v_cmp_ne_u32 vcc, s3, v2
  s_nop 1
  s_cbranch_vccz ok_22
  s_mov_b32 s97, 0x20000
  s_branch polls_24
poll_23:
  s_sleep 4
polls_24:
  s_sub_u32 s97, s97, 1
  s_cbranch_scc1 END
  buffer_load_dword v2, v8, s[8:11], 0 offen sc1
  s_waitcnt vmcnt(0)
  v_cmp_ne_u32 vcc, s3, v2
  s_nop 1
  s_cbranch_vccnz poll_23
ok_22:
merge_3:
  v_mov_b32 v96, 0x3f803f80
  v_mov_b32 v97, 0x3f803f80
  v_mov_b32 v98, 0x3f803f80
  v_mov_b32 v99, 0x3f803f80
  s_mul_i32 s100, s89, 61440
  s_add_u32 s101, s100, 12648448
  s_add_u32 s100, s100, 10682368
  s_waitcnt vmcnt(25)
  v_mfma_f32_16x16x32_bf16 v[112:115], a[0:3], v[96:99], 0
  s_add_u32 s24, s6, 1
  s_and_b32 s24, s24, 3
  s_add_u32 s25, s6, 2
  s_and_b32 s25, s25, 3
  s_add_u32 s26, s6, 3
  s_and_b32 s26, s26, 3
  s_add_u32 s27, s6, 4
  s_and_b32 s27, s27, 3
  v_lshrrev_b32 v3, 4, v0
  v_lshlrev_b32 v4, 4, v3
  v_mfma_f32_16x16x32_bf16 v[116:119], a[4:7], v[96:99], 0
  v_add_u32 v4, 124672, v4
  s_mul_i32 s40, s6, 320
  v_add_u32 v85, s40, v4
  s_lshl_b32 s41, s6, 13
  v_mfma_f32_16x16x32_bf16 v[120:123], a[8:11], v[96:99], 0
  v_lshlrev_b32 v104, 7, v0
  v_add_u32 v104, s41, v104
  v_mfma_f32_16x16x32_bf16 v[124:127], a[12:15], v[96:99], 0
  v_and_b32 v5, 3, v0
  v_lshlrev_b32 v105, 7, v5
  s_lshl_b32 s41, s89, 9
  v_mfma_f32_16x16x32_bf16 v[128:131], a[16:19], v[96:99], 0
  v_add_u32 v105, s41, v105
  v_mov_b32 v102, s3
  v_mfma_f32_16x16x32_bf16 v[112:115], a[20:23], v[96:99], v[112:115]
  v_lshlrev_b32 v103, 15, v0
  s_mul_i32 s40, s24, 15360
  s_add_u32 s40, s40, 81920
  v_add_u32 v86, s40, v110
  s_mul_i32 s40, s25, 15360
  s_add_u32 s40, s40, 87040
  v_mfma_f32_16x16x32_bf16 v[116:119], a[24:27], v[96:99], v[116:119]
  v_add_u32 v87, s40, v110
  s_mul_i32 s40, s26, 15360
  s_add_u32 s40, s40, 92160
  v_add_u32 v88, s40, v110
  s_mul_i32 s40, s6, 15360
  s_add_u32 s40, s40, 81920
  v_mfma_f32_16x16x32_bf16 v[120:123], a[28:31], v[96:99], v[120:123]
  v_add_u32 v89, s40, v110
  v_lshlrev_b32 v6, 2, v5
  v_mfma_f32_16x16x32_bf16 v[124:127], a[32:35], v[96:99], v[124:127]
  v_and_b32 v7, 4, v0
  v_lshlrev_b32 v7, 5, v7
  v_mfma_f32_16x16x32_bf16 v[128:131], a[36:39], v[96:99], v[128:131]
  v_add_u32 v111, v6, v7
  s_lshl_b32 s40, s98, 2
  s_add_u32 s40, s40, s6
  s_lshl_b32 s40, s40, 8
  v_add_u32 v111, s40, v111
  v_mfma_f32_16x16x32_bf16 v[112:115], a[40:43], v[96:99], v[112:115]
  v_lshrrev_b32 v6, 2, v0
  v_lshlrev_b32 v7, 7, v6
  v_mfma_f32_16x16x32_bf16 v[116:119], a[44:47], v[96:99], v[116:119]
  v_lshlrev_b32 v5, 3, v5
  v_add_u32 v7, v7, v5
  v_mfma_f32_16x16x32_bf16 v[120:123], a[48:51], v[96:99], v[120:123]
  v_and_b32 v6, 3, v6
  v_and_b32 v2, 1, v3
  v_mfma_f32_16x16x32_bf16 v[124:127], a[52:55], v[96:99], v[124:127]
  v_xor_b32 v2, v2, v6
  v_lshlrev_b32 v2, 5, v2
  v_mfma_f32_16x16x32_bf16 v[128:131], a[56:59], v[96:99], v[128:131]
  v_add_u32 v7, v7, v2
  s_mul_i32 s43, s6, 20480
  v_add_u32 v7, s43, v7
  s_lshl_b32 s41, s24, 5
  v_mfma_f32_16x16x32_bf16 v[112:115], a[60:63], v[96:99], v[112:115]
  v_xor_b32 v90, s41, v7
  s_lshl_b32 s41, s25, 5
  v_xor_b32 v91, s41, v7
  s_lshl_b32 s41, s26, 5
  v_mfma_f32_16x16x32_bf16 v[116:119], a[64:67], v[96:99], v[116:119]
  v_xor_b32 v92, s41, v7
  s_lshl_b32 s41, s27, 5
  v_xor_b32 v93, s41, v7
  v_mfma_f32_16x16x32_bf16 v[120:123], a[68:71], v[96:99], v[120:123]
  v_mul_u32_u24 v3, 20, v3
  v_add_u32 v3, v3, v6
  v_mfma_f32_16x16x32_bf16 v[124:127], a[72:75], v[96:99], v[124:127]
  v_lshlrev_b32 v3, 7, v3
  v_add_u32 v3, v3, v5
  v_mfma_f32_16x16x32_bf16 v[128:131], a[76:79], v[96:99], v[128:131]
  v_add_u32 v3, v3, v2
  s_mul_i32 s40, s99, 10240
  v_add_u32 v3, s40, v3
  s_lshl_b32 s41, s6, 5
  v_mfma_f32_16x16x32_bf16 v[112:115], a[80:83], v[96:99], v[112:115]
  v_xor_b32 v94, s41, v3
  v_xor_b32 v95, 32, v94
  v_mfma_f32_16x16x32_bf16 v[116:119], a[84:87], v[96:99], v[116:119]
  v_and_b32 v84, 15, v0
  v_lshlrev_b32 v84, 5, v84
  v_mfma_f32_16x16x32_bf16 v[120:123], a[88:91], v[96:99], v[120:123]
  v_add_u32 v84, 143360, v84
  v_mfma_f32_16x16x32_bf16 v[124:127], a[92:95], v[96:99], v[124:127]
  v_mfma_f32_16x16x32_bf16 v[128:131], a[96:99], v[96:99], v[128:131]
  s_mul_i32 s42, s98, 81920
  s_add_u32 s42, s42, s43
  s_add_u32 s42, s42, 3145728
  s_mov_b32 m0, s43
  s_mov_b32 s40, 0
  s_lshl_b32 s45, s96, 7
  s_add_u32 s45, s45, 65536
  s_add_u32 s40, s40, 65536
  s_mov_b32 s41, 409600
  s_mov_b32 exec_lo, 0x00010001
  s_mov_b32 exec_hi, 0x00010001
  ds_write_b128 v85, v[112:115] offset:0
  ds_write_b128 v85, v[116:119] offset:64
  ds_write_b128 v85, v[120:123] offset:128
  ds_write_b128 v85, v[124:127] offset:192
  ds_write_b128 v85, v[128:131] offset:256
  s_mov_b64 exec, -1
  s_waitcnt vmcnt(0) lgkmcnt(0)
  s_barrier
  s_cmp_lg_u32 s6, 0
  s_cbranch_scc1 nofl_25
  s_mov_b64 exec, 0x1
  buffer_store_dword v102, v103, s[8:11], s45 offen sc1
  s_mov_b64 exec, -1
nofl_25:
  buffer_load_dwordx4 a[200:203], v110, s[8:11], s100 offen offset:0 sc1
  buffer_load_dwordx4 a[204:207], v110, s[8:11], s100 offen offset:1024 sc1
  buffer_load_dwordx4 a[208:211], v110, s[8:11], s100 offen offset:2048 sc1
  buffer_load_dwordx4 a[212:215], v110, s[8:11], s100 offen offset:3072 sc1
  s_add_u32 s100, s100, 4096
  buffer_load_dwordx4 a[216:219], v110, s[8:11], s100 offen offset:0 sc1
  buffer_load_dwordx4 a[220:223], v110, s[8:11], s100 offen offset:1024 sc1
  buffer_load_dwordx4 a[224:227], v110, s[8:11], s100 offen offset:2048 sc1
  buffer_load_dwordx4 a[228:231], v110, s[8:11], s100 offen offset:3072 sc1
  s_add_u32 s100, s100, 4096
  buffer_load_dwordx4 a[232:235], v110, s[8:11], s100 offen offset:0 sc1
  buffer_load_dwordx4 a[236:239], v110, s[8:11], s100 offen offset:1024 sc1
  buffer_load_dwordx4 a[240:243], v110, s[8:11], s100 offen offset:2048 sc1
  buffer_load_dwordx4 a[244:247], v110, s[8:11], s100 offen offset:3072 sc1
  s_add_u32 s100, s100, 4096
  buffer_load_dwordx4 a[248:251], v110, s[8:11], s100 offen offset:0 sc1
  buffer_load_dwordx4 a[252:255], v110, s[8:11], s100 offen offset:1024 sc1
  buffer_load_dwordx4 v[112:115], v110, s[8:11], s100 offen offset:2048 sc1
  buffer_load_dwordx4 v[116:119], v110, s[8:11], s100 offen offset:3072 sc1
  s_add_u32 s100, s100, 4096
  buffer_load_dwordx4 v[120:123], v110, s[8:11], s100 offen offset:0 sc1
  buffer_load_dwordx4 v[124:127], v110, s[8:11], s100 offen offset:1024 sc1
  buffer_load_dwordx4 v[128:131], v110, s[8:11], s100 offen offset:2048 sc1
  buffer_load_dwordx4 v[132:135], v110, s[8:11], s100 offen offset:3072 sc1
  s_add_u32 s100, s100, 4096
  buffer_load_dwordx4 v[136:139], v110, s[8:11], s100 offen offset:0 sc1
  buffer_load_dwordx4 v[140:143], v110, s[8:11], s100 offen offset:1024 sc1
  buffer_load_dwordx4 v[144:147], v110, s[8:11], s100 offen offset:2048 sc1
  buffer_load_dwordx4 v[148:151], v110, s[8:11], s100 offen offset:3072 sc1
  ds_read_b128 v[196:199], v4 offset:0
  ds_read_b128 v[216:219], v4 offset:320
  ds_read_b128 v[236:239], v4 offset:640
  ds_read_b128 v[28:31], v4 offset:960
  ds_read_b128 v[200:203], v4 offset:64
  ds_read_b128 v[220:223], v4 offset:384
  ds_read_b128 v[240:243], v4 offset:704
  ds_read_b128 v[32:35], v4 offset:1024
  ds_read_b128 v[204:207], v4 offset:128
  ds_read_b128 v[224:227], v4 offset:448
  ds_read_b128 v[244:247], v4 offset:768
  ds_read_b128 v[36:39], v4 offset:1088
  ds_read_b128 v[208:211], v4 offset:192
  ds_read_b128 v[228:231], v4 offset:512
  ds_read_b128 v[248:251], v4 offset:832
  ds_read_b128 v[40:43], v4 offset:1152
  ds_read_b128 v[212:215], v4 offset:256
  ds_read_b128 v[232:235], v4 offset:576
  ds_read_b128 v[252:255], v4 offset:896
  ds_read_b128 v[44:47], v4 offset:1216
  s_mov_b32 s28, 0x22222222
  s_mov_b32 s29, s28
  s_mov_b32 s30, 0x44444444
  s_mov_b32 s31, s30
  s_mov_b32 s32, 0x88888888
  s_mov_b32 s33, s32
  s_mov_b32 s34, 0x00f0000f
  s_mov_b32 s35, 0xf0000f00
  s_waitcnt lgkmcnt(15)
  v_pk_add_f32 v[196:197], v[196:197], v[216:217]
  v_pk_add_f32 v[236:237], v[236:237], v[28:29]
  v_pk_add_f32 v[198:199], v[198:199], v[218:219]
  v_pk_add_f32 v[238:239], v[238:239], v[30:31]
  v_pk_add_f32 v[196:197], v[196:197], v[236:237]
  v_pk_add_f32 v[198:199], v[198:199], v[238:239]
  s_waitcnt lgkmcnt(12)
  v_pk_add_f32 v[200:201], v[200:201], v[220:221]
  v_pk_add_f32 v[240:241], v[240:241], v[32:33]
  v_pk_add_f32 v[202:203], v[202:203], v[222:223]
  v_pk_add_f32 v[242:243], v[242:243], v[34:35]
  v_pk_add_f32 v[200:201], v[200:201], v[240:241]
  v_pk_add_f32 v[202:203], v[202:203], v[242:243]
  s_waitcnt lgkmcnt(8)
  v_pk_add_f32 v[204:205], v[204:205], v[224:225]
  v_pk_add_f32 v[244:245], v[244:245], v[36:37]
  v_pk_add_f32 v[206:207], v[206:207], v[226:227]
  v_pk_add_f32 v[246:247], v[246:247], v[38:39]
  v_pk_add_f32 v[204:205], v[204:205], v[244:245]
  v_pk_add_f32 v[206:207], v[206:207], v[246:247]
  s_waitcnt lgkmcnt(4)
  v_pk_add_f32 v[208:209], v[208:209], v[228:229]
  v_pk_add_f32 v[248:249], v[248:249], v[40:41]
  v_pk_add_f32 v[210:211], v[210:211], v[230:231]
  v_pk_add_f32 v[250:251], v[250:251], v[42:43]
  v_pk_add_f32 v[208:209], v[208:209], v[248:249]
  v_pk_add_f32 v[210:211], v[210:211], v[250:251]
  s_waitcnt lgkmcnt(0)
  v_pk_add_f32 v[212:213], v[212:213], v[232:233]
  v_pk_add_f32 v[252:253], v[252:253], v[44:45]
  v_pk_add_f32 v[214:215], v[214:215], v[234:235]
  v_pk_add_f32 v[254:255], v[254:255], v[46:47]
  v_pk_add_f32 v[212:213], v[212:213], v[252:253]
  v_pk_add_f32 v[214:215], v[214:215], v[254:255]
  s_mov_b32 exec_lo, 0x00010001
  s_mov_b32 exec_hi, 0x00010001
  ds_write_b128 v85, v[196:199] offset:22016
  ds_write_b128 v85, v[200:203] offset:22080
  ds_write_b128 v85, v[204:207] offset:22144
  ds_write_b128 v85, v[208:211] offset:22208
  ds_write_b128 v85, v[212:215] offset:22272
  s_mov_b64 exec, -1
  s_mov_b64 exec, 0
  s_cmp_eq_u32 s6, 0
  s_cbranch_scc1 PAD0
  s_cmp_eq_u32 s6, 1
  s_cbranch_scc1 PAD9
  s_cmp_eq_u32 s6, 2
  s_cbranch_scc1 PAD19
  s_branch PAD29
WRET:
  s_mov_b64 exec, -1
  s_mov_b32 s97, 0x20000
  buffer_load_dword v106, v104, s[8:11], s40 offen sc1
  buffer_load_dword v107, v105, s[8:11], s41 offen sc1
  s_waitcnt vmcnt(1)
  v_xor_b32 v108, s3, v106
  v_cmp_lt_u32 s[36:37], 0, v108
  s_waitcnt vmcnt(0)
  v_xor_b32 v108, s3, v107
  v_cmp_lt_u32 s[38:39], 0, v108
  s_nop 1
  s_or_b64 vcc, s[36:37], s[38:39]
  s_cbranch_scc0 ppe_27
pp_26:
  s_sleep 4
  s_sub_u32 s97, s97, 1
  s_cbranch_scc1 END
  s_mov_b64 exec, s[36:37]
  buffer_load_dword v106, v104, s[8:11], s40 offen sc1
  s_mov_b64 exec, s[38:39]
  buffer_load_dword v107, v105, s[8:11], s41 offen sc1
  s_mov_b64 exec, -1
  s_waitcnt vmcnt(1)
  v_xor_b32 v108, s3, v106
  v_cmp_lt_u32 s[36:37], 0, v108
  s_waitcnt vmcnt(0)
  v_xor_b32 v108, s3, v107
  v_cmp_lt_u32 s[38:39], 0, v108
  s_nop 1
  s_or_b64 vcc, s[36:37], s[38:39]
  s_cbranch_scc1 pp_26
ppe_27:
  buffer_load_dwordx4 v110, s[8:11], s42 offen offset:0 sc1 lds
  buffer_load_dwordx4 v110, s[8:11], s42 offen offset:1024 sc1 lds
  buffer_load_dwordx4 v110, s[8:11], s42 offen offset:2048 sc1 lds
  buffer_load_dwordx4 v110, s[8:11], s42 offen offset:3072 sc1 lds
  s_add_u32 s42, s42, 4096
  s_add_u32 m0, m0, 4096
  s_nop 0
  buffer_load_dwordx4 v110, s[8:11], s42 offen offset:0 sc1 lds
  buffer_load_dwordx4 v110, s[8:11], s42 offen offset:1024 sc1 lds
  buffer_load_dwordx4 v110, s[8:11], s42 offen offset:2048 sc1 lds
  buffer_load_dwordx4 v110, s[8:11], s42 offen offset:3072 sc1 lds
  s_add_u32 s42, s42, 4096
  s_add_u32 m0, m0, 4096
  s_nop 0
  buffer_load_dwordx4 v110, s[8:11], s42 offen offset:0 sc1 lds
  buffer_load_dwordx4 v110, s[8:11], s42 offen offset:1024 sc1 lds
  buffer_load_dwordx4 v110, s[8:11], s42 offen offset:2048 sc1 lds
  buffer_load_dwordx4 v110, s[8:11], s42 offen offset:3072 sc1 lds
  s_add_u32 s42, s42, 4096
  s_add_u32 m0, m0, 4096
  s_nop 0
  buffer_load_dwordx4 v110, s[8:11], s42 offen offset:0 sc1 lds
  buffer_load_dwordx4 v110, s[8:11], s42 offen offset:1024 sc1 lds
  buffer_load_dwordx4 v110, s[8:11], s42 offen offset:2048 sc1 lds
  buffer_load_dwordx4 v110, s[8:11], s42 offen offset:3072 sc1 lds
  s_add_u32 s42, s42, 4096
  s_add_u32 m0, m0, 4096
  s_nop 0
  buffer_load_dwordx4 v110, s[8:11], s42 offen offset:0 sc1 lds
  buffer_load_dwordx4 v110, s[8:11], s42 offen offset:1024 sc1 lds
  buffer_load_dwordx4 v110, s[8:11], s42 offen offset:2048 sc1 lds
  buffer_load_dwordx4 v110, s[8:11], s42 offen offset:3072 sc1 lds
  s_mul_i32 s43, s89, 61440
  s_add_u32 s43, s43, 10715136
  s_waitcnt vmcnt(16)
  ds_read_b64_tr_b16 v[60:61], v90 offset:0
  ds_read_b64_tr_b16 v[62:63], v90 offset:2048
  ds_read_b64_tr_b16 v[64:65], v91 offset:0
  ds_read_b64_tr_b16 v[66:67], v91 offset:2048
  ds_read_b64_tr_b16 v[68:69], v92 offset:0
  ds_read_b64_tr_b16 v[70:71], v92 offset:2048
  ds_read_b64_tr_b16 v[72:73], v93 offset:0
  ds_read_b64_tr_b16 v[74:75], v93 offset:2048
  s_waitcnt lgkmcnt(6)
  v_mfma_f32_16x16x32_bf16 v[28:31], v[60:63], v[60:63], 0
  s_waitcnt vmcnt(12)
  ds_read_b64_tr_b16 v[76:77], v90 offset:4096
  ds_read_b64_tr_b16 v[78:79], v90 offset:6144
  s_add_u32 s100, s100, 4096
  buffer_load_dwordx4 v[152:155], v110, s[8:11], s100 offen offset:0 sc1
  v_mfma_f32_16x16x32_bf16 v[44:47], v[96:99], v[60:63], 0
  v_mfma_f32_16x16x32_bf16 v[196:199], a[0:3], v[60:63], 0
  v_mfma_f32_16x16x32_bf16 v[200:203], a[4:7], v[60:63], 0
  v_mfma_f32_16x16x32_bf16 v[204:207], a[8:11], v[60:63], 0
  v_mfma_f32_16x16x32_bf16 v[208:211], a[12:15], v[60:63], 0
  buffer_load_dwordx4 v[156:159], v110, s[8:11], s100 offen offset:1024 sc1
  v_mfma_f32_16x16x32_bf16 v[212:215], a[16:19], v[60:63], 0
  s_waitcnt lgkmcnt(6)
  v_mfma_f32_16x16x32_bf16 v[32:35], v[64:67], v[64:67], 0
  ds_read_b64_tr_b16 v[80:81], v91 offset:4096
  ds_read_b64_tr_b16 v[82:83], v91 offset:6144
  v_mfma_f32_16x16x32_bf16 v[48:51], v[96:99], v[64:67], 0
  v_mfma_f32_16x16x32_bf16 v[216:219], a[0:3], v[64:67], 0
  v_mfma_f32_16x16x32_bf16 v[220:223], a[4:7], v[64:67], 0
  buffer_load_dwordx4 v[160:163], v110, s[8:11], s100 offen offset:2048 sc1
  v_mfma_f32_16x16x32_bf16 v[224:227], a[8:11], v[64:67], 0
  v_mfma_f32_16x16x32_bf16 v[228:231], a[12:15], v[64:67], 0
  v_mfma_f32_16x16x32_bf16 v[232:235], a[16:19], v[64:67], 0
  s_waitcnt lgkmcnt(6)
  v_mfma_f32_16x16x32_bf16 v[36:39], v[68:71], v[68:71], 0
  ds_read_b64_tr_b16 v[60:61], v92 offset:4096
  ds_read_b64_tr_b16 v[62:63], v92 offset:6144
  v_mfma_f32_16x16x32_bf16 v[52:55], v[96:99], v[68:71], 0
  buffer_load_dwordx4 v[164:167], v110, s[8:11], s100 offen offset:3072 sc1
  v_mfma_f32_16x16x32_bf16 v[236:239], a[0:3], v[68:71], 0
  v_mfma_f32_16x16x32_bf16 v[240:243], a[4:7], v[68:71], 0
  v_mfma_f32_16x16x32_bf16 v[244:247], a[8:11], v[68:71], 0
  v_mfma_f32_16x16x32_bf16 v[248:251], a[12:15], v[68:71], 0
  v_mfma_f32_16x16x32_bf16 v[252:255], a[16:19], v[68:71], 0
  s_add_u32 s100, s100, 4096
  buffer_load_dwordx4 v[168:171], v110, s[8:11], s100 offen offset:0 sc1
  s_waitcnt lgkmcnt(6)
  v_mfma_f32_16x16x32_bf16 v[40:43], v[72:75], v[72:75], 0
  ds_read_b64_tr_b16 v[64:65], v93 offset:4096
  ds_read_b64_tr_b16 v[66:67], v93 offset:6144
  v_mfma_f32_16x16x32_bf16 v[56:59], v[96:99], v[72:75], 0
  v_mfma_f32_16x16x32_bf16 v[8:11], a[0:3], v[72:75], 0
  v_mfma_f32_16x16x32_bf16 v[12:15], a[4:7], v[72:75], 0
  v_mfma_f32_16x16x32_bf16 v[16:19], a[8:11], v[72:75], 0
  buffer_load_dwordx4 v[172:175], v110, s[8:11], s100 offen offset:1024 sc1
  v_mfma_f32_16x16x32_bf16 v[20:23], a[12:15], v[72:75], 0
  v_mfma_f32_16x16x32_bf16 v[24:27], a[16:19], v[72:75], 0
  s_waitcnt lgkmcnt(6)
  v_mfma_f32_16x16x32_bf16 v[28:31], v[76:79], v[76:79], v[28:31]
  s_waitcnt vmcnt(14)
  ds_read_b64_tr_b16 v[68:69], v90 offset:8192
  ds_read_b64_tr_b16 v[70:71], v90 offset:10240
  v_mfma_f32_16x16x32_bf16 v[44:47], v[96:99], v[76:79], v[44:47]
  v_mfma_f32_16x16x32_bf16 v[196:199], a[20:23], v[76:79], v[196:199]
  buffer_load_dwordx4 v[176:179], v110, s[8:11], s100 offen offset:2048 sc1
  v_mfma_f32_16x16x32_bf16 v[200:203], a[24:27], v[76:79], v[200:203]
  v_mfma_f32_16x16x32_bf16 v[204:207], a[28:31], v[76:79], v[204:207]
  v_mfma_f32_16x16x32_bf16 v[208:211], a[32:35], v[76:79], v[208:211]
  v_mfma_f32_16x16x32_bf16 v[212:215], a[36:39], v[76:79], v[212:215]
  s_waitcnt lgkmcnt(6)
  v_mfma_f32_16x16x32_bf16 v[32:35], v[80:83], v[80:83], v[32:35]
  ds_read_b64_tr_b16 v[72:73], v91 offset:8192
  ds_read_b64_tr_b16 v[74:75], v91 offset:10240
  buffer_load_dwordx4 v[180:183], v110, s[8:11], s100 offen offset:3072 sc1
  v_mfma_f32_16x16x32_bf16 v[48:51], v[96:99], v[80:83], v[48:51]
  v_mfma_f32_16x16x32_bf16 v[216:219], a[20:23], v[80:83], v[216:219]
  v_mfma_f32_16x16x32_bf16 v[220:223], a[24:27], v[80:83], v[220:223]
  v_mfma_f32_16x16x32_bf16 v[224:227], a[28:31], v[80:83], v[224:227]
  v_mfma_f32_16x16x32_bf16 v[228:231], a[32:35], v[80:83], v[228:231]
  s_add_u32 s100, s100, 4096
  buffer_load_dwordx4 v[184:187], v110, s[8:11], s100 offen offset:0 sc1
  v_mfma_f32_16x16x32_bf16 v[232:235], a[36:39], v[80:83], v[232:235]
  s_waitcnt lgkmcnt(6)
  v_mfma_f32_16x16x32_bf16 v[36:39], v[60:63], v[60:63], v[36:39]
  ds_read_b64_tr_b16 v[76:77], v92 offset:8192
  ds_read_b64_tr_b16 v[78:79], v92 offset:10240
  v_mfma_f32_16x16x32_bf16 v[52:55], v[96:99], v[60:63], v[52:55]
  v_mfma_f32_16x16x32_bf16 v[236:239], a[20:23], v[60:63], v[236:239]
  v_mfma_f32_16x16x32_bf16 v[240:243], a[24:27], v[60:63], v[240:243]
  buffer_load_dwordx4 v[188:191], v110, s[8:11], s100 offen offset:1024 sc1
  v_mfma_f32_16x16x32_bf16 v[244:247], a[28:31], v[60:63], v[244:247]
  v_mfma_f32_16x16x32_bf16 v[248:251], a[32:35], v[60:63], v[248:251]
  v_mfma_f32_16x16x32_bf16 v[252:255], a[36:39], v[60:63], v[252:255]
  s_waitcnt lgkmcnt(6)
  v_mfma_f32_16x16x32_bf16 v[40:43], v[64:67], v[64:67], v[40:43]
  ds_read_b64_tr_b16 v[80:81], v93 offset:8192
  ds_read_b64_tr_b16 v[82:83], v93 offset:10240
  v_mfma_f32_16x16x32_bf16 v[56:59], v[96:99], v[64:67], v[56:59]
  buffer_load_dwordx4 v[192:195], v110, s[8:11], s100 offen offset:2048 sc1
  v_mfma_f32_16x16x32_bf16 v[8:11], a[20:23], v[64:67], v[8:11]
  v_mfma_f32_16x16x32_bf16 v[12:15], a[24:27], v[64:67], v[12:15]
  v_mfma_f32_16x16x32_bf16 v[16:19], a[28:31], v[64:67], v[16:19]
  v_mfma_f32_16x16x32_bf16 v[20:23], a[32:35], v[64:67], v[20:23]
  v_mfma_f32_16x16x32_bf16 v[24:27], a[36:39], v[64:67], v[24:27]
  buffer_load_dwordx4 a[0:3], v110, s[8:11], s43 offen offset:3072 sc1
  s_waitcnt lgkmcnt(6)
  v_mfma_f32_16x16x32_bf16 v[28:31], v[68:71], v[68:71], v[28:31]
  s_waitcnt vmcnt(16)
  ds_read_b64_tr_b16 v[60:61], v90 offset:12288
  ds_read_b64_tr_b16 v[62:63], v90 offset:14336
  v_mfma_f32_16x16x32_bf16 v[44:47], v[96:99], v[68:71], v[44:47]
  v_mfma_f32_16x16x32_bf16 v[196:199], a[40:43], v[68:71], v[196:199]
  v_mfma_f32_16x16x32_bf16 v[200:203], a[44:47], v[68:71], v[200:203]
  v_mfma_f32_16x16x32_bf16 v[204:207], a[48:51], v[68:71], v[204:207]
  s_add_u32 s43, s43, 4096
  buffer_load_dwordx4 a[4:7], v110, s[8:11], s43 offen offset:0 sc1
  v_mfma_f32_16x16x32_bf16 v[208:211], a[52:55], v[68:71], v[208:211]
  v_mfma_f32_16x16x32_bf16 v[212:215], a[56:59], v[68:71], v[212:215]
  s_waitcnt lgkmcnt(6)
  v_mfma_f32_16x16x32_bf16 v[32:35], v[72:75], v[72:75], v[32:35]
  s_waitcnt vmcnt(13)
  ds_read_b64_tr_b16 v[64:65], v90 offset:16384
  ds_read_b64_tr_b16 v[66:67], v90 offset:18432
  v_mfma_f32_16x16x32_bf16 v[48:51], v[96:99], v[72:75], v[48:51]
  v_mfma_f32_16x16x32_bf16 v[216:219], a[40:43], v[72:75], v[216:219]
  buffer_load_dwordx4 a[8:11], v110, s[8:11], s43 offen offset:1024 sc1
  v_mfma_f32_16x16x32_bf16 v[220:223], a[44:47], v[72:75], v[220:223]
  v_mfma_f32_16x16x32_bf16 v[224:227], a[48:51], v[72:75], v[224:227]
  v_mfma_f32_16x16x32_bf16 v[228:231], a[52:55], v[72:75], v[228:231]
  v_mfma_f32_16x16x32_bf16 v[232:235], a[56:59], v[72:75], v[232:235]
  s_waitcnt lgkmcnt(6)
  v_mfma_f32_16x16x32_bf16 v[36:39], v[76:79], v[76:79], v[36:39]
  ds_read_b64_tr_b16 v[68:69], v91 offset:12288
  ds_read_b64_tr_b16 v[70:71], v91 offset:14336
  buffer_load_dwordx4 a[12:15], v110, s[8:11], s43 offen offset:2048 sc1
  v_mfma_f32_16x16x32_bf16 v[52:55], v[96:99], v[76:79], v[52:55]
  v_mfma_f32_16x16x32_bf16 v[236:239], a[40:43], v[76:79], v[236:239]
  v_mfma_f32_16x16x32_bf16 v[240:243], a[44:47], v[76:79], v[240:243]
  v_mfma_f32_16x16x32_bf16 v[244:247], a[48:51], v[76:79], v[244:247]
  v_mfma_f32_16x16x32_bf16 v[248:251], a[52:55], v[76:79], v[248:251]
  buffer_load_dwordx4 a[16:19], v110, s[8:11], s43 offen offset:3072 sc1
  v_mfma_f32_16x16x32_bf16 v[252:255], a[56:59], v[76:79], v[252:255]
  s_waitcnt lgkmcnt(6)
  v_mfma_f32_16x16x32_bf16 v[40:43], v[80:83], v[80:83], v[40:43]
  ds_read_b64_tr_b16 v[72:73], v91 offset:16384
  ds_read_b64_tr_b16 v[74:75], v91 offset:18432
  v_mfma_f32_16x16x32_bf16 v[56:59], v[96:99], v[80:83], v[56:59]
  v_mfma_f32_16x16x32_bf16 v[8:11], a[40:43], v[80:83], v[8:11]
  v_mfma_f32_16x16x32_bf16 v[12:15], a[44:47], v[80:83], v[12:15]
  s_add_u32 s43, s43, 4096
  buffer_load_dwordx4 a[20:23], v110, s[8:11], s43 offen offset:0 sc1
  v_mfma_f32_16x16x32_bf16 v[16:19], a[48:51], v[80:83], v[16:19]
  v_mfma_f32_16x16x32_bf16 v[20:23], a[52:55], v[80:83], v[20:23]
  v_mfma_f32_16x16x32_bf16 v[24:27], a[56:59], v[80:83], v[24:27]
  s_waitcnt lgkmcnt(6)
  v_mfma_f32_16x16x32_bf16 v[28:31], v[60:63], v[60:63], v[28:31]
  ds_read_b64_tr_b16 v[76:77], v92 offset:12288
  ds_read_b64_tr_b16 v[78:79], v92 offset:14336
  v_mfma_f32_16x16x32_bf16 v[44:47], v[96:99], v[60:63], v[44:47]
  buffer_load_dwordx4 a[24:27], v110, s[8:11], s43 offen offset:1024 sc1
  v_mfma_f32_16x16x32_bf16 v[196:199], a[60:63], v[60:63], v[196:199]
  v_mfma_f32_16x16x32_bf16 v[200:203], a[64:67], v[60:63], v[200:203]
  v_mfma_f32_16x16x32_bf16 v[204:207], a[68:71], v[60:63], v[204:207]
  v_mfma_f32_16x16x32_bf16 v[208:211], a[72:75], v[60:63], v[208:211]
  v_mfma_f32_16x16x32_bf16 v[212:215], a[76:79], v[60:63], v[212:215]
  buffer_load_dwordx4 a[28:31], v110, s[8:11], s43 offen offset:2048 sc1
  s_waitcnt lgkmcnt(6)
  v_mfma_f32_16x16x32_bf16 v[28:31], v[64:67], v[64:67], v[28:31]
  ds_read_b64_tr_b16 v[80:81], v92 offset:16384
  ds_read_b64_tr_b16 v[82:83], v92 offset:18432
  v_mfma_f32_16x16x32_bf16 v[44:47], v[96:99], v[64:67], v[44:47]
  v_mfma_f32_16x16x32_bf16 v[196:199], a[80:83], v[64:67], v[196:199]
  v_mfma_f32_16x16x32_bf16 v[200:203], a[84:87], v[64:67], v[200:203]
  v_mfma_f32_16x16x32_bf16 v[204:207], a[88:91], v[64:67], v[204:207]
  buffer_load_dwordx4 a[32:35], v110, s[8:11], s43 offen offset:3072 sc1
  v_mfma_f32_16x16x32_bf16 v[208:211], a[92:95], v[64:67], v[208:211]
  v_mfma_f32_16x16x32_bf16 v[212:215], a[96:99], v[64:67], v[212:215]
  s_waitcnt lgkmcnt(6)
  v_mfma_f32_16x16x32_bf16 v[32:35], v[68:71], v[68:71], v[32:35]
  ds_read_b64_tr_b16 v[60:61], v93 offset:12288
  ds_read_b64_tr_b16 v[62:63], v93 offset:14336
  v_mfma_f32_16x16x32_bf16 v[48:51], v[96:99], v[68:71], v[48:51]
  v_mfma_f32_16x16x32_bf16 v[216:219], a[60:63], v[68:71], v[216:219]
  s_add_u32 s43, s43, 4096
  buffer_load_dwordx4 a[36:39], v110, s[8:11], s43 offen offset:0 sc1
  v_cndmask_b32_e64 v45, v28, v29, s[28:29]
  v_cndmask_b32_e64 v30, v30, v31, s[32:33]
  s_lshl_b32 s40, s24, 9
  s_lshl_b32 s41, s6, 3
  s_add_u32 s40, s40, s41
  s_or_b64 vcc, s[30:31], s[32:33]
  v_add_u32 v28, s40, v84
  v_cndmask_b32 v45, v45, v30, vcc
  s_mov_b64 exec, s[34:35]
  ds_write_b64 v28, v[44:45]
  s_mov_b64 exec, -1
  v_mfma_f32_16x16x32_bf16 v[220:223], a[64:67], v[68:71], v[220:223]
  v_lshlrev_b32 v2, 7, v0
  s_mul_i32 s47, s98, 32
  s_add_u32 s47, s47, s89
  s_mul_i32 s47, s47, 3072
  s_add_u32 s47, s47, 5898240
  s_mov_b64 exec, 0xffffff
  buffer_load_dword v3, v2, s[12:15], s47 offen sc1
  s_mov_b64 exec, -1
  ds_write_b128 v86, v[196:199] offset:0
  v_mfma_f32_16x16x32_bf16 v[224:227], a[68:71], v[68:71], v[224:227]
  ds_write_b128 v86, v[200:203] offset:1024
  v_mfma_f32_16x16x32_bf16 v[228:231], a[72:75], v[68:71], v[228:231]
  ds_write_b128 v86, v[204:207] offset:2048
  v_mfma_f32_16x16x32_bf16 v[232:235], a[76:79], v[68:71], v[232:235]
  ds_write_b128 v86, v[208:211] offset:3072
  s_waitcnt lgkmcnt(11)
  v_mfma_f32_16x16x32_bf16 v[32:35], v[72:75], v[72:75], v[32:35]
  ds_read_b64_tr_b16 v[64:65], v93 offset:16384
  ds_read_b64_tr_b16 v[66:67], v93 offset:18432
  buffer_load_dwordx4 a[40:43], v110, s[8:11], s43 offen offset:1024 sc1
  v_mfma_f32_16x16x32_bf16 v[48:51], v[96:99], v[72:75], v[48:51]
  v_mfma_f32_16x16x32_bf16 v[216:219], a[80:83], v[72:75], v[216:219]
  ds_write_b128 v86, v[212:215] offset:4096
  v_mfma_f32_16x16x32_bf16 v[220:223], a[84:87], v[72:75], v[220:223]
  v_mfma_f32_16x16x32_bf16 v[224:227], a[88:91], v[72:75], v[224:227]
  v_mfma_f32_16x16x32_bf16 v[228:231], a[92:95], v[72:75], v[228:231]
  buffer_load_dwordx4 a[44:47], v110, s[8:11], s43 offen offset:2048 sc1
  v_mfma_f32_16x16x32_bf16 v[232:235], a[96:99], v[72:75], v[232:235]
  s_waitcnt lgkmcnt(12)
  v_mfma_f32_16x16x32_bf16 v[36:39], v[76:79], v[76:79], v[36:39]
  v_mfma_f32_16x16x32_bf16 v[52:55], v[96:99], v[76:79], v[52:55]
  v_mfma_f32_16x16x32_bf16 v[236:239], a[60:63], v[76:79], v[236:239]
  v_cndmask_b32_e64 v49, v32, v33, s[28:29]
  v_cndmask_b32_e64 v34, v34, v35, s[32:33]
  s_lshl_b32 s40, s25, 9
  s_lshl_b32 s41, s6, 3
  s_add_u32 s40, s40, s41
  s_or_b64 vcc, s[30:31], s[32:33]
  v_add_u32 v32, s40, v84
  v_cndmask_b32 v49, v49, v34, vcc
  s_mov_b64 exec, s[34:35]
  ds_write_b64 v32, v[48:49]
  s_mov_b64 exec, -1
  v_mfma_f32_16x16x32_bf16 v[240:243], a[64:67], v[76:79], v[240:243]
  buffer_load_dwordx4 a[48:51], v110, s[8:11], s43 offen offset:3072 sc1
  ds_write_b128 v87, v[216:219] offset:0
  v_mfma_f32_16x16x32_bf16 v[244:247], a[68:71], v[76:79], v[244:247]
  ds_write_b128 v87, v[220:223] offset:1024
  v_mfma_f32_16x16x32_bf16 v[248:251], a[72:75], v[76:79], v[248:251]
  ds_write_b128 v87, v[224:227] offset:2048
  v_mfma_f32_16x16x32_bf16 v[252:255], a[76:79], v[76:79], v[252:255]
  ds_write_b128 v87, v[228:231] offset:3072
  s_waitcnt lgkmcnt(15)
  v_mfma_f32_16x16x32_bf16 v[36:39], v[80:83], v[80:83], v[36:39]
  v_mfma_f32_16x16x32_bf16 v[52:55], v[96:99], v[80:83], v[52:55]
  s_add_u32 s43, s43, 4096
  buffer_load_dwordx4 a[52:55], v110, s[8:11], s43 offen offset:0 sc1
  v_mfma_f32_16x16x32_bf16 v[236:239], a[80:83], v[80:83], v[236:239]
  ds_write_b128 v87, v[232:235] offset:4096
  v_mfma_f32_16x16x32_bf16 v[240:243], a[84:87], v[80:83], v[240:243]
  v_mfma_f32_16x16x32_bf16 v[244:247], a[88:91], v[80:83], v[244:247]
  v_mfma_f32_16x16x32_bf16 v[248:251], a[92:95], v[80:83], v[248:251]
  v_mfma_f32_16x16x32_bf16 v[252:255], a[96:99], v[80:83], v[252:255]
  buffer_load_dwordx4 a[56:59], v110, s[8:11], s43 offen offset:1024 sc1
  s_waitcnt lgkmcnt(14)
  v_mfma_f32_16x16x32_bf16 v[40:43], v[60:63], v[60:63], v[40:43]
  v_mfma_f32_16x16x32_bf16 v[56:59], v[96:99], v[60:63], v[56:59]
  v_mfma_f32_16x16x32_bf16 v[8:11], a[60:63], v[60:63], v[8:11]
  v_cndmask_b32_e64 v53, v36, v37, s[28:29]
  v_cndmask_b32_e64 v38, v38, v39, s[32:33]
  s_lshl_b32 s40, s26, 9
  s_lshl_b32 s41, s6, 3
  s_add_u32 s40, s40, s41
  s_or_b64 vcc, s[30:31], s[32:33]
  v_add_u32 v36, s40, v84
  v_cndmask_b32 v53, v53, v38, vcc
  s_mov_b64 exec, s[34:35]
  ds_write_b64 v36, v[52:53]
  s_mov_b64 exec, -1
  v_mfma_f32_16x16x32_bf16 v[12:15], a[64:67], v[60:63], v[12:15]
  ds_write_b128 v88, v[236:239] offset:0
  v_mfma_f32_16x16x32_bf16 v[16:19], a[68:71], v[60:63], v[16:19]
  buffer_load_dwordx4 a[60:63], v110, s[8:11], s43 offen offset:2048 sc1
  ds_write_b128 v88, v[240:243] offset:1024
  v_mfma_f32_16x16x32_bf16 v[20:23], a[72:75], v[60:63], v[20:23]
  ds_write_b128 v88, v[244:247] offset:2048
  v_mfma_f32_16x16x32_bf16 v[24:27], a[76:79], v[60:63], v[24:27]
  ds_write_b128 v88, v[248:251] offset:3072
  s_waitcnt lgkmcnt(12)
  v_mfma_f32_16x16x32_bf16 v[40:43], v[64:67], v[64:67], v[40:43]
  v_mfma_f32_16x16x32_bf16 v[56:59], v[96:99], v[64:67], v[56:59]
  v_mfma_f32_16x16x32_bf16 v[8:11], a[80:83], v[64:67], v[8:11]
  buffer_load_dwordx4 a[64:67], v110, s[8:11], s43 offen offset:3072 sc1
  ds_write_b128 v88, v[252:255] offset:4096
  v_mfma_f32_16x16x32_bf16 v[12:15], a[84:87], v[64:67], v[12:15]
  v_mfma_f32_16x16x32_bf16 v[16:19], a[88:91], v[64:67], v[16:19]
  s_nop 2
  v_cndmask_b32_e64 v57, v40, v41, s[28:29]
  v_cndmask_b32_e64 v42, v42, v43, s[32:33]
  s_lshl_b32 s40, s27, 9
  s_lshl_b32 s41, s6, 3
  s_add_u32 s40, s40, s41
  s_or_b64 vcc, s[30:31], s[32:33]
  v_add_u32 v40, s40, v84
  v_cndmask_b32 v57, v57, v42, vcc
  s_mov_b64 exec, s[34:35]
  ds_write_b64 v40, v[56:57]
  s_mov_b64 exec, -1
  v_mfma_f32_16x16x32_bf16 v[20:23], a[92:95], v[64:67], v[20:23]
  v_mfma_f32_16x16x32_bf16 v[24:27], a[96:99], v[64:67], v[24:27]
  ds_read_b128 v[60:63], v85 offset:22016
  ds_read_b128 v[64:67], v85 offset:22080
  ds_read_b128 v[68:71], v85 offset:22144
  ds_read_b128 v[72:75], v85 offset:22208
  ds_read_b128 v[76:79], v85 offset:22272
  s_lshl_b32 s40, s6, 9
  v_add_u32 v84, s40, v84
  s_waitcnt lgkmcnt(0)
  s_barrier
  ds_read_b128 v[28:31], v84
  ds_read_b128 v[32:35], v84 offset:16
  ds_read_b128 v[196:199], v89 offset:0
  ds_read_b128 v[216:219], v89 offset:5120
  ds_read_b128 v[236:239], v89 offset:10240
  ds_read_b128 v[200:203], v89 offset:1024
  ds_read_b128 v[220:223], v89 offset:6144
  ds_read_b128 v[240:243], v89 offset:11264
  ds_read_b128 v[204:207], v89 offset:2048
  ds_read_b128 v[224:227], v89 offset:7168
  ds_read_b128 v[244:247], v89 offset:12288
  ds_read_b128 v[208:211], v89 offset:3072
  ds_read_b128 v[228:231], v89 offset:8192
  ds_read_b128 v[248:251], v89 offset:13312
  ds_read_b128 v[212:215], v89 offset:4096
  ds_read_b128 v[232:235], v89 offset:9216
  ds_read_b128 v[252:255], v89 offset:14336
  s_or_b32 s7, s2, s6
  s_cmp_lg_u32 s7, 0
  s_cbranch_scc1 noep_28
  v_mov_b32 v2, s3
  v_mov_b32 v3, 0
  s_mov_b64 exec, 1
  buffer_store_dword v2, v3, s[8:11], s7 offen sc1
  s_mov_b64 exec, -1
noep_28:
  s_waitcnt lgkmcnt(15)
  v_pk_add_f32 v[28:29], v[28:29], v[30:31]
  v_pk_add_f32 v[32:33], v[32:33], v[34:35]
  s_mov_b32 s41, 0x3acccccd
  v_pk_add_f32 v[28:29], v[28:29], v[32:33]
  v_mul_f32 v28, s41, v28
  v_mul_f32 v29, s41, v29
  v_fma_f32 v29, -v28, v28, v29
  v_max_f32 v29, 0, v29
  v_cvt_pk_bf16_f32 v30, v28, v29
  v_and_b32 v31, 0xffff0000, v30
  v_lshlrev_b32 v30, 16, v30
  v_add_f32 v31, 0x3727c5ac, v31
  v_cvt_pk_bf16_f32 v31, v31, v31
  v_lshlrev_b32 v31, 16, v31
  v_sqrt_f32 v31, v31
  s_nop 0
  v_cvt_pk_bf16_f32 v31, v31, v31
  v_lshlrev_b32 v31, 16, v31
  v_rcp_f32 v6, v31
  v_sub_f32 v28, v28, v30
  s_add_u32 s43, s43, 4096
  buffer_load_dwordx4 a[68:71], v110, s[8:11], s43 offen offset:0 sc1
  v_mul_f32 v29, v29, v6
  v_mul_f32 v28, v28, v6
  v_mul_f32 v29, v29, v6
  v_cvt_pk_bf16_f32 v28, v28, v29
  v_and_b32 v29, 0xffff0000, v28
  v_lshlrev_b32 v28, 16, v28
  v_add_f32 v29, 0x3727c5ac, v29
  v_cvt_pk_bf16_f32 v29, v29, v29
  v_lshlrev_b32 v29, 16, v29
  v_sqrt_f32 v29, v29
  s_nop 0
  v_cvt_pk_bf16_f32 v29, v29, v29
  v_lshlrev_b32 v29, 16, v29
  ds_read_b64_tr_b16 v[100:101], v94 offset:0
  ds_read_b64_tr_b16 v[102:103], v95 offset:512
  ds_read_b64_tr_b16 v[104:105], v94 offset:1024
  ds_read_b64_tr_b16 v[106:107], v95 offset:1536
  ds_read_b64_tr_b16 v[108:109], v94 offset:2048
  v_mul_f32_e64 v7, -v30, v6
  v_fma_f32 v32, -v28, v31, -v30
  v_mul_f32 v33, v29, v31
  v_rcp_f32 v34, v33
  s_nop 0
  v_mul_f32 v35, v34, v34
  v_mul_f32 v35, 0xbdd2d3e8, v35
  buffer_load_dwordx4 a[72:75], v110, s[8:11], s43 offen offset:1024 sc1
  v_mul_f32 v35, v35, v34
  v_mul_f32 v34, 0xc0135761, v34
  s_waitcnt lgkmcnt(15)
  v_pk_add_f32 v[196:197], v[196:197], v[216:217]
  v_pk_add_f32 v[8:9], v[8:9], v[236:237]
  v_pk_add_f32 v[198:199], v[198:199], v[218:219]
  v_pk_add_f32 v[10:11], v[10:11], v[238:239]
  v_pk_fma_f32 v[196:197], v[60:61], v[32:33], v[196:197] op_sel_hi:[1,0,1]
  v_pk_fma_f32 v[198:199], v[62:63], v[32:33], v[198:199] op_sel_hi:[1,0,1]
  v_pk_add_f32 v[8:9], v[8:9], v[196:197]
  v_pk_add_f32 v[10:11], v[10:11], v[198:199]
  s_waitcnt lgkmcnt(14)
  v_pk_add_f32 v[200:201], v[200:201], v[220:221]
  v_pk_add_f32 v[12:13], v[12:13], v[240:241]
  v_pk_add_f32 v[202:203], v[202:203], v[222:223]
  v_pk_add_f32 v[14:15], v[14:15], v[242:243]
  v_pk_fma_f32 v[200:201], v[64:65], v[32:33], v[200:201] op_sel_hi:[1,0,1]
  v_pk_fma_f32 v[202:203], v[66:67], v[32:33], v[202:203] op_sel_hi:[1,0,1]
  v_pk_add_f32 v[12:13], v[12:13], v[200:201]
  v_pk_add_f32 v[14:15], v[14:15], v[202:203]
  s_waitcnt lgkmcnt(11)
  v_pk_add_f32 v[204:205], v[204:205], v[224:225]
  v_pk_add_f32 v[16:17], v[16:17], v[244:245]
  v_pk_add_f32 v[206:207], v[206:207], v[226:227]
  v_pk_add_f32 v[18:19], v[18:19], v[246:247]
  v_pk_fma_f32 v[204:205], v[68:69], v[32:33], v[204:205] op_sel_hi:[1,0,1]
  v_pk_fma_f32 v[206:207], v[70:71], v[32:33], v[206:207] op_sel_hi:[1,0,1]
  buffer_load_dwordx4 a[76:79], v110, s[8:11], s43 offen offset:2048 sc1
  v_pk_add_f32 v[16:17], v[16:17], v[204:205]
  v_pk_add_f32 v[18:19], v[18:19], v[206:207]
  s_waitcnt lgkmcnt(8)
  v_pk_add_f32 v[208:209], v[208:209], v[228:229]
  v_pk_add_f32 v[20:21], v[20:21], v[248:249]
  v_pk_add_f32 v[210:211], v[210:211], v[230:231]
  v_pk_add_f32 v[22:23], v[22:23], v[250:251]
  v_pk_fma_f32 v[208:209], v[72:73], v[32:33], v[208:209] op_sel_hi:[1,0,1]
  v_pk_fma_f32 v[210:211], v[74:75], v[32:33], v[210:211] op_sel_hi:[1,0,1]
  v_pk_add_f32 v[20:21], v[20:21], v[208:209]
  v_pk_add_f32 v[22:23], v[22:23], v[210:211]
  s_waitcnt lgkmcnt(5)
  v_pk_add_f32 v[212:213], v[212:213], v[232:233]
  v_pk_add_f32 v[24:25], v[24:25], v[252:253]
  v_pk_add_f32 v[214:215], v[214:215], v[234:235]
  v_pk_add_f32 v[26:27], v[26:27], v[254:255]
  v_pk_fma_f32 v[212:213], v[76:77], v[32:33], v[212:213] op_sel_hi:[1,0,1]
  v_pk_fma_f32 v[214:215], v[78:79], v[32:33], v[214:215] op_sel_hi:[1,0,1]
  v_pk_add_f32 v[24:25], v[24:25], v[212:213]
  v_pk_add_f32 v[26:27], v[26:27], v[214:215]
  s_waitcnt lgkmcnt(0)
  s_barrier
  v_pk_mul_f32 v[60:61], v[8:9], v[8:9]
  v_pk_mul_f32 v[62:63], v[10:11], v[10:11]
  v_pk_mul_f32 v[64:65], v[12:13], v[12:13]
  v_pk_mul_f32 v[66:67], v[14:15], v[14:15]
  v_pk_mul_f32 v[68:69], v[16:17], v[16:17]
  v_pk_mul_f32 v[70:71], v[18:19], v[18:19]
  buffer_load_dwordx4 a[80:83], v110, s[8:11], s43 offen offset:3072 sc1
  v_pk_mul_f32 v[72:73], v[20:21], v[20:21]
  v_pk_mul_f32 v[74:75], v[22:23], v[22:23]
  v_pk_mul_f32 v[76:77], v[24:25], v[24:25]
  v_pk_mul_f32 v[78:79], v[26:27], v[26:27]
  v_pk_fma_f32 v[60:61], v[60:61], v[34:35], v[34:35] op_sel:[0,1,0] op_sel_hi:[1,1,0]
  v_pk_fma_f32 v[62:63], v[62:63], v[34:35], v[34:35] op_sel:[0,1,0] op_sel_hi:[1,1,0]
  v_pk_fma_f32 v[64:65], v[64:65], v[34:35], v[34:35] op_sel:[0,1,0] op_sel_hi:[1,1,0]
  v_pk_fma_f32 v[66:67], v[66:67], v[34:35], v[34:35] op_sel:[0,1,0] op_sel_hi:[1,1,0]
  v_pk_fma_f32 v[68:69], v[68:69], v[34:35], v[34:35] op_sel:[0,1,0] op_sel_hi:[1,1,0]
  v_pk_fma_f32 v[70:71], v[70:71], v[34:35], v[34:35] op_sel:[0,1,0] op_sel_hi:[1,1,0]
  v_pk_fma_f32 v[72:73], v[72:73], v[34:35], v[34:35] op_sel:[0,1,0] op_sel_hi:[1,1,0]
  v_pk_fma_f32 v[74:75], v[74:75], v[34:35], v[34:35] op_sel:[0,1,0] op_sel_hi:[1,1,0]
  v_pk_fma_f32 v[76:77], v[76:77], v[34:35], v[34:35] op_sel:[0,1,0] op_sel_hi:[1,1,0]
  v_pk_fma_f32 v[78:79], v[78:79], v[34:35], v[34:35] op_sel:[0,1,0] op_sel_hi:[1,1,0]
  v_pk_mul_f32 v[60:61], v[60:61], v[8:9]
  v_pk_mul_f32 v[62:63], v[62:63], v[10:11]
  v_pk_mul_f32 v[64:65], v[64:65], v[12:13]
  v_pk_mul_f32 v[66:67], v[66:67], v[14:15]
  v_pk_mul_f32 v[68:69], v[68:69], v[16:17]
  v_pk_mul_f32 v[70:71], v[70:71], v[18:19]
  v_pk_mul_f32 v[72:73], v[72:73], v[20:21]
  v_pk_mul_f32 v[74:75], v[74:75], v[22:23]
  v_pk_mul_f32 v[76:77], v[76:77], v[24:25]
  v_pk_mul_f32 v[78:79], v[78:79], v[26:27]
  s_add_u32 s43, s43, 4096
  buffer_load_dwordx4 a[84:87], v110, s[8:11], s43 offen offset:0 sc1
  v_exp_f32 v60, v60
  v_exp_f32 v61, v61
  v_exp_f32 v62, v62
  v_exp_f32 v63, v63
  v_exp_f32 v64, v64
  v_exp_f32 v65, v65
  buffer_load_dwordx4 a[88:91], v110, s[8:11], s43 offen offset:1024 sc1
  v_exp_f32 v66, v66
  v_exp_f32 v67, v67
  v_exp_f32 v68, v68
  v_exp_f32 v69, v69
  v_exp_f32 v70, v70
  v_exp_f32 v71, v71
  buffer_load_dwordx4 a[92:95], v110, s[8:11], s43 offen offset:2048 sc1
  v_exp_f32 v72, v72
  v_exp_f32 v73, v73
  v_exp_f32 v74, v74
  v_exp_f32 v75, v75
  v_exp_f32 v76, v76
  v_exp_f32 v77, v77
  buffer_load_dwordx4 a[96:99], v110, s[8:11], s43 offen offset:3072 sc1
  v_exp_f32 v78, v78
  v_exp_f32 v79, v79
  v_pk_fma_f32 v[60:61], v[60:61], v[32:33], v[32:33] op_sel:[0,1,1] op_sel_hi:[1,1,1]
  v_pk_fma_f32 v[62:63], v[62:63], v[32:33], v[32:33] op_sel:[0,1,1] op_sel_hi:[1,1,1]
  v_pk_fma_f32 v[64:65], v[64:65], v[32:33], v[32:33] op_sel:[0,1,1] op_sel_hi:[1,1,1]
  v_pk_fma_f32 v[66:67], v[66:67], v[32:33], v[32:33] op_sel:[0,1,1] op_sel_hi:[1,1,1]
  v_pk_fma_f32 v[68:69], v[68:69], v[32:33], v[32:33] op_sel:[0,1,1] op_sel_hi:[1,1,1]
  v_pk_fma_f32 v[70:71], v[70:71], v[32:33], v[32:33] op_sel:[0,1,1] op_sel_hi:[1,1,1]
  v_pk_fma_f32 v[72:73], v[72:73], v[32:33], v[32:33] op_sel:[0,1,1] op_sel_hi:[1,1,1]
  v_pk_fma_f32 v[74:75], v[74:75], v[32:33], v[32:33] op_sel:[0,1,1] op_sel_hi:[1,1,1]
  v_pk_fma_f32 v[76:77], v[76:77], v[32:33], v[32:33] op_sel:[0,1,1] op_sel_hi:[1,1,1]
  v_pk_fma_f32 v[78:79], v[78:79], v[32:33], v[32:33] op_sel:[0,1,1] op_sel_hi:[1,1,1]
  v_rcp_f32 v60, v60
  v_rcp_f32 v61, v61
  v_rcp_f32 v62, v62
  v_rcp_f32 v63, v63
  v_rcp_f32 v64, v64
  v_rcp_f32 v65, v65
  v_rcp_f32 v66, v66
  v_rcp_f32 v67, v67
  v_rcp_f32 v68, v68
  v_rcp_f32 v69, v69
  v_rcp_f32 v70, v70
  v_rcp_f32 v71, v71
  v_rcp_f32 v72, v72
  v_rcp_f32 v73, v73
  v_rcp_f32 v74, v74
  v_rcp_f32 v75, v75
  v_rcp_f32 v76, v76
  v_rcp_f32 v77, v77
  v_rcp_f32 v78, v78
  v_rcp_f32 v79, v79
  s_lshl_b32 s40, s98, 2
  s_add_u32 s40, s40, s6
  s_mul_i32 s40, s40, 20480
  s_mul_i32 s41, s91, 5120
  s_add_u32 s36, s40, s41
  s_add_u32 s40, s36, 524288
  s_mul_i32 s41, s90, 3072
  s_add_u32 s41, s41, s40
  s_lshl_b32 s42, s90, 3
  s_add_u32 s42, s42, s40
  s_lshl_b32 s43, s96, 9
  s_add_u32 s43, s43, 262144
  s_mov_b32 s44, 0xc000c000
  s_bitcmp1_b32 s91, 0
  s_cselect_b32 s44, 0x00030003, s44
  s_cselect_b32 s45, 0, 3
  v_lshrrev_b32 v1, 4, v0
  v_lshlrev_b32 v1, 5, v1
  v_and_b32 v2, 1, v0
  v_lshlrev_b32 v2, 4, v2
  s_cmp_eq_u32 s6, s45
  s_cselect_b32 s45, 0, 0x80000000
  v_add3_u32 v1, v1, v2, s45
  v_pk_mul_f32 v[60:61], v[60:61], v[8:9]
  v_pk_mul_f32 v[62:63], v[62:63], v[10:11]
  v_pk_mul_f32 v[64:65], v[64:65], v[12:13]
  v_pk_mul_f32 v[66:67], v[66:67], v[14:15]
  v_pk_mul_f32 v[68:69], v[68:69], v[16:17]
  v_pk_mul_f32 v[70:71], v[70:71], v[18:19]
  v_pk_mul_f32 v[72:73], v[72:73], v[20:21]
  v_pk_mul_f32 v[74:75], v[74:75], v[22:23]
  v_pk_mul_f32 v[76:77], v[76:77], v[24:25]
  v_pk_mul_f32 v[78:79], v[78:79], v[26:27]
  v_cvt_pk_bf16_f32 v48, v60, v61
  v_cvt_pk_bf16_f32 v49, v62, v63
  v_cvt_pk_bf16_f32 v50, v64, v65
  v_cvt_pk_bf16_f32 v51, v66, v67
  v_cvt_pk_bf16_f32 v52, v68, v69
  v_cvt_pk_bf16_f32 v53, v70, v71
  v_cvt_pk_bf16_f32 v54, v72, v73
  v_cvt_pk_bf16_f32 v55, v74, v75
  v_cvt_pk_bf16_f32 v56, v76, v77
  v_cvt_pk_bf16_f32 v57, v78, v79
  buffer_store_dwordx4 v[48:51], v110, s[12:15], s41 offen
  buffer_store_dwordx4 v[48:51], v110, s[16:19], s41 offen sc1
  buffer_store_dwordx4 v[52:55], v110, s[12:15], s41 offen offset:1024
  buffer_store_dwordx4 v[52:55], v110, s[16:19], s41 offen offset:1024 sc1
  buffer_store_dwordx2 v[56:57], v110, s[12:15], s42 offen offset:2048
  buffer_store_dwordx2 v[56:57], v110, s[16:19], s42 offen offset:2048 sc1
  v_mov_b32 v60, v51
  v_mov_b32 v61, v55
  v_mov_b32 v63, s3
  v_mov_b32 v59, s3
  v_mov_b32 v51, s3
  v_mov_b32 v55, s3
  s_mov_b32 exec_lo, s44
  s_mov_b32 exec_hi, s44
  buffer_store_dwordx4 v[48:51], v1, s[8:11], s43 offen offset:0 sc1
  buffer_store_dwordx4 v[52:55], v1, s[8:11], s43 offen offset:128 sc1
  buffer_store_dwordx4 v[56:59], v1, s[8:11], s43 offen offset:256 sc1
  buffer_store_dwordx4 v[60:63], v1, s[8:11], s43 offen offset:384 sc1
  s_mov_b64 exec, -1
  s_mov_b32 s41, 0xffff0000
  v_lshlrev_b32 v8, 16, v100
  v_and_b32 v9, s41, v100
  v_lshlrev_b32 v10, 16, v101
  v_and_b32 v11, s41, v101
  v_lshlrev_b32 v12, 16, v102
  v_and_b32 v13, s41, v102
  v_lshlrev_b32 v14, 16, v103
  v_and_b32 v15, s41, v103
  v_lshlrev_b32 v16, 16, v104
  v_and_b32 v17, s41, v104
  v_lshlrev_b32 v18, 16, v105
  v_and_b32 v19, s41, v105
  v_lshlrev_b32 v20, 16, v106
  v_and_b32 v21, s41, v106
  v_lshlrev_b32 v22, 16, v107
  v_and_b32 v23, s41, v107
  v_lshlrev_b32 v24, 16, v108
  v_and_b32 v25, s41, v108
  v_lshlrev_b32 v26, 16, v109
  v_and_b32 v27, s41, v109
  v_pk_fma_f32 v[8:9], v[8:9], v[6:7], v[6:7] op_sel:[0,0,1] op_sel_hi:[1,0,1]
  v_pk_fma_f32 v[10:11], v[10:11], v[6:7], v[6:7] op_sel:[0,0,1] op_sel_hi:[1,0,1]
  v_pk_fma_f32 v[12:13], v[12:13], v[6:7], v[6:7] op_sel:[0,0,1] op_sel_hi:[1,0,1]
  v_pk_fma_f32 v[14:15], v[14:15], v[6:7], v[6:7] op_sel:[0,0,1] op_sel_hi:[1,0,1]
  v_pk_fma_f32 v[16:17], v[16:17], v[6:7], v[6:7] op_sel:[0,0,1] op_sel_hi:[1,0,1]
  v_pk_fma_f32 v[18:19], v[18:19], v[6:7], v[6:7] op_sel:[0,0,1] op_sel_hi:[1,0,1]
  v_pk_fma_f32 v[20:21], v[20:21], v[6:7], v[6:7] op_sel:[0,0,1] op_sel_hi:[1,0,1]
  v_pk_fma_f32 v[22:23], v[22:23], v[6:7], v[6:7] op_sel:[0,0,1] op_sel_hi:[1,0,1]
  v_pk_fma_f32 v[24:25], v[24:25], v[6:7], v[6:7] op_sel:[0,0,1] op_sel_hi:[1,0,1]
  v_pk_fma_f32 v[26:27], v[26:27], v[6:7], v[6:7] op_sel:[0,0,1] op_sel_hi:[1,0,1]
  s_lshl_b32 s40, s96, 5
  s_add_u32 s40, s40, s6
  s_lshl_b32 s40, s40, 2
  s_add_u32 s40, s40, 98304
  s_waitcnt vmcnt(4)
  v_mov_b32 v2, s3
  v_mov_b32 v3, 0
  s_mov_b64 exec, 1
  buffer_store_dword v2, v3, s[12:15], s40 offen
  buffer_store_dword v2, v3, s[16:19], s40 offen sc1
  s_mov_b64 exec, -1
  s_mov_b32 s40, 98304
  s_mov_b32 s97, 0x20000
  buffer_load_dword v1, v111, s[8:11], s40 offen sc1
  s_lshr_b32 s41, s6, 1
  s_mul_i32 s45, s41, 5120
  s_add_u32 s45, s45, 148736
  s_add_u32 s41, s41, 1
  s_sub_u32 s42, 16, s41
  s_add_u32 s43, 16, s41
  s_mul_i32 s37, s6, 20480
  s_bitcmp1_b32 s6, 0
  s_cselect_b32 s43, s43, s42
  s_cselect_b32 s44, 1, -1
  s_mov_b32 s46, 0xaaaa
  s_cselect_b32 s46, 0x5555, s46
  s_cselect_b32 s47, 0, 14
  s_cmp_ge_u32 s6, 2
  s_cselect_b32 s38, 0xffff, s46
  s_mov_b32 s39, 0
  v_and_b32 v3, 15, v0
  v_add_u32 v3, s43, v3
  v_lshrrev_b32 v4, 4, v3
  v_cmp_ne_u32 vcc, 1, v4
  v_and_b32 v3, 15, v3
  v_lshlrev_b32 v3, 4, v3
  v_lshrrev_b32 v5, 4, v0
  v_lshl_add_u32 v3, v5, 8, v3
  s_mul_i32 s41, s24, 5120
  s_add_u32 s41, s41, s37
  s_add_u32 s42, s24, s44
  s_mul_i32 s43, s42, 5120
  s_add_u32 s43, s43, s37
  s_cmp_lt_u32 s42, 4
  s_cselect_b32 s43, s43, s45
  v_add_u32 v60, s41, v3
  v_add_u32 v4, s43, v3
  v_cndmask_b32 v60, v60, v4, vcc
  s_mul_i32 s41, s25, 5120
  s_add_u32 s41, s41, s37
  s_add_u32 s42, s25, s44
  s_mul_i32 s43, s42, 5120
  s_add_u32 s43, s43, s37
  s_cmp_lt_u32 s42, 4
  s_cselect_b32 s43, s43, s45
  v_add_u32 v61, s41, v3
  v_add_u32 v4, s43, v3
  v_cndmask_b32 v61, v61, v4, vcc
  s_mul_i32 s41, s26, 5120
  s_add_u32 s41, s41, s37
  s_add_u32 s42, s26, s44
  s_mul_i32 s43, s42, 5120
  s_add_u32 s43, s43, s37
  s_cmp_lt_u32 s42, 4
  s_cselect_b32 s43, s43, s45
  v_add_u32 v62, s41, v3
  v_add_u32 v4, s43, v3
  v_cndmask_b32 v62, v62, v4, vcc
  s_mul_i32 s41, s27, 5120
  s_add_u32 s41, s41, s37
  s_add_u32 s42, s27, s44
  s_mul_i32 s43, s42, 5120
  s_add_u32 s43, s43, s37
  s_cmp_lt_u32 s42, 4
  s_cselect_b32 s43, s43, s45
  v_add_u32 v63, s41, v3
  v_add_u32 v4, s43, v3
  v_cndmask_b32 v63, v63, v4, vcc
  s_mul_i32 s41, s98, 81920
  s_mul_i32 s42, s6, 5120
  s_add_u32 s41, s41, s42
  s_add_u32 s28, s41, 524288
  s_add_u32 s29, s41, 544768
  s_add_u32 s30, s41, 565248
  s_add_u32 s31, s41, 585728
  s_add_u32 s44, s98, s44
  s_cmp_lt_u32 s44, 32
  s_cselect_b32 s46, s3, 0
  s_cselect_b32 s41, 0, 0x80000000
  s_lshl_b32 s44, s44, 2
  s_add_u32 s44, s44, s6
  s_lshl_b32 s44, s44, 10
  s_add_u32 s44, s44, 262144
  s_and_b32 s44, s44, 0xffffff
  s_or_b32 s44, s44, s41
  v_and_b32 v4, 7, v0
  v_lshlrev_b32 v4, 4, v4
  v_and_b32 v5, 8, v0
  v_lshlrev_b32 v84, 6, v5
  v_add_u32 v4, v4, v84
  v_add_u32 v4, s44, v4
  v_lshrrev_b32 v84, 1, v0
  v_and_b32 v84, 3, v84
  v_lshlrev_b32 v84, 4, v84
  v_and_b32 v85, 1, v0
  v_add_u32 v84, v84, v85
  v_add_u32 v84, s47, v84
  v_lshlrev_b32 v84, 4, v84
  v_add_u32 v84, s45, v84
  v_add_u32 v85, v84, v5
  v_mul_u32_u24 v5, 384, v5
  v_add_u32 v84, v84, v5
  s_branch polle_30
poll_29:
  s_sub_u32 s97, s97, 1
  s_cbranch_scc1 END
  buffer_load_dword v1, v111, s[8:11], s40 offen sc1
polle_30:
  s_waitcnt vmcnt(0)
  v_cmp_ne_u32 vcc, s3, v1
  s_nop 1
  s_cbranch_vccnz poll_29
  s_add_u32 m0, s37, 0
  s_nop 0
  buffer_load_dwordx4 v110, s[8:11], s28 offen offset:0 sc1 lds
  s_add_u32 m0, s37, 5120
  s_nop 0
  buffer_load_dwordx4 v110, s[8:11], s29 offen offset:0 sc1 lds
  s_add_u32 m0, s37, 10240
  s_nop 0
  buffer_load_dwordx4 v110, s[8:11], s30 offen offset:0 sc1 lds
  s_add_u32 m0, s37, 15360
  s_nop 0
  buffer_load_dwordx4 v110, s[8:11], s31 offen offset:0 sc1 lds
  buffer_load_dwordx4 v[64:67], v4, s[8:11], 0 offen offset:0 sc1
  buffer_load_dwordx4 v[68:71], v4, s[8:11], 0 offen offset:128 sc1
  buffer_load_dwordx4 v[72:75], v4, s[8:11], 0 offen offset:256 sc1
  buffer_load_dwordx4 v[76:79], v4, s[8:11], 0 offen offset:384 sc1
  s_add_u32 m0, s37, 0
  s_nop 0
  buffer_load_dwordx4 v110, s[8:11], s28 offen offset:1024 sc1 lds
  s_add_u32 m0, s37, 5120
  s_nop 0
  buffer_load_dwordx4 v110, s[8:11], s29 offen offset:1024 sc1 lds
  s_add_u32 m0, s37, 10240
  s_nop 0
  buffer_load_dwordx4 v110, s[8:11], s30 offen offset:1024 sc1 lds
  s_add_u32 m0, s37, 15360
  s_nop 0
  buffer_load_dwordx4 v110, s[8:11], s31 offen offset:1024 sc1 lds
  s_add_u32 m0, s37, 0
  s_nop 0
  buffer_load_dwordx4 v110, s[8:11], s28 offen offset:2048 sc1 lds
  s_add_u32 m0, s37, 5120
  s_nop 0
  buffer_load_dwordx4 v110, s[8:11], s29 offen offset:2048 sc1 lds
  s_add_u32 m0, s37, 10240
  s_nop 0
  buffer_load_dwordx4 v110, s[8:11], s30 offen offset:2048 sc1 lds
  s_add_u32 m0, s37, 15360
  s_nop 0
  buffer_load_dwordx4 v110, s[8:11], s31 offen offset:2048 sc1 lds
  s_waitcnt vmcnt(12)
  ds_read_b128 v[28:31], v60 offset:0
  ds_read_b128 v[32:35], v62 offset:0
  s_waitcnt lgkmcnt(1)
  v_mfma_f32_16x16x32_bf16 v[196:199], a[100:103], v[28:31], 0
  v_mfma_f32_16x16x32_bf16 v[200:203], a[104:107], v[28:31], 0
  s_add_u32 m0, s37, 0
  s_nop 0
  buffer_load_dwordx4 v110, s[8:11], s28 offen offset:3072 sc1 lds
  v_mfma_f32_16x16x32_bf16 v[204:207], a[108:111], v[28:31], 0
  v_mfma_f32_16x16x32_bf16 v[208:211], a[112:115], v[28:31], 0
  s_add_u32 m0, s37, 5120
  s_nop 0
  buffer_load_dwordx4 v110, s[8:11], s29 offen offset:3072 sc1 lds
  v_mfma_f32_16x16x32_bf16 v[212:215], a[116:119], v[28:31], 0
  s_waitcnt lgkmcnt(0)
  v_mfma_f32_16x16x32_bf16 v[236:239], a[100:103], v[32:35], 0
  s_add_u32 m0, s37, 10240
  s_nop 0
  buffer_load_dwordx4 v110, s[8:11], s30 offen offset:3072 sc1 lds
  v_mfma_f32_16x16x32_bf16 v[240:243], a[104:107], v[32:35], 0
  v_mfma_f32_16x16x32_bf16 v[244:247], a[108:111], v[32:35], 0
  s_add_u32 m0, s37, 15360
  s_nop 0
  buffer_load_dwordx4 v110, s[8:11], s31 offen offset:3072 sc1 lds
  v_mfma_f32_16x16x32_bf16 v[248:251], a[112:115], v[32:35], 0
  v_mfma_f32_16x16x32_bf16 v[252:255], a[116:119], v[32:35], 0
  s_waitcnt vmcnt(8)
  ds_read_b128 v[36:39], v60 offset:1024
  ds_read_b128 v[40:43], v62 offset:1024
  s_add_u32 m0, s37, 4096
  s_add_u32 s28, s28, 4096
  buffer_load_dwordx4 v110, s[8:11], s28 offen offset:0 sc1 lds
  s_waitcnt lgkmcnt(1)
  v_mfma_f32_16x16x32_bf16 v[196:199], a[120:123], v[36:39], v[196:199]
  v_mfma_f32_16x16x32_bf16 v[200:203], a[124:127], v[36:39], v[200:203]
  s_add_u32 m0, s37, 9216
  s_add_u32 s29, s29, 4096
  buffer_load_dwordx4 v110, s[8:11], s29 offen offset:0 sc1 lds
  v_mfma_f32_16x16x32_bf16 v[204:207], a[128:131], v[36:39], v[204:207]
  v_mfma_f32_16x16x32_bf16 v[208:211], a[132:135], v[36:39], v[208:211]
  s_add_u32 m0, s37, 14336
  s_add_u32 s30, s30, 4096
  buffer_load_dwordx4 v110, s[8:11], s30 offen offset:0 sc1 lds
  v_mfma_f32_16x16x32_bf16 v[212:215], a[136:139], v[36:39], v[212:215]
  s_waitcnt lgkmcnt(0)
  v_mfma_f32_16x16x32_bf16 v[236:239], a[120:123], v[40:43], v[236:239]
  s_add_u32 m0, s37, 19456
  s_add_u32 s31, s31, 4096
  buffer_load_dwordx4 v110, s[8:11], s31 offen offset:0 sc1 lds
  v_mfma_f32_16x16x32_bf16 v[240:243], a[124:127], v[40:43], v[240:243]
  v_mfma_f32_16x16x32_bf16 v[244:247], a[128:131], v[40:43], v[244:247]
  v_mfma_f32_16x16x32_bf16 v[248:251], a[132:135], v[40:43], v[248:251]
  v_mfma_f32_16x16x32_bf16 v[252:255], a[136:139], v[40:43], v[252:255]
  s_mov_b32 s97, 0x20000
hchk_31:
  v_xor_b32 v67, s46, v67
  v_xor_b32 v71, s46, v71
  v_xor_b32 v75, s46, v75
  v_xor_b32 v79, s46, v79
  v_or3_b32 v67, v67, v71, v75
  v_or_b32 v67, v67, v79
  v_cmp_ne_u32 vcc, 0, v67
  s_nop 1
  s_cbranch_vccz hok_32
  s_sub_u32 s97, s97, 1
  s_cbranch_scc1 END
  buffer_load_dwordx4 v[64:67], v4, s[8:11], 0 offen offset:0 sc1
  buffer_load_dwordx4 v[68:71], v4, s[8:11], 0 offen offset:128 sc1
  buffer_load_dwordx4 v[72:75], v4, s[8:11], 0 offen offset:256 sc1
  buffer_load_dwordx4 v[76:79], v4, s[8:11], 0 offen offset:384 sc1
  s_waitcnt vmcnt(0)
  s_branch hchk_31
hok_32:
  v_mov_b32 v67, v76
  v_mov_b32 v71, v77
  s_mov_b64 exec, s[38:39]
  ds_write_b128 v84, v[64:67]
  ds_write_b128 v84, v[68:71] offset:1024
  ds_write_b64 v85, v[72:73] offset:2048
  s_mov_b64 exec, -1
  ds_read_b128 v[44:47], v61 offset:0
  ds_read_b128 v[48:51], v63 offset:0
  ds_read_b128 v[52:55], v61 offset:1024
  ds_read_b128 v[56:59], v63 offset:1024
  s_waitcnt lgkmcnt(3)
  v_mfma_f32_16x16x32_bf16 v[216:219], a[100:103], v[44:47], 0
  s_waitcnt vmcnt(8)
  ds_read_b128 v[28:31], v60 offset:2048
  v_mfma_f32_16x16x32_bf16 v[220:223], a[104:107], v[44:47], 0
  v_mfma_f32_16x16x32_bf16 v[224:227], a[108:111], v[44:47], 0
  v_mfma_f32_16x16x32_bf16 v[228:231], a[112:115], v[44:47], 0
  v_mfma_f32_16x16x32_bf16 v[232:235], a[116:119], v[44:47], 0
  s_waitcnt lgkmcnt(3)
  v_mfma_f32_16x16x32_bf16 v[8:11], a[100:103], v[48:51], v[8:11]
  ds_read_b128 v[32:35], v62 offset:2048
  v_mfma_f32_16x16x32_bf16 v[12:15], a[104:107], v[48:51], v[12:15]
  v_mfma_f32_16x16x32_bf16 v[16:19], a[108:111], v[48:51], v[16:19]
  v_mfma_f32_16x16x32_bf16 v[20:23], a[112:115], v[48:51], v[20:23]
  buffer_load_dwordx4 a[100:103], v110, s[8:11], s101 offen offset:0 sc1
  v_mfma_f32_16x16x32_bf16 v[24:27], a[116:119], v[48:51], v[24:27]
  s_waitcnt lgkmcnt(3)
  v_mfma_f32_16x16x32_bf16 v[216:219], a[120:123], v[52:55], v[216:219]
  ds_read_b128 v[36:39], v61 offset:2048
  v_mfma_f32_16x16x32_bf16 v[220:223], a[124:127], v[52:55], v[220:223]
  v_mfma_f32_16x16x32_bf16 v[224:227], a[128:131], v[52:55], v[224:227]
  buffer_load_dwordx4 a[104:107], v110, s[8:11], s101 offen offset:1024 sc1
  v_mfma_f32_16x16x32_bf16 v[228:231], a[132:135], v[52:55], v[228:231]
  v_mfma_f32_16x16x32_bf16 v[232:235], a[136:139], v[52:55], v[232:235]
  s_waitcnt lgkmcnt(3)
  v_mfma_f32_16x16x32_bf16 v[8:11], a[120:123], v[56:59], v[8:11]
  ds_read_b128 v[40:43], v63 offset:2048
  v_mfma_f32_16x16x32_bf16 v[12:15], a[124:127], v[56:59], v[12:15]
  buffer_load_dwordx4 a[108:111], v110, s[8:11], s101 offen offset:2048 sc1
  v_mfma_f32_16x16x32_bf16 v[16:19], a[128:131], v[56:59], v[16:19]
  v_mfma_f32_16x16x32_bf16 v[20:23], a[132:135], v[56:59], v[20:23]
  v_mfma_f32_16x16x32_bf16 v[24:27], a[136:139], v[56:59], v[24:27]
  s_waitcnt lgkmcnt(3)
  v_mfma_f32_16x16x32_bf16 v[196:199], a[140:143], v[28:31], v[196:199]
  s_waitcnt vmcnt(7)
  ds_read_b128 v[44:47], v60 offset:3072
  buffer_load_dwordx4 a[112:115], v110, s[8:11], s101 offen offset:3072 sc1
  v_mfma_f32_16x16x32_bf16 v[200:203], a[144:147], v[28:31], v[200:203]
  v_mfma_f32_16x16x32_bf16 v[204:207], a[148:151], v[28:31], v[204:207]
  v_mfma_f32_16x16x32_bf16 v[208:211], a[152:155], v[28:31], v[208:211]
  v_mfma_f32_16x16x32_bf16 v[212:215], a[156:159], v[28:31], v[212:215]
  s_add_u32 s101, s101, 4096
  buffer_load_dwordx4 a[116:119], v110, s[8:11], s101 offen offset:0 sc1
  s_waitcnt lgkmcnt(3)
  v_mfma_f32_16x16x32_bf16 v[236:239], a[140:143], v[32:35], v[236:239]
  s_waitcnt vmcnt(5)
  ds_read_b128 v[48:51], v60 offset:4096
  v_mfma_f32_16x16x32_bf16 v[240:243], a[144:147], v[32:35], v[240:243]
  v_mfma_f32_16x16x32_bf16 v[244:247], a[148:151], v[32:35], v[244:247]
  v_mfma_f32_16x16x32_bf16 v[248:251], a[152:155], v[32:35], v[248:251]
  buffer_load_dwordx4 a[120:123], v110, s[8:11], s101 offen offset:1024 sc1
  v_mfma_f32_16x16x32_bf16 v[252:255], a[156:159], v[32:35], v[252:255]
  s_waitcnt lgkmcnt(3)
  v_mfma_f32_16x16x32_bf16 v[216:219], a[140:143], v[36:39], v[216:219]
  ds_read_b128 v[52:55], v61 offset:3072
  v_mfma_f32_16x16x32_bf16 v[220:223], a[144:147], v[36:39], v[220:223]
  v_mfma_f32_16x16x32_bf16 v[224:227], a[148:151], v[36:39], v[224:227]
  buffer_load_dwordx4 a[124:127], v110, s[8:11], s101 offen offset:2048 sc1
  v_mfma_f32_16x16x32_bf16 v[228:231], a[152:155], v[36:39], v[228:231]
  v_mfma_f32_16x16x32_bf16 v[232:235], a[156:159], v[36:39], v[232:235]
  s_waitcnt lgkmcnt(3)
  v_mfma_f32_16x16x32_bf16 v[8:11], a[140:143], v[40:43], v[8:11]
  ds_read_b128 v[56:59], v61 offset:4096
  v_mfma_f32_16x16x32_bf16 v[12:15], a[144:147], v[40:43], v[12:15]
  buffer_load_dwordx4 a[128:131], v110, s[8:11], s101 offen offset:3072 sc1
  v_mfma_f32_16x16x32_bf16 v[16:19], a[148:151], v[40:43], v[16:19]
  v_mfma_f32_16x16x32_bf16 v[20:23], a[152:155], v[40:43], v[20:23]
  v_mfma_f32_16x16x32_bf16 v[24:27], a[156:159], v[40:43], v[24:27]
  s_waitcnt lgkmcnt(3)
  v_mfma_f32_16x16x32_bf16 v[196:199], a[160:163], v[44:47], v[196:199]
  ds_read_b128 v[28:31], v62 offset:3072
  s_add_u32 s101, s101, 4096
  buffer_load_dwordx4 a[132:135], v110, s[8:11], s101 offen offset:0 sc1
  v_mfma_f32_16x16x32_bf16 v[200:203], a[164:167], v[44:47], v[200:203]
  v_mfma_f32_16x16x32_bf16 v[204:207], a[168:171], v[44:47], v[204:207]
  v_mfma_f32_16x16x32_bf16 v[208:211], a[172:175], v[44:47], v[208:211]
  v_mfma_f32_16x16x32_bf16 v[212:215], a[176:179], v[44:47], v[212:215]
  buffer_load_dwordx4 a[136:139], v110, s[8:11], s101 offen offset:1024 sc1
  s_waitcnt lgkmcnt(3)
  v_mfma_f32_16x16x32_bf16 v[196:199], a[180:183], v[48:51], v[196:199]
  ds_read_b128 v[32:35], v62 offset:4096
  v_mfma_f32_16x16x32_bf16 v[200:203], a[184:187], v[48:51], v[200:203]
  v_mfma_f32_16x16x32_bf16 v[204:207], a[188:191], v[48:51], v[204:207]
  v_mfma_f32_16x16x32_bf16 v[208:211], a[192:195], v[48:51], v[208:211]
  buffer_load_dwordx4 a[140:143], v110, s[8:11], s101 offen offset:2048 sc1
  v_mfma_f32_16x16x32_bf16 v[212:215], a[196:199], v[48:51], v[212:215]
  s_waitcnt lgkmcnt(3)
  v_mfma_f32_16x16x32_bf16 v[216:219], a[160:163], v[52:55], v[216:219]
  ds_read_b128 v[36:39], v63 offset:3072
  v_mfma_f32_16x16x32_bf16 v[220:223], a[164:167], v[52:55], v[220:223]
  ds_write_b128 v86, v[196:199] offset:0
  v_mfma_f32_16x16x32_bf16 v[224:227], a[168:171], v[52:55], v[224:227]
  buffer_load_dwordx4 a[144:147], v110, s[8:11], s101 offen offset:3072 sc1
  ds_write_b128 v86, v[200:203] offset:1024
  v_mfma_f32_16x16x32_bf16 v[228:231], a[172:175], v[52:55], v[228:231]
  ds_write_b128 v86, v[204:207] offset:2048
  v_mfma_f32_16x16x32_bf16 v[232:235], a[176:179], v[52:55], v[232:235]
  ds_write_b128 v86, v[208:211] offset:3072
  s_waitcnt lgkmcnt(7)
  v_mfma_f32_16x16x32_bf16 v[216:219], a[180:183], v[56:59], v[216:219]
  ds_read_b128 v[40:43], v63 offset:4096
  v_mfma_f32_16x16x32_bf16 v[220:223], a[184:187], v[56:59], v[220:223]
  s_add_u32 s101, s101, 4096
  buffer_load_dwordx4 a[148:151], v110, s[8:11], s101 offen offset:0 sc1
  ds_write_b128 v86, v[212:215] offset:4096
  v_mfma_f32_16x16x32_bf16 v[224:227], a[188:191], v[56:59], v[224:227]
  v_mfma_f32_16x16x32_bf16 v[228:231], a[192:195], v[56:59], v[228:231]
  v_mfma_f32_16x16x32_bf16 v[232:235], a[196:199], v[56:59], v[232:235]
  s_waitcnt lgkmcnt(8)
  v_mfma_f32_16x16x32_bf16 v[236:239], a[160:163], v[28:31], v[236:239]
  buffer_load_dwordx4 a[152:155], v110, s[8:11], s101 offen offset:1024 sc1
  v_mfma_f32_16x16x32_bf16 v[240:243], a[164:167], v[28:31], v[240:243]
  ds_write_b128 v87, v[216:219] offset:0
  v_mfma_f32_16x16x32_bf16 v[244:247], a[168:171], v[28:31], v[244:247]
  ds_write_b128 v87, v[220:223] offset:1024
  v_mfma_f32_16x16x32_bf16 v[248:251], a[172:175], v[28:31], v[248:251]
  ds_write_b128 v87, v[224:227] offset:2048
  v_mfma_f32_16x16x32_bf16 v[252:255], a[176:179], v[28:31], v[252:255]
  buffer_load_dwordx4 a[156:159], v110, s[8:11], s101 offen offset:2048 sc1
  ds_write_b128 v87, v[228:231] offset:3072
  s_waitcnt lgkmcnt(11)
  v_mfma_f32_16x16x32_bf16 v[236:239], a[180:183], v[32:35], v[236:239]
  v_mfma_f32_16x16x32_bf16 v[240:243], a[184:187], v[32:35], v[240:243]
  ds_write_b128 v87, v[232:235] offset:4096
  v_mfma_f32_16x16x32_bf16 v[244:247], a[188:191], v[32:35], v[244:247]
  v_mfma_f32_16x16x32_bf16 v[248:251], a[192:195], v[32:35], v[248:251]
  v_mfma_f32_16x16x32_bf16 v[252:255], a[196:199], v[32:35], v[252:255]
  s_waitcnt lgkmcnt(11)
  v_mfma_f32_16x16x32_bf16 v[8:11], a[160:163], v[36:39], v[8:11]
  v_mfma_f32_16x16x32_bf16 v[12:15], a[164:167], v[36:39], v[12:15]
  ds_write_b128 v88, v[236:239] offset:0
  v_mfma_f32_16x16x32_bf16 v[16:19], a[168:171], v[36:39], v[16:19]
  buffer_load_dwordx4 a[160:163], v110, s[8:11], s101 offen offset:3072 sc1
  ds_write_b128 v88, v[240:243] offset:1024
  v_mfma_f32_16x16x32_bf16 v[20:23], a[172:175], v[36:39], v[20:23]
  ds_write_b128 v88, v[244:247] offset:2048
  v_mfma_f32_16x16x32_bf16 v[24:27], a[176:179], v[36:39], v[24:27]
  ds_write_b128 v88, v[248:251] offset:3072
  s_waitcnt lgkmcnt(10)
  v_mfma_f32_16x16x32_bf16 v[8:11], a[180:183], v[40:43], v[8:11]
  v_mfma_f32_16x16x32_bf16 v[12:15], a[184:187], v[40:43], v[12:15]
  s_add_u32 s101, s101, 4096
  buffer_load_dwordx4 a[164:167], v110, s[8:11], s101 offen offset:0 sc1
  ds_write_b128 v88, v[252:255] offset:4096
  v_mfma_f32_16x16x32_bf16 v[16:19], a[188:191], v[40:43], v[16:19]
  v_mfma_f32_16x16x32_bf16 v[20:23], a[192:195], v[40:43], v[20:23]
  v_mfma_f32_16x16x32_bf16 v[24:27], a[196:199], v[40:43], v[24:27]
  s_add_u32 s40, s36, 3145728
  s_lshl_b32 s41, s90, 11
  s_add_u32 s41, s41, s40
  s_lshl_b32 s42, s90, 3
  s_add_u32 s42, s42, s40
  s_add_u32 s42, s42, 4096
  s_lshl_b32 s43, s98, 2
  s_add_u32 s43, s43, s6
  s_lshl_b32 s43, s43, 3
  s_add_u32 s43, s43, s99
  s_lshl_b32 s43, s43, 7
  s_add_u32 s43, s43, 5767168
  v_mov_b32 v1, 0x3f803f80
  v_and_b32 v6, 15, v0
  v_lshlrev_b32 v6, 3, v6
  v_mov_b32 v2, 0
  v_mov_b32 v3, 0
  v_mov_b32 v4, 0
  v_mov_b32 v5, 0
  s_waitcnt lgkmcnt(0)
  s_barrier
  ds_read_b128 v[196:199], v89 offset:0
  ds_read_b128 v[216:219], v89 offset:5120
  ds_read_b128 v[236:239], v89 offset:10240
  ds_read_b128 v[200:203], v89 offset:1024
  ds_read_b128 v[220:223], v89 offset:6144
  ds_read_b128 v[240:243], v89 offset:11264
  ds_read_b128 v[204:207], v89 offset:2048
  ds_read_b128 v[224:227], v89 offset:7168
  ds_read_b128 v[244:247], v89 offset:12288
  ds_read_b128 v[208:211], v89 offset:3072
  ds_read_b128 v[228:231], v89 offset:8192
  ds_read_b128 v[248:251], v89 offset:13312
  ds_read_b128 v[212:215], v89 offset:4096
  ds_read_b128 v[232:235], v89 offset:9216
  ds_read_b128 v[252:255], v89 offset:14336
  buffer_load_dwordx4 a[168:171], v110, s[8:11], s101 offen offset:1024 sc1
  buffer_load_dwordx4 a[172:175], v110, s[8:11], s101 offen offset:2048 sc1
  buffer_load_dwordx4 a[176:179], v110, s[8:11], s101 offen offset:3072 sc1
  s_add_u32 s101, s101, 4096
  buffer_load_dwordx4 a[180:183], v110, s[8:11], s101 offen offset:0 sc1
  buffer_load_dwordx4 a[184:187], v110, s[8:11], s101 offen offset:1024 sc1
  s_waitcnt lgkmcnt(12)
  v_pk_add_f32 v[196:197], v[196:197], v[216:217]
  v_pk_add_f32 v[8:9], v[8:9], v[236:237]
  v_pk_add_f32 v[198:199], v[198:199], v[218:219]
  v_pk_add_f32 v[10:11], v[10:11], v[238:239]
  v_pk_add_f32 v[8:9], v[8:9], v[196:197]
  v_pk_add_f32 v[10:11], v[10:11], v[198:199]
  v_cvt_pk_bf16_f32 v90, v8, v9
  v_cvt_pk_bf16_f32 v91, v10, v11
  v_dot2_f32_bf16 v2, v90, v1, v2
  v_dot2_f32_bf16 v3, v90, v90, v3
  v_dot2_f32_bf16 v4, v91, v1, v4
  v_dot2_f32_bf16 v5, v91, v91, v5
  s_waitcnt lgkmcnt(9)
  v_pk_add_f32 v[200:201], v[200:201], v[220:221]
  v_pk_add_f32 v[12:13], v[12:13], v[240:241]
  v_pk_add_f32 v[202:203], v[202:203], v[222:223]
  v_pk_add_f32 v[14:15], v[14:15], v[242:243]
  v_pk_add_f32 v[12:13], v[12:13], v[200:201]
  v_pk_add_f32 v[14:15], v[14:15], v[202:203]
  v_cvt_pk_bf16_f32 v92, v12, v13
  v_cvt_pk_bf16_f32 v93, v14, v15
  v_dot2_f32_bf16 v2, v92, v1, v2
  v_dot2_f32_bf16 v3, v92, v92, v3
  v_dot2_f32_bf16 v4, v93, v1, v4
  v_dot2_f32_bf16 v5, v93, v93, v5
  buffer_store_dwordx4 v[90:93], v110, s[12:15], s41 offen
  buffer_store_dwordx4 v[90:93], v110, s[16:19], s41 offen sc1
  s_waitcnt lgkmcnt(6)
  v_pk_add_f32 v[204:205], v[204:205], v[224:225]
  v_pk_add_f32 v[16:17], v[16:17], v[244:245]
  v_pk_add_f32 v[206:207], v[206:207], v[226:227]
  v_pk_add_f32 v[18:19], v[18:19], v[246:247]
  v_pk_add_f32 v[16:17], v[16:17], v[204:205]
  v_pk_add_f32 v[18:19], v[18:19], v[206:207]
  v_cvt_pk_bf16_f32 v94, v16, v17
  v_cvt_pk_bf16_f32 v95, v18, v19
  v_dot2_f32_bf16 v2, v94, v1, v2
  v_dot2_f32_bf16 v3, v94, v94, v3
  v_dot2_f32_bf16 v4, v95, v1, v4
  v_dot2_f32_bf16 v5, v95, v95, v5
  s_waitcnt lgkmcnt(3)
  v_pk_add_f32 v[208:209], v[208:209], v[228:229]
  v_pk_add_f32 v[20:21], v[20:21], v[248:249]
  v_pk_add_f32 v[210:211], v[210:211], v[230:231]
  v_pk_add_f32 v[22:23], v[22:23], v[250:251]
  v_pk_add_f32 v[20:21], v[20:21], v[208:209]
  v_pk_add_f32 v[22:23], v[22:23], v[210:211]
  v_cvt_pk_bf16_f32 v96, v20, v21
  v_cvt_pk_bf16_f32 v97, v22, v23
  v_dot2_f32_bf16 v2, v96, v1, v2
  v_dot2_f32_bf16 v3, v96, v96, v3
  v_dot2_f32_bf16 v4, v97, v1, v4
  v_dot2_f32_bf16 v5, v97, v97, v5
  buffer_store_dwordx4 v[94:97], v110, s[12:15], s41 offen offset:1024
  buffer_store_dwordx4 v[94:97], v110, s[16:19], s41 offen offset:1024 sc1
  s_waitcnt lgkmcnt(0)
  v_pk_add_f32 v[212:213], v[212:213], v[232:233]
  v_pk_add_f32 v[24:25], v[24:25], v[252:253]
  v_pk_add_f32 v[214:215], v[214:215], v[234:235]
  v_pk_add_f32 v[26:27], v[26:27], v[254:255]
  v_pk_add_f32 v[24:25], v[24:25], v[212:213]
  v_pk_add_f32 v[26:27], v[26:27], v[214:215]
  v_cvt_pk_bf16_f32 v98, v24, v25
  v_cvt_pk_bf16_f32 v99, v26, v27
  v_dot2_f32_bf16 v2, v98, v1, v2
  v_dot2_f32_bf16 v3, v98, v98, v3
  v_dot2_f32_bf16 v4, v99, v1, v4
  v_dot2_f32_bf16 v5, v99, v99, v5
  buffer_store_dwordx2 v[98:99], v110, s[12:15], s42 offen
  buffer_store_dwordx2 v[98:99], v110, s[16:19], s42 offen sc1
  s_nop 0
  v_pk_add_f32 v[2:3], v[2:3], v[4:5]
  s_nop 1
  v_permlane16_swap_b32 v2, v3
  v_add_f32 v2, v2, v3
  v_mov_b32 v3, v2
  s_nop 1
  v_permlane32_swap_b32 v2, v3
  v_add_f32 v2, v2, v3
  v_mov_b32 v3, v2
  s_nop 1
  v_permlane16_swap_b32 v2, v3
  s_mov_b64 exec, 0xffff
  buffer_store_dwordx2 v[2:3], v6, s[12:15], s43 offen
  buffer_store_dwordx2 v[2:3], v6, s[16:19], s43 offen sc1
  s_mov_b64 exec, -1
  v_mov_b32 v44, 0x3f803f80
  v_mov_b32 v45, 0x3f803f80
  v_mov_b32 v46, 0x3f803f80
  v_mov_b32 v47, 0x3f803f80
  s_nop 1
  v_mfma_f32_16x16x32_bf16 v[32:35], a[200:203], v[44:47], 0
  v_mfma_f32_16x16x32_bf16 v[36:39], a[204:207], v[44:47], 0
  v_mfma_f32_16x16x32_bf16 v[40:43], a[208:211], v[44:47], 0
  buffer_load_dwordx4 a[188:191], v110, s[8:11], s101 offen offset:2048 sc1
  v_mfma_f32_16x16x32_bf16 v[32:35], a[212:215], v[44:47], v[32:35]
  v_mfma_f32_16x16x32_bf16 v[36:39], a[216:219], v[44:47], v[36:39]
  v_mfma_f32_16x16x32_bf16 v[40:43], a[220:223], v[44:47], v[40:43]
  buffer_load_dwordx4 a[192:195], v110, s[8:11], s101 offen offset:3072 sc1
  v_mfma_f32_16x16x32_bf16 v[32:35], a[224:227], v[44:47], v[32:35]
  v_mfma_f32_16x16x32_bf16 v[36:39], a[228:231], v[44:47], v[36:39]
  v_mfma_f32_16x16x32_bf16 v[40:43], a[232:235], v[44:47], v[40:43]
  s_add_u32 s101, s101, 4096
  buffer_load_dwordx4 a[196:199], v110, s[8:11], s101 offen offset:0 sc1
  v_mfma_f32_16x16x32_bf16 v[32:35], a[236:239], v[44:47], v[32:35]
  v_mfma_f32_16x16x32_bf16 v[36:39], a[240:243], v[44:47], v[36:39]
  v_mfma_f32_16x16x32_bf16 v[40:43], a[244:247], v[44:47], v[40:43]
  v_mfma_f32_16x16x32_bf16 v[32:35], a[248:251], v[44:47], v[32:35]
  v_mfma_f32_16x16x32_bf16 v[36:39], a[252:255], v[44:47], v[36:39]
  v_mfma_f32_16x16x32_bf16 v[40:43], v[112:115], v[44:47], v[40:43]
  v_mfma_f32_16x16x32_bf16 v[32:35], v[116:119], v[44:47], v[32:35]
  v_mfma_f32_16x16x32_bf16 v[36:39], v[120:123], v[44:47], v[36:39]
  v_mfma_f32_16x16x32_bf16 v[40:43], v[124:127], v[44:47], v[40:43]
  v_mfma_f32_16x16x32_bf16 v[32:35], v[128:131], v[44:47], v[32:35]
  v_mfma_f32_16x16x32_bf16 v[36:39], v[132:135], v[44:47], v[36:39]
  v_mfma_f32_16x16x32_bf16 v[40:43], v[136:139], v[44:47], v[40:43]
  v_mfma_f32_16x16x32_bf16 v[32:35], v[140:143], v[44:47], v[32:35]
  v_mfma_f32_16x16x32_bf16 v[36:39], v[144:147], v[44:47], v[36:39]
  v_mfma_f32_16x16x32_bf16 v[40:43], v[148:151], v[44:47], v[40:43]
  s_lshl_b32 s40, s96, 5
  s_add_u32 s40, s40, s6
  s_lshl_b32 s40, s40, 2
  s_add_u32 s40, s40, 131072
  s_waitcnt vmcnt(3)
  v_mov_b32 v4, s3
  v_mov_b32 v5, 0
  s_mov_b64 exec, 1
  buffer_store_dword v4, v5, s[12:15], s40 offen
  buffer_store_dword v4, v5, s[16:19], s40 offen sc1
  s_mov_b64 exec, -1
  s_mov_b32 s40, 131072
  s_mov_b32 s97, 0x20000
  buffer_load_dword v1, v111, s[8:11], s40 offen sc1
  v_mfma_f32_16x16x32_bf16 v[32:35], v[152:155], v[44:47], v[32:35]
  v_mfma_f32_16x16x32_bf16 v[36:39], v[156:159], v[44:47], v[36:39]
  v_mfma_f32_16x16x32_bf16 v[40:43], v[160:163], v[44:47], v[40:43]
  v_mfma_f32_16x16x32_bf16 v[32:35], v[164:167], v[44:47], v[32:35]
  v_mfma_f32_16x16x32_bf16 v[36:39], v[168:171], v[44:47], v[36:39]
  v_mfma_f32_16x16x32_bf16 v[40:43], v[172:175], v[44:47], v[40:43]
  v_mfma_f32_16x16x32_bf16 v[32:35], v[176:179], v[44:47], v[32:35]
  v_mfma_f32_16x16x32_bf16 v[36:39], v[180:183], v[44:47], v[36:39]
  v_mfma_f32_16x16x32_bf16 v[40:43], v[184:187], v[44:47], v[40:43]
  v_mfma_f32_16x16x32_bf16 v[32:35], v[188:191], v[44:47], v[32:35]
  v_mfma_f32_16x16x32_bf16 v[36:39], v[192:195], v[44:47], v[36:39]
  v_mfma_f32_16x16x32_bf16 v[40:43], a[0:3], v[44:47], v[40:43]
  v_mfma_f32_16x16x32_bf16 v[32:35], a[4:7], v[44:47], v[32:35]
  v_mfma_f32_16x16x32_bf16 v[36:39], a[8:11], v[44:47], v[36:39]
  v_mfma_f32_16x16x32_bf16 v[40:43], a[12:15], v[44:47], v[40:43]
  v_mfma_f32_16x16x32_bf16 v[32:35], a[16:19], v[44:47], v[32:35]
  v_mfma_f32_16x16x32_bf16 v[36:39], a[20:23], v[44:47], v[36:39]
  v_mfma_f32_16x16x32_bf16 v[40:43], a[24:27], v[44:47], v[40:43]
  v_mfma_f32_16x16x32_bf16 v[32:35], a[28:31], v[44:47], v[32:35]
  v_mfma_f32_16x16x32_bf16 v[36:39], a[32:35], v[44:47], v[36:39]
  v_mfma_f32_16x16x32_bf16 v[40:43], a[36:39], v[44:47], v[40:43]
  v_mfma_f32_16x16x32_bf16 v[32:35], a[40:43], v[44:47], v[32:35]
  v_mfma_f32_16x16x32_bf16 v[36:39], a[44:47], v[44:47], v[36:39]
  v_mfma_f32_16x16x32_bf16 v[40:43], a[48:51], v[44:47], v[40:43]
  v_mfma_f32_16x16x32_bf16 v[32:35], a[52:55], v[44:47], v[32:35]
  v_mfma_f32_16x16x32_bf16 v[36:39], a[56:59], v[44:47], v[36:39]
  v_mfma_f32_16x16x32_bf16 v[40:43], a[60:63], v[44:47], v[40:43]
  v_mfma_f32_16x16x32_bf16 v[32:35], a[64:67], v[44:47], v[32:35]
  v_mfma_f32_16x16x32_bf16 v[36:39], a[68:71], v[44:47], v[36:39]
  v_mfma_f32_16x16x32_bf16 v[40:43], a[72:75], v[44:47], v[40:43]
  v_mfma_f32_16x16x32_bf16 v[32:35], a[76:79], v[44:47], v[32:35]
  v_mfma_f32_16x16x32_bf16 v[36:39], a[80:83], v[44:47], v[36:39]
  v_mfma_f32_16x16x32_bf16 v[40:43], a[84:87], v[44:47], v[40:43]
  v_mfma_f32_16x16x32_bf16 v[32:35], a[88:91], v[44:47], v[32:35]
  v_mfma_f32_16x16x32_bf16 v[36:39], a[92:95], v[44:47], v[36:39]
  v_mfma_f32_16x16x32_bf16 v[40:43], a[96:99], v[44:47], v[40:43]
  s_mul_i32 s41, s98, 81920
  s_mul_i32 s42, s6, 5120
  s_add_u32 s41, s41, s42
  s_add_u32 s41, s41, 3145728
  s_lshl_b32 s43, s98, 12
  s_lshl_b32 s44, s6, 8
  s_add_u32 s43, s43, s44
  s_add_u32 s43, s43, 5767168
  s_lshl_b32 s44, s6, 10
  s_add_u32 s45, s44, 147456
  s_add_u32 s44, s44, 143360
  v_lshrrev_b32 v2, 4, v0
  v_and_b32 v3, 15, v0
  v_lshlrev_b32 v4, 10, v2
  v_lshlrev_b32 v5, 4, v3
  v_add_u32 v4, v4, v5
  v_add_u32 v7, s45, v5
  v_add_u32 v6, s45, v110
  v_lshlrev_b32 v2, 8, v2
  v_lshlrev_b32 v3, 3, v3
  v_add_u32 v5, v2, v3
  v_add_u32 v5, 143360, v5
  v_mov_b32 v85, v110
  s_mul_i32 s28, s98, 98304
  s_add_u32 s28, s28, 5799936
  s_mul_i32 s29, s98, 25600
  s_add_u32 s29, s29, 8970240
  s_cmp_eq_u32 s99, 3
  s_cselect_b32 s28, s29, s28
  s_mul_i32 s29, s98, 81920
  s_add_u32 s29, s29, 524288
  s_cmp_lt_u32 s99, 3
  s_cselect_b32 s28, s29, s28
  s_mul_i32 s29, s99, 24576
  s_add_u32 s28, s28, s29
  s_lshr_b32 s29, s6, 1
  s_mul_i32 s29, s29, 12288
  s_add_u32 s28, s28, s29
  s_and_b32 s31, s6, 1
  s_lshl_b32 s29, s31, 12
  s_add_u32 s29, s29, s28
  s_lshl_b32 s30, s31, 3
  s_add_u32 s30, s30, s28
  s_add_u32 s30, s30, 8192
  s_mov_b32 m0, s44
  s_branch polle_34
poll_33:
  s_sub_u32 s97, s97, 1
  s_cbranch_scc1 END
  buffer_load_dword v1, v111, s[8:11], s40 offen sc1
polle_34:
  s_waitcnt vmcnt(0)
  v_cmp_ne_u32 vcc, s3, v1
  s_nop 1
  s_cbranch_vccnz poll_33
  buffer_load_dwordx4 v4, s[8:11], s43 offen sc1 lds
  s_add_u32 m0, s42, 0
  s_mov_b32 s47, s41
  buffer_load_dwordx4 v110, s[8:11], s47 offen offset:0 sc1 lds
  buffer_load_dwordx4 v110, s[8:11], s47 offen offset:1024 sc1 lds
  buffer_load_dwordx4 v110, s[8:11], s47 offen offset:2048 sc1 lds
  buffer_load_dwordx4 v110, s[8:11], s47 offen offset:3072 sc1 lds
  s_add_u32 m0, s42, 4096
  s_add_u32 s47, s47, 4096
  buffer_load_dwordx4 v110, s[8:11], s47 offen offset:0 sc1 lds
  s_mov_b32 s41, 0x3acccccd
  s_waitcnt vmcnt(0)
  s_barrier
  ds_read_b128 v[44:47], v85 offset:0
  ds_read_b128 v[48:51], v85 offset:1024
  ds_read_b128 v[52:55], v85 offset:2048
  ds_read_b128 v[56:59], v85 offset:3072
  ds_read_b128 v[60:63], v85 offset:4096
  ds_read_b64 v[68:69], v5 offset:0
  ds_read_b64 v[70:71], v5 offset:128
  ds_read_b64 v[72:73], v5 offset:1024
  ds_read_b64 v[74:75], v5 offset:1152
  ds_read_b64 v[76:77], v5 offset:2048
  ds_read_b64 v[78:79], v5 offset:2176
  ds_read_b64 v[80:81], v5 offset:3072
  ds_read_b64 v[82:83], v5 offset:3200
  s_waitcnt lgkmcnt(12)
  v_mfma_f32_16x16x32_bf16 v[8:11], a[200:203], v[44:47], 0
  ds_read_b128 v[64:67], v85 offset:5120
  v_mfma_f32_16x16x32_bf16 v[12:15], a[204:207], v[44:47], 0
  s_add_u32 m0, s42, 20480
  s_add_u32 s47, s47, 16384
  buffer_load_dwordx4 v110, s[8:11], s47 offen offset:0 sc1 lds
  v_mfma_f32_16x16x32_bf16 v[16:19], a[208:211], v[44:47], 0
  s_waitcnt lgkmcnt(12)
  v_mfma_f32_16x16x32_bf16 v[8:11], a[212:215], v[48:51], v[8:11]
  ds_read_b128 v[44:47], v85 offset:6144
  s_waitcnt lgkmcnt(2)
  v_mfma_f32_16x16x32_bf16 v[12:15], a[216:219], v[48:51], v[12:15]
  buffer_load_dwordx4 v110, s[8:11], s47 offen offset:1024 sc1 lds
  v_add_f32 v68, v68, v70
  v_add_f32 v69, v69, v71
  v_mfma_f32_16x16x32_bf16 v[16:19], a[220:223], v[48:51], v[16:19]
  v_add_f32 v72, v72, v74
  v_add_f32 v73, v73, v75
  v_mfma_f32_16x16x32_bf16 v[8:11], a[224:227], v[52:55], v[8:11]
  ds_read_b128 v[48:51], v85 offset:7168
  v_add_f32 v76, v76, v78
  v_mfma_f32_16x16x32_bf16 v[12:15], a[228:231], v[52:55], v[12:15]
  buffer_load_dwordx4 v110, s[8:11], s47 offen offset:2048 sc1 lds
  v_add_f32 v77, v77, v79
  v_add_f32 v80, v80, v82
  v_mfma_f32_16x16x32_bf16 v[16:19], a[232:235], v[52:55], v[16:19]
  v_add_f32 v81, v81, v83
  v_add_f32 v68, v68, v72
  v_mfma_f32_16x16x32_bf16 v[8:11], a[236:239], v[56:59], v[8:11]
  ds_read_b128 v[52:55], v85 offset:8192
  v_add_f32 v69, v69, v73
  v_mfma_f32_16x16x32_bf16 v[12:15], a[240:243], v[56:59], v[12:15]
  buffer_load_dwordx4 v110, s[8:11], s47 offen offset:3072 sc1 lds
  v_add_f32 v76, v76, v80
  v_add_f32 v77, v77, v81
  v_mfma_f32_16x16x32_bf16 v[16:19], a[244:247], v[56:59], v[16:19]
  v_add_f32 v68, v68, v76
  v_add_f32 v69, v69, v77
  v_mfma_f32_16x16x32_bf16 v[8:11], a[248:251], v[60:63], v[8:11]
  ds_read_b128 v[56:59], v85 offset:9216
  v_mul_f32 v68, s41, v68
  v_mfma_f32_16x16x32_bf16 v[12:15], a[252:255], v[60:63], v[12:15]
  s_add_u32 m0, s42, 24576
  s_add_u32 s47, s47, 4096
  buffer_load_dwordx4 v110, s[8:11], s47 offen offset:0 sc1 lds
  v_mul_f32 v69, s41, v69
  v_fma_f32 v69, -v68, v68, v69
  v_mfma_f32_16x16x32_bf16 v[16:19], v[112:115], v[60:63], v[16:19]
  v_max_f32 v69, 0, v69
  v_cvt_pk_bf16_f32 v68, -v68, v69
  s_waitcnt lgkmcnt(4)
  v_mfma_f32_16x16x32_bf16 v[8:11], v[116:119], v[64:67], v[8:11]
  ds_read_b128 v[60:63], v85 offset:10240
  v_and_b32 v69, 0xffff0000, v68
  v_mfma_f32_16x16x32_bf16 v[12:15], v[120:123], v[64:67], v[12:15]
  s_add_u32 m0, s42, 40960
  s_add_u32 s47, s47, 16384
  buffer_load_dwordx4 v110, s[8:11], s47 offen offset:0 sc1 lds
  v_lshlrev_b32 v68, 16, v68
  v_add_f32 v69, 0x3727c5ac, v69
  v_mfma_f32_16x16x32_bf16 v[16:19], v[124:127], v[64:67], v[16:19]
  v_cvt_pk_bf16_f32 v69, v69, v69
  v_lshlrev_b32 v69, 16, v69
  s_waitcnt lgkmcnt(4)
  v_mfma_f32_16x16x32_bf16 v[8:11], v[128:131], v[44:47], v[8:11]
  ds_read_b128 v[64:67], v85 offset:11264
  v_sqrt_f32 v69, v69
  v_mfma_f32_16x16x32_bf16 v[12:15], v[132:135], v[44:47], v[12:15]
  buffer_load_dwordx4 v110, s[8:11], s47 offen offset:1024 sc1 lds
  v_cvt_pk_bf16_f32 v69, v69, v69
  v_lshlrev_b32 v71, 16, v69
  v_mfma_f32_16x16x32_bf16 v[16:19], v[136:139], v[44:47], v[16:19]
  v_rcp_f32 v69, v71
  s_nop 0
  v_mul_f32 v70, v69, v69
  s_waitcnt lgkmcnt(4)
  v_mfma_f32_16x16x32_bf16 v[8:11], v[140:143], v[48:51], v[8:11]
  ds_read_b128 v[44:47], v85 offset:12288
  v_mul_f32 v70, 0xbdd2d3e8, v70
  v_mfma_f32_16x16x32_bf16 v[12:15], v[144:147], v[48:51], v[12:15]
  buffer_load_dwordx4 v110, s[8:11], s47 offen offset:2048 sc1 lds
  v_mul_f32 v70, v70, v69
  v_mul_f32 v69, 0xc0135761, v69
  v_mfma_f32_16x16x32_bf16 v[16:19], v[148:151], v[48:51], v[16:19]
  ds_write_b128 v6, v[68:71]
  ds_read_b128 v[68:71], v7 offset:0
  s_waitcnt lgkmcnt(6)
  v_mfma_f32_16x16x32_bf16 v[8:11], v[152:155], v[52:55], v[8:11]
  ds_read_b128 v[48:51], v85 offset:13312
  ds_read_b128 v[72:75], v7 offset:256
  v_mfma_f32_16x16x32_bf16 v[12:15], v[156:159], v[52:55], v[12:15]
  buffer_load_dwordx4 v110, s[8:11], s47 offen offset:3072 sc1 lds
  ds_read_b128 v[76:79], v7 offset:512
  ds_read_b128 v[80:83], v7 offset:768
  v_mfma_f32_16x16x32_bf16 v[16:19], v[160:163], v[52:55], v[16:19]
  s_waitcnt lgkmcnt(9)
  v_mfma_f32_16x16x32_bf16 v[8:11], v[164:167], v[56:59], v[8:11]
  ds_read_b128 v[52:55], v85 offset:14336
  v_mfma_f32_16x16x32_bf16 v[12:15], v[168:171], v[56:59], v[12:15]
  s_add_u32 m0, s42, 45056
  s_add_u32 s47, s47, 4096
  buffer_load_dwordx4 v110, s[8:11], s47 offen offset:0 sc1 lds
  v_mfma_f32_16x16x32_bf16 v[16:19], v[172:175], v[56:59], v[16:19]
  s_waitcnt lgkmcnt(9)
  v_mfma_f32_16x16x32_bf16 v[8:11], v[176:179], v[60:63], v[8:11]
  ds_read_b128 v[56:59], v85 offset:15360
  v_mfma_f32_16x16x32_bf16 v[12:15], v[180:183], v[60:63], v[12:15]
  s_add_u32 m0, s42, 61440
  s_add_u32 s47, s47, 16384
  buffer_load_dwordx4 v110, s[8:11], s47 offen offset:0 sc1 lds
  v_mfma_f32_16x16x32_bf16 v[16:19], v[184:187], v[60:63], v[16:19]
  s_waitcnt lgkmcnt(9)
  v_mfma_f32_16x16x32_bf16 v[8:11], v[188:191], v[64:67], v[8:11]
  ds_read_b128 v[60:63], v85 offset:16384
  v_mfma_f32_16x16x32_bf16 v[12:15], v[192:195], v[64:67], v[12:15]
  buffer_load_dwordx4 v110, s[8:11], s47 offen offset:1024 sc1 lds
  v_mfma_f32_16x16x32_bf16 v[16:19], a[0:3], v[64:67], v[16:19]
  s_waitcnt lgkmcnt(9)
  v_mfma_f32_16x16x32_bf16 v[8:11], a[4:7], v[44:47], v[8:11]
  ds_read_b128 v[64:67], v85 offset:17408
  v_mfma_f32_16x16x32_bf16 v[12:15], a[8:11], v[44:47], v[12:15]
  buffer_load_dwordx4 v110, s[8:11], s47 offen offset:2048 sc1 lds
  v_mfma_f32_16x16x32_bf16 v[16:19], a[12:15], v[44:47], v[16:19]
  s_waitcnt lgkmcnt(7)
  v_mfma_f32_16x16x32_bf16 v[8:11], a[16:19], v[48:51], v[8:11]
  ds_read_b128 v[44:47], v85 offset:18432
  v_mfma_f32_16x16x32_bf16 v[12:15], a[20:23], v[48:51], v[12:15]
  buffer_load_dwordx4 v110, s[8:11], s47 offen offset:3072 sc1 lds
  v_mfma_f32_16x16x32_bf16 v[16:19], a[24:27], v[48:51], v[16:19]
  s_waitcnt lgkmcnt(4)
  v_mfma_f32_16x16x32_bf16 v[8:11], a[28:31], v[52:55], v[8:11]
  ds_read_b128 v[48:51], v85 offset:19456
  v_mfma_f32_16x16x32_bf16 v[12:15], a[32:35], v[52:55], v[12:15]
  s_add_u32 m0, s42, 65536
  s_add_u32 s47, s47, 4096
  buffer_load_dwordx4 v110, s[8:11], s47 offen offset:0 sc1 lds
  v_mfma_f32_16x16x32_bf16 v[16:19], a[36:39], v[52:55], v[16:19]
  s_waitcnt lgkmcnt(4)
  v_mfma_f32_16x16x32_bf16 v[8:11], a[40:43], v[56:59], v[8:11]
  s_waitcnt vmcnt(10)
  s_barrier
  v_add_u32 v85, 20480, v85
  ds_read_b128 v[52:55], v85 offset:0
  v_mfma_f32_16x16x32_bf16 v[12:15], a[44:47], v[56:59], v[12:15]
  v_mfma_f32_16x16x32_bf16 v[16:19], a[48:51], v[56:59], v[16:19]
  s_waitcnt lgkmcnt(4)
  v_mfma_f32_16x16x32_bf16 v[8:11], a[52:55], v[60:63], v[8:11]
  ds_read_b128 v[56:59], v85 offset:1024
  v_mfma_f32_16x16x32_bf16 v[12:15], a[56:59], v[60:63], v[12:15]
  v_mfma_f32_16x16x32_bf16 v[16:19], a[60:63], v[60:63], v[16:19]
  s_waitcnt lgkmcnt(4)
  v_mfma_f32_16x16x32_bf16 v[8:11], a[64:67], v[64:67], v[8:11]
  ds_read_b128 v[60:63], v85 offset:2048
  v_mfma_f32_16x16x32_bf16 v[12:15], a[68:71], v[64:67], v[12:15]
  v_mfma_f32_16x16x32_bf16 v[16:19], a[72:75], v[64:67], v[16:19]
  s_waitcnt lgkmcnt(4)
  v_mfma_f32_16x16x32_bf16 v[8:11], a[76:79], v[44:47], v[8:11]
  ds_read_b128 v[64:67], v85 offset:3072
  v_mfma_f32_16x16x32_bf16 v[12:15], a[80:83], v[44:47], v[12:15]
  v_mfma_f32_16x16x32_bf16 v[16:19], a[84:87], v[44:47], v[16:19]
  s_waitcnt lgkmcnt(4)
  v_mfma_f32_16x16x32_bf16 v[8:11], a[88:91], v[48:51], v[8:11]
  ds_read_b128 v[44:47], v85 offset:4096
  v_mfma_f32_16x16x32_bf16 v[12:15], a[92:95], v[48:51], v[12:15]
  v_mfma_f32_16x16x32_bf16 v[16:19], a[96:99], v[48:51], v[16:19]
  s_waitcnt lgkmcnt(4)
  v_mfma_f32_16x16x32_bf16 v[20:23], a[200:203], v[52:55], 0
  ds_read_b128 v[48:51], v85 offset:5120
  v_mfma_f32_16x16x32_bf16 v[24:27], a[204:207], v[52:55], 0
  v_mfma_f32_16x16x32_bf16 v[28:31], a[208:211], v[52:55], 0
  v_fma_f32 v8, v32, v68, v8
  v_fma_f32 v9, v33, v68, v9
  v_mul_f32 v1, v8, v8
  s_waitcnt lgkmcnt(4)
  v_mfma_f32_16x16x32_bf16 v[20:23], a[212:215], v[56:59], v[20:23]
  ds_read_b128 v[52:55], v85 offset:6144
  v_mul_f32 v2, v9, v9
  v_fma_f32 v1, v1, v70, v69
  v_mfma_f32_16x16x32_bf16 v[24:27], a[216:219], v[56:59], v[24:27]
  v_fma_f32 v2, v2, v70, v69
  v_mul_f32 v1, v1, v8
  v_mul_f32 v2, v2, v9
  v_exp_f32 v1, v1
  v_mfma_f32_16x16x32_bf16 v[28:31], a[220:223], v[56:59], v[28:31]
  v_fma_f32 v10, v34, v68, v10
  v_fma_f32 v11, v35, v68, v11
  v_exp_f32 v2, v2
  s_waitcnt lgkmcnt(4)
  v_mfma_f32_16x16x32_bf16 v[20:23], a[224:227], v[60:63], v[20:23]
  ds_read_b128 v[56:59], v85 offset:7168
  v_mul_f32 v3, v10, v10
  v_mul_f32 v84, v11, v11
  v_mfma_f32_16x16x32_bf16 v[24:27], a[228:231], v[60:63], v[24:27]
  v_fma_f32 v3, v3, v70, v69
  v_fma_f32 v84, v84, v70, v69
  v_mul_f32 v3, v3, v10
  v_exp_f32 v3, v3
  v_mfma_f32_16x16x32_bf16 v[28:31], a[232:235], v[60:63], v[28:31]
  buffer_load_dwordx4 v[196:199], v110, s[8:11], s101 offen offset:1024 sc1
  v_mul_f32 v84, v84, v11
  v_exp_f32 v84, v84
  s_waitcnt lgkmcnt(4)
  v_mfma_f32_16x16x32_bf16 v[20:23], a[236:239], v[64:67], v[20:23]
  ds_read_b128 v[60:63], v85 offset:8192
  v_fma_f32 v1, v1, v71, v71
  v_rcp_f32 v1, v1
  v_mfma_f32_16x16x32_bf16 v[24:27], a[240:243], v[64:67], v[24:27]
  v_fma_f32 v2, v2, v71, v71
  v_fma_f32 v3, v3, v71, v71
  v_rcp_f32 v2, v2
  v_mfma_f32_16x16x32_bf16 v[28:31], a[244:247], v[64:67], v[28:31]
  v_fma_f32 v84, v84, v71, v71
  v_rcp_f32 v3, v3
  s_waitcnt lgkmcnt(4)
  v_mfma_f32_16x16x32_bf16 v[20:23], a[248:251], v[44:47], v[20:23]
  ds_read_b128 v[64:67], v85 offset:9216
  v_rcp_f32 v84, v84
  v_mfma_f32_16x16x32_bf16 v[24:27], a[252:255], v[44:47], v[24:27]
  v_fma_f32 v12, v36, v68, v12
  v_fma_f32 v13, v37, v68, v13
  v_mfma_f32_16x16x32_bf16 v[28:31], v[112:115], v[44:47], v[28:31]
  buffer_load_dwordx4 v[200:203], v110, s[8:11], s101 offen offset:2048 sc1
  v_mul_f32 v4, v12, v12
  s_waitcnt lgkmcnt(4)
  v_mfma_f32_16x16x32_bf16 v[20:23], v[116:119], v[48:51], v[20:23]
  ds_read_b128 v[44:47], v85 offset:10240
  v_mul_f32 v5, v13, v13
  v_mfma_f32_16x16x32_bf16 v[24:27], v[120:123], v[48:51], v[24:27]
  v_fma_f32 v4, v4, v70, v69
  v_fma_f32 v5, v5, v70, v69
  v_mfma_f32_16x16x32_bf16 v[28:31], v[124:127], v[48:51], v[28:31]
  v_mul_f32 v4, v4, v12
  v_mul_f32 v5, v5, v13
  v_exp_f32 v4, v4
  s_waitcnt lgkmcnt(4)
  v_mfma_f32_16x16x32_bf16 v[20:23], v[128:131], v[52:55], v[20:23]
  ds_read_b128 v[48:51], v85 offset:11264
  v_exp_f32 v5, v5
  v_mfma_f32_16x16x32_bf16 v[24:27], v[132:135], v[52:55], v[24:27]
  v_fma_f32 v14, v38, v68, v14
  v_fma_f32 v15, v39, v68, v15
  v_mfma_f32_16x16x32_bf16 v[28:31], v[136:139], v[52:55], v[28:31]
  buffer_load_dwordx4 v[204:207], v110, s[8:11], s101 offen offset:3072 sc1
  v_mul_f32 v6, v14, v14
  s_waitcnt lgkmcnt(4)
  v_mfma_f32_16x16x32_bf16 v[20:23], v[140:143], v[56:59], v[20:23]
  ds_read_b128 v[52:55], v85 offset:12288
  v_mul_f32 v7, v15, v15
  v_mfma_f32_16x16x32_bf16 v[24:27], v[144:147], v[56:59], v[24:27]
  v_fma_f32 v6, v6, v70, v69
  v_fma_f32 v7, v7, v70, v69
  v_mfma_f32_16x16x32_bf16 v[28:31], v[148:151], v[56:59], v[28:31]
  v_mul_f32 v6, v6, v14
  v_mul_f32 v7, v7, v15
  v_exp_f32 v6, v6
  s_waitcnt lgkmcnt(4)
  v_mfma_f32_16x16x32_bf16 v[20:23], v[152:155], v[60:63], v[20:23]
  ds_read_b128 v[56:59], v85 offset:13312
  v_exp_f32 v7, v7
  v_mfma_f32_16x16x32_bf16 v[24:27], v[156:159], v[60:63], v[24:27]
  v_fma_f32 v4, v4, v71, v71
  v_fma_f32 v5, v5, v71, v71
  v_rcp_f32 v4, v4
  v_mfma_f32_16x16x32_bf16 v[28:31], v[160:163], v[60:63], v[28:31]
  s_add_u32 s101, s101, 4096
  buffer_load_dwordx4 v[208:211], v110, s[8:11], s101 offen offset:0 sc1
  v_rcp_f32 v5, v5
  s_waitcnt lgkmcnt(4)
  v_mfma_f32_16x16x32_bf16 v[20:23], v[164:167], v[64:67], v[20:23]
  ds_read_b128 v[60:63], v85 offset:14336
  v_fma_f32 v6, v6, v71, v71
  v_rcp_f32 v6, v6
  v_mfma_f32_16x16x32_bf16 v[24:27], v[168:171], v[64:67], v[24:27]
  v_fma_f32 v7, v7, v71, v71
  v_mul_f32 v8, v8, v1
  v_rcp_f32 v7, v7
  v_mfma_f32_16x16x32_bf16 v[28:31], v[172:175], v[64:67], v[28:31]
  v_mul_f32 v9, v9, v2
  v_mul_f32 v10, v10, v3
  s_waitcnt lgkmcnt(4)
  v_mfma_f32_16x16x32_bf16 v[20:23], v[176:179], v[44:47], v[20:23]
  ds_read_b128 v[64:67], v85 offset:15360
  v_mul_f32 v11, v11, v84
  v_mfma_f32_16x16x32_bf16 v[24:27], v[180:183], v[44:47], v[24:27]
  v_cvt_pk_bf16_f32 v8, v8, v9
  v_cvt_pk_bf16_f32 v9, v10, v11
  v_mfma_f32_16x16x32_bf16 v[28:31], v[184:187], v[44:47], v[28:31]
  buffer_load_dwordx4 v[212:215], v110, s[8:11], s101 offen offset:1024 sc1
  v_fma_f32 v16, v40, v68, v16
  s_waitcnt lgkmcnt(4)
  v_mfma_f32_16x16x32_bf16 v[20:23], v[188:191], v[48:51], v[20:23]
  ds_read_b128 v[44:47], v85 offset:16384
  v_fma_f32 v17, v41, v68, v17
  v_mfma_f32_16x16x32_bf16 v[24:27], v[192:195], v[48:51], v[24:27]
  v_mul_f32 v1, v16, v16
  v_mul_f32 v2, v17, v17
  v_mfma_f32_16x16x32_bf16 v[28:31], a[0:3], v[48:51], v[28:31]
  v_fma_f32 v1, v1, v70, v69
  v_fma_f32 v2, v2, v70, v69
  s_waitcnt lgkmcnt(4)
  v_mfma_f32_16x16x32_bf16 v[20:23], a[4:7], v[52:55], v[20:23]
  ds_read_b128 v[48:51], v85 offset:17408
  v_mul_f32 v1, v1, v16
  v_exp_f32 v1, v1
  v_mfma_f32_16x16x32_bf16 v[24:27], a[8:11], v[52:55], v[24:27]
  v_mul_f32 v2, v2, v17
  v_fma_f32 v18, v42, v68, v18
  v_exp_f32 v2, v2
  v_mfma_f32_16x16x32_bf16 v[28:31], a[12:15], v[52:55], v[28:31]
  buffer_load_dwordx4 v[216:219], v110, s[8:11], s101 offen offset:2048 sc1
  v_fma_f32 v19, v43, v68, v19
  s_waitcnt lgkmcnt(4)
  v_mfma_f32_16x16x32_bf16 v[20:23], a[16:19], v[56:59], v[20:23]
  ds_read_b128 v[52:55], v85 offset:18432
  v_mul_f32 v3, v18, v18
  v_mfma_f32_16x16x32_bf16 v[24:27], a[20:23], v[56:59], v[24:27]
  v_mul_f32 v84, v19, v19
  v_fma_f32 v3, v3, v70, v69
  v_mfma_f32_16x16x32_bf16 v[28:31], a[24:27], v[56:59], v[28:31]
  v_fma_f32 v84, v84, v70, v69
  v_mul_f32 v3, v3, v18
  v_exp_f32 v3, v3
  s_waitcnt lgkmcnt(4)
  v_mfma_f32_16x16x32_bf16 v[20:23], a[28:31], v[60:63], v[20:23]
  ds_read_b128 v[56:59], v85 offset:19456
  v_mul_f32 v84, v84, v19
  v_exp_f32 v84, v84
  v_mfma_f32_16x16x32_bf16 v[24:27], a[32:35], v[60:63], v[24:27]
  v_fma_f32 v1, v1, v71, v71
  v_fma_f32 v2, v2, v71, v71
  v_rcp_f32 v1, v1
  v_mfma_f32_16x16x32_bf16 v[28:31], a[36:39], v[60:63], v[28:31]
  buffer_load_dwordx4 v[220:223], v110, s[8:11], s101 offen offset:3072 sc1
  v_rcp_f32 v2, v2
  s_waitcnt lgkmcnt(4)
  v_mfma_f32_16x16x32_bf16 v[20:23], a[40:43], v[64:67], v[20:23]
  s_waitcnt vmcnt(12)
  s_barrier
  v_add_u32 v85, 20480, v85
  ds_read_b128 v[60:63], v85 offset:0
  v_fma_f32 v3, v3, v71, v71
  v_rcp_f32 v3, v3
  v_mfma_f32_16x16x32_bf16 v[24:27], a[44:47], v[64:67], v[24:27]
  v_fma_f32 v84, v84, v71, v71
  v_mul_f32 v12, v12, v4
  v_rcp_f32 v84, v84
  v_mfma_f32_16x16x32_bf16 v[28:31], a[48:51], v[64:67], v[28:31]
  v_mul_f32 v13, v13, v5
  v_mul_f32 v14, v14, v6
  s_waitcnt lgkmcnt(4)
  v_mfma_f32_16x16x32_bf16 v[20:23], a[52:55], v[44:47], v[20:23]
  ds_read_b128 v[64:67], v85 offset:1024
  v_mul_f32 v15, v15, v7
  v_mfma_f32_16x16x32_bf16 v[24:27], a[56:59], v[44:47], v[24:27]
  v_cvt_pk_bf16_f32 v10, v12, v13
  v_cvt_pk_bf16_f32 v11, v14, v15
  v_mfma_f32_16x16x32_bf16 v[28:31], a[60:63], v[44:47], v[28:31]
  s_add_u32 s101, s101, 4096
  buffer_load_dwordx4 v[224:227], v110, s[8:11], s101 offen offset:0 sc1
  buffer_store_dwordx4 v[8:11], v110, s[12:15], s29 offen offset:0
  buffer_store_dwordx4 v[8:11], v110, s[16:19], s29 offen offset:0 sc1
  s_waitcnt lgkmcnt(4)
  v_mfma_f32_16x16x32_bf16 v[20:23], a[64:67], v[48:51], v[20:23]
  ds_read_b128 v[44:47], v85 offset:2048
  v_mul_f32 v16, v16, v1
  v_mfma_f32_16x16x32_bf16 v[24:27], a[68:71], v[48:51], v[24:27]
  v_mul_f32 v17, v17, v2
  v_mul_f32 v18, v18, v3
  v_mfma_f32_16x16x32_bf16 v[28:31], a[72:75], v[48:51], v[28:31]
  v_mul_f32 v19, v19, v84
  v_cvt_pk_bf16_f32 v12, v16, v17
  s_waitcnt lgkmcnt(4)
  v_mfma_f32_16x16x32_bf16 v[20:23], a[76:79], v[52:55], v[20:23]
  ds_read_b128 v[48:51], v85 offset:3072
  v_cvt_pk_bf16_f32 v13, v18, v19
  v_mfma_f32_16x16x32_bf16 v[24:27], a[80:83], v[52:55], v[24:27]
  buffer_store_dwordx2 v[12:13], v110, s[12:15], s30 offen offset:0
  buffer_store_dwordx2 v[12:13], v110, s[16:19], s30 offen offset:0 sc1
  v_mfma_f32_16x16x32_bf16 v[28:31], a[84:87], v[52:55], v[28:31]
  buffer_load_dwordx4 v[228:231], v110, s[8:11], s101 offen offset:1024 sc1
  s_waitcnt lgkmcnt(4)
  v_mfma_f32_16x16x32_bf16 v[20:23], a[88:91], v[56:59], v[20:23]
  ds_read_b128 v[52:55], v85 offset:4096
  v_mfma_f32_16x16x32_bf16 v[24:27], a[92:95], v[56:59], v[24:27]
  v_mfma_f32_16x16x32_bf16 v[28:31], a[96:99], v[56:59], v[28:31]
  s_waitcnt lgkmcnt(4)
  v_mfma_f32_16x16x32_bf16 v[8:11], a[200:203], v[60:63], 0
  ds_read_b128 v[56:59], v85 offset:5120
  v_mfma_f32_16x16x32_bf16 v[12:15], a[204:207], v[60:63], 0
  v_mfma_f32_16x16x32_bf16 v[16:19], a[208:211], v[60:63], 0
  buffer_load_dwordx4 v[232:235], v110, s[8:11], s101 offen offset:2048 sc1
  v_fma_f32 v20, v32, v72, v20
  v_fma_f32 v21, v33, v72, v21
  s_waitcnt lgkmcnt(4)
  v_mfma_f32_16x16x32_bf16 v[8:11], a[212:215], v[64:67], v[8:11]
  ds_read_b128 v[60:63], v85 offset:6144
  v_mul_f32 v1, v20, v20
  v_mul_f32 v2, v21, v21
  v_mfma_f32_16x16x32_bf16 v[12:15], a[216:219], v[64:67], v[12:15]
  v_fma_f32 v1, v1, v74, v73
  v_fma_f32 v2, v2, v74, v73
  v_mul_f32 v1, v1, v20
  v_exp_f32 v1, v1
  v_mfma_f32_16x16x32_bf16 v[16:19], a[220:223], v[64:67], v[16:19]
  v_mul_f32 v2, v2, v21
  v_fma_f32 v22, v34, v72, v22
  v_fma_f32 v23, v35, v72, v23
  v_exp_f32 v2, v2
  s_waitcnt lgkmcnt(4)
  v_mfma_f32_16x16x32_bf16 v[8:11], a[224:227], v[44:47], v[8:11]
  ds_read_b128 v[64:67], v85 offset:7168
  v_mul_f32 v3, v22, v22
  v_mul_f32 v84, v23, v23
  v_mfma_f32_16x16x32_bf16 v[12:15], a[228:231], v[44:47], v[12:15]
  v_fma_f32 v3, v3, v74, v73
  v_fma_f32 v84, v84, v74, v73
  v_mul_f32 v3, v3, v22
  v_exp_f32 v3, v3
  v_mfma_f32_16x16x32_bf16 v[16:19], a[232:235], v[44:47], v[16:19]
  buffer_load_dwordx4 v[236:239], v110, s[8:11], s101 offen offset:3072 sc1
  v_mul_f32 v84, v84, v23
  v_exp_f32 v84, v84
  s_waitcnt lgkmcnt(4)
  v_mfma_f32_16x16x32_bf16 v[8:11], a[236:239], v[48:51], v[8:11]
  ds_read_b128 v[44:47], v85 offset:8192
  v_fma_f32 v1, v1, v75, v75
  v_rcp_f32 v1, v1
  v_mfma_f32_16x16x32_bf16 v[12:15], a[240:243], v[48:51], v[12:15]
  v_fma_f32 v2, v2, v75, v75
  v_fma_f32 v3, v3, v75, v75
  v_rcp_f32 v2, v2
  v_mfma_f32_16x16x32_bf16 v[16:19], a[244:247], v[48:51], v[16:19]
  v_fma_f32 v84, v84, v75, v75
  v_rcp_f32 v3, v3
  s_waitcnt lgkmcnt(4)
  v_mfma_f32_16x16x32_bf16 v[8:11], a[248:251], v[52:55], v[8:11]
  ds_read_b128 v[48:51], v85 offset:9216
  v_rcp_f32 v84, v84
  v_mfma_f32_16x16x32_bf16 v[12:15], a[252:255], v[52:55], v[12:15]
  v_fma_f32 v24, v36, v72, v24
  v_fma_f32 v25, v37, v72, v25
  v_mfma_f32_16x16x32_bf16 v[16:19], v[112:115], v[52:55], v[16:19]
  s_add_u32 s101, s101, 4096
  buffer_load_dwordx4 v[240:243], v110, s[8:11], s101 offen offset:0 sc1
  v_mul_f32 v4, v24, v24
  s_waitcnt lgkmcnt(4)
  v_mfma_f32_16x16x32_bf16 v[8:11], v[116:119], v[56:59], v[8:11]
  ds_read_b128 v[52:55], v85 offset:10240
  v_mul_f32 v5, v25, v25
  v_mfma_f32_16x16x32_bf16 v[12:15], v[120:123], v[56:59], v[12:15]
  v_fma_f32 v4, v4, v74, v73
  v_fma_f32 v5, v5, v74, v73
  v_mfma_f32_16x16x32_bf16 v[16:19], v[124:127], v[56:59], v[16:19]
  v_mul_f32 v4, v4, v24
  v_mul_f32 v5, v5, v25
  v_exp_f32 v4, v4
  s_waitcnt lgkmcnt(4)
  v_mfma_f32_16x16x32_bf16 v[8:11], v[128:131], v[60:63], v[8:11]
  ds_read_b128 v[56:59], v85 offset:11264
  v_exp_f32 v5, v5
  v_mfma_f32_16x16x32_bf16 v[12:15], v[132:135], v[60:63], v[12:15]
  v_fma_f32 v26, v38, v72, v26
  v_fma_f32 v27, v39, v72, v27
  v_mfma_f32_16x16x32_bf16 v[16:19], v[136:139], v[60:63], v[16:19]
  buffer_load_dwordx4 v[244:247], v110, s[8:11], s101 offen offset:1024 sc1
  v_mul_f32 v6, v26, v26
  s_waitcnt lgkmcnt(4)
  v_mfma_f32_16x16x32_bf16 v[8:11], v[140:143], v[64:67], v[8:11]
  ds_read_b128 v[60:63], v85 offset:12288
  v_mul_f32 v7, v27, v27
  v_mfma_f32_16x16x32_bf16 v[12:15], v[144:147], v[64:67], v[12:15]
  v_fma_f32 v6, v6, v74, v73
  v_fma_f32 v7, v7, v74, v73
  v_mfma_f32_16x16x32_bf16 v[16:19], v[148:151], v[64:67], v[16:19]
  v_mul_f32 v6, v6, v26
  v_mul_f32 v7, v7, v27
  v_exp_f32 v6, v6
  s_waitcnt lgkmcnt(4)
  v_mfma_f32_16x16x32_bf16 v[8:11], v[152:155], v[44:47], v[8:11]
  ds_read_b128 v[64:67], v85 offset:13312
  v_exp_f32 v7, v7
  v_mfma_f32_16x16x32_bf16 v[12:15], v[156:159], v[44:47], v[12:15]
  v_fma_f32 v4, v4, v75, v75
  v_fma_f32 v5, v5, v75, v75
  v_rcp_f32 v4, v4
  v_mfma_f32_16x16x32_bf16 v[16:19], v[160:163], v[44:47], v[16:19]
  buffer_load_dwordx4 v[248:251], v110, s[8:11], s101 offen offset:2048 sc1
  v_rcp_f32 v5, v5
  s_waitcnt lgkmcnt(4)
  v_mfma_f32_16x16x32_bf16 v[8:11], v[164:167], v[48:51], v[8:11]
  ds_read_b128 v[44:47], v85 offset:14336
  v_fma_f32 v6, v6, v75, v75
  v_rcp_f32 v6, v6
  v_mfma_f32_16x16x32_bf16 v[12:15], v[168:171], v[48:51], v[12:15]
  v_fma_f32 v7, v7, v75, v75
  v_mul_f32 v20, v20, v1
  v_rcp_f32 v7, v7
  v_mfma_f32_16x16x32_bf16 v[16:19], v[172:175], v[48:51], v[16:19]
  v_mul_f32 v21, v21, v2
  v_mul_f32 v22, v22, v3
  s_waitcnt lgkmcnt(4)
  v_mfma_f32_16x16x32_bf16 v[8:11], v[176:179], v[52:55], v[8:11]
  ds_read_b128 v[48:51], v85 offset:15360
  v_mul_f32 v23, v23, v84
  v_mfma_f32_16x16x32_bf16 v[12:15], v[180:183], v[52:55], v[12:15]
  v_cvt_pk_bf16_f32 v20, v20, v21
  v_cvt_pk_bf16_f32 v21, v22, v23
  v_mfma_f32_16x16x32_bf16 v[16:19], v[184:187], v[52:55], v[16:19]
  buffer_load_dwordx4 v[252:255], v110, s[8:11], s101 offen offset:3072 sc1
  v_fma_f32 v28, v40, v72, v28
  s_waitcnt lgkmcnt(4)
  v_mfma_f32_16x16x32_bf16 v[8:11], v[188:191], v[56:59], v[8:11]
  ds_read_b128 v[52:55], v85 offset:16384
  v_fma_f32 v29, v41, v72, v29
  v_mfma_f32_16x16x32_bf16 v[12:15], v[192:195], v[56:59], v[12:15]
  v_mul_f32 v1, v28, v28
  v_mul_f32 v2, v29, v29
  v_mfma_f32_16x16x32_bf16 v[16:19], a[0:3], v[56:59], v[16:19]
  v_fma_f32 v1, v1, v74, v73
  v_fma_f32 v2, v2, v74, v73
  s_waitcnt lgkmcnt(4)
  v_mfma_f32_16x16x32_bf16 v[8:11], a[4:7], v[60:63], v[8:11]
  ds_read_b128 v[56:59], v85 offset:17408
  v_mul_f32 v1, v1, v28
  v_exp_f32 v1, v1
  v_mfma_f32_16x16x32_bf16 v[12:15], a[8:11], v[60:63], v[12:15]
  v_mul_f32 v2, v2, v29
  v_fma_f32 v30, v42, v72, v30
  v_exp_f32 v2, v2
  v_mfma_f32_16x16x32_bf16 v[16:19], a[12:15], v[60:63], v[16:19]
  v_fma_f32 v31, v43, v72, v31
  v_mul_f32 v3, v30, v30
  s_waitcnt lgkmcnt(4)
  v_mfma_f32_16x16x32_bf16 v[8:11], a[16:19], v[64:67], v[8:11]
  ds_read_b128 v[60:63], v85 offset:18432
  v_mul_f32 v84, v31, v31
  v_mfma_f32_16x16x32_bf16 v[12:15], a[20:23], v[64:67], v[12:15]
  v_fma_f32 v3, v3, v74, v73
  v_fma_f32 v84, v84, v74, v73
  v_mfma_f32_16x16x32_bf16 v[16:19], a[24:27], v[64:67], v[16:19]
  v_mul_f32 v3, v3, v30
  v_mul_f32 v84, v84, v31
  v_exp_f32 v3, v3
  s_waitcnt lgkmcnt(4)
  v_mfma_f32_16x16x32_bf16 v[8:11], a[28:31], v[44:47], v[8:11]
  ds_read_b128 v[64:67], v85 offset:19456
  v_exp_f32 v84, v84
  v_mfma_f32_16x16x32_bf16 v[12:15], a[32:35], v[44:47], v[12:15]
  v_fma_f32 v1, v1, v75, v75
  v_fma_f32 v2, v2, v75, v75
  v_rcp_f32 v1, v1
  v_mfma_f32_16x16x32_bf16 v[16:19], a[36:39], v[44:47], v[16:19]
  v_fma_f32 v3, v3, v75, v75
  v_rcp_f32 v2, v2
  s_waitcnt lgkmcnt(4)
  v_mfma_f32_16x16x32_bf16 v[8:11], a[40:43], v[48:51], v[8:11]
  s_waitcnt vmcnt(19)
  s_barrier
  v_add_u32 v85, 20480, v85
  ds_read_b128 v[44:47], v85 offset:0
  v_rcp_f32 v3, v3
  v_mfma_f32_16x16x32_bf16 v[12:15], a[44:47], v[48:51], v[12:15]
  v_fma_f32 v84, v84, v75, v75
  v_mul_f32 v24, v24, v4
  v_rcp_f32 v84, v84
  v_mfma_f32_16x16x32_bf16 v[16:19], a[48:51], v[48:51], v[16:19]
  v_mul_f32 v25, v25, v5
  v_mul_f32 v26, v26, v6
  s_waitcnt lgkmcnt(4)
  v_mfma_f32_16x16x32_bf16 v[8:11], a[52:55], v[52:55], v[8:11]
  ds_read_b128 v[48:51], v85 offset:1024
  v_mul_f32 v27, v27, v7
  v_mfma_f32_16x16x32_bf16 v[12:15], a[56:59], v[52:55], v[12:15]
  v_cvt_pk_bf16_f32 v22, v24, v25
  v_cvt_pk_bf16_f32 v23, v26, v27
  v_mfma_f32_16x16x32_bf16 v[16:19], a[60:63], v[52:55], v[16:19]
  buffer_store_dwordx4 v[20:23], v110, s[12:15], s29 offen offset:1024
  buffer_store_dwordx4 v[20:23], v110, s[16:19], s29 offen offset:1024 sc1
  v_mul_f32 v28, v28, v1
  s_waitcnt lgkmcnt(4)
  v_mfma_f32_16x16x32_bf16 v[8:11], a[64:67], v[56:59], v[8:11]
  ds_read_b128 v[52:55], v85 offset:2048
  v_mul_f32 v29, v29, v2
  v_mfma_f32_16x16x32_bf16 v[12:15], a[68:71], v[56:59], v[12:15]
  v_mul_f32 v30, v30, v3
  v_mul_f32 v31, v31, v84
  v_mfma_f32_16x16x32_bf16 v[16:19], a[72:75], v[56:59], v[16:19]
  v_cvt_pk_bf16_f32 v24, v28, v29
  v_cvt_pk_bf16_f32 v25, v30, v31
  s_waitcnt lgkmcnt(4)
  v_mfma_f32_16x16x32_bf16 v[8:11], a[76:79], v[60:63], v[8:11]
  ds_read_b128 v[56:59], v85 offset:3072
  buffer_store_dwordx2 v[24:25], v110, s[12:15], s30 offen offset:1024
  buffer_store_dwordx2 v[24:25], v110, s[16:19], s30 offen offset:1024 sc1
  v_mfma_f32_16x16x32_bf16 v[12:15], a[80:83], v[60:63], v[12:15]
  v_mfma_f32_16x16x32_bf16 v[16:19], a[84:87], v[60:63], v[16:19]
  s_waitcnt lgkmcnt(4)
  v_mfma_f32_16x16x32_bf16 v[8:11], a[88:91], v[64:67], v[8:11]
  ds_read_b128 v[60:63], v85 offset:4096
  v_mfma_f32_16x16x32_bf16 v[12:15], a[92:95], v[64:67], v[12:15]
  v_mfma_f32_16x16x32_bf16 v[16:19], a[96:99], v[64:67], v[16:19]
  s_waitcnt lgkmcnt(4)
  v_mfma_f32_16x16x32_bf16 v[20:23], a[200:203], v[44:47], 0
  ds_read_b128 v[64:67], v85 offset:5120
  v_mfma_f32_16x16x32_bf16 v[24:27], a[204:207], v[44:47], 0
  s_add_u32 s101, s101, 4096
  buffer_load_dwordx4 a[200:203], v110, s[8:11], s101 offen offset:0 sc1
  v_mfma_f32_16x16x32_bf16 v[28:31], a[208:211], v[44:47], 0
  v_fma_f32 v8, v32, v76, v8
  v_fma_f32 v9, v33, v76, v9
  v_mul_f32 v1, v8, v8
  s_waitcnt lgkmcnt(4)
  v_mfma_f32_16x16x32_bf16 v[20:23], a[212:215], v[48:51], v[20:23]
  ds_read_b128 v[44:47], v85 offset:6144
  v_mul_f32 v2, v9, v9
  v_fma_f32 v1, v1, v78, v77
  v_mfma_f32_16x16x32_bf16 v[24:27], a[216:219], v[48:51], v[24:27]
  v_fma_f32 v2, v2, v78, v77
  v_mul_f32 v1, v1, v8
  v_mul_f32 v2, v2, v9
  v_exp_f32 v1, v1
  v_mfma_f32_16x16x32_bf16 v[28:31], a[220:223], v[48:51], v[28:31]
  buffer_load_dwordx4 a[204:207], v110, s[8:11], s101 offen offset:1024 sc1
  v_fma_f32 v10, v34, v76, v10
  v_exp_f32 v2, v2
  s_waitcnt lgkmcnt(4)
  v_mfma_f32_16x16x32_bf16 v[20:23], a[224:227], v[52:55], v[20:23]
  ds_read_b128 v[48:51], v85 offset:7168
  v_fma_f32 v11, v35, v76, v11
  v_mul_f32 v3, v10, v10
  v_mfma_f32_16x16x32_bf16 v[24:27], a[228:231], v[52:55], v[24:27]
  v_mul_f32 v84, v11, v11
  v_fma_f32 v3, v3, v78, v77
  v_fma_f32 v84, v84, v78, v77
  v_mfma_f32_16x16x32_bf16 v[28:31], a[232:235], v[52:55], v[28:31]
  v_mul_f32 v3, v3, v10
  v_mul_f32 v84, v84, v11
  v_fma_f32 v1, v1, v79, v79
  v_exp_f32 v3, v3
  s_waitcnt lgkmcnt(4)
  v_mfma_f32_16x16x32_bf16 v[20:23], a[236:239], v[56:59], v[20:23]
  ds_read_b128 v[52:55], v85 offset:8192
  buffer_load_dwordx4 a[208:211], v110, s[8:11], s101 offen offset:2048 sc1
  v_exp_f32 v84, v84
  v_mfma_f32_16x16x32_bf16 v[24:27], a[240:243], v[56:59], v[24:27]
  v_fma_f32 v2, v2, v79, v79
  v_rcp_f32 v1, v1
  v_mfma_f32_16x16x32_bf16 v[28:31], a[244:247], v[56:59], v[28:31]
  v_fma_f32 v3, v3, v79, v79
  v_rcp_f32 v2, v2
  s_waitcnt lgkmcnt(4)
  v_mfma_f32_16x16x32_bf16 v[20:23], a[248:251], v[60:63], v[20:23]
  ds_read_b128 v[56:59], v85 offset:9216
  v_rcp_f32 v3, v3
  v_mfma_f32_16x16x32_bf16 v[24:27], a[252:255], v[60:63], v[24:27]
  buffer_load_dwordx4 a[212:215], v110, s[8:11], s101 offen offset:3072 sc1
  v_fma_f32 v84, v84, v79, v79
  v_rcp_f32 v84, v84
  v_mfma_f32_16x16x32_bf16 v[28:31], v[112:115], v[60:63], v[28:31]
  v_fma_f32 v12, v36, v76, v12
  v_fma_f32 v13, v37, v76, v13
  s_waitcnt lgkmcnt(4)
  v_mfma_f32_16x16x32_bf16 v[20:23], v[116:119], v[64:67], v[20:23]
  ds_read_b128 v[60:63], v85 offset:10240
  v_mul_f32 v4, v12, v12
  v_mfma_f32_16x16x32_bf16 v[24:27], v[120:123], v[64:67], v[24:27]
  v_mul_f32 v5, v13, v13
  v_fma_f32 v4, v4, v78, v77
  v_mfma_f32_16x16x32_bf16 v[28:31], v[124:127], v[64:67], v[28:31]
  s_add_u32 s101, s101, 4096
  buffer_load_dwordx4 a[216:219], v110, s[8:11], s101 offen offset:0 sc1
  v_fma_f32 v5, v5, v78, v77
  s_waitcnt lgkmcnt(4)
  v_mfma_f32_16x16x32_bf16 v[20:23], v[128:131], v[44:47], v[20:23]
  ds_read_b128 v[64:67], v85 offset:11264
  v_mul_f32 v4, v4, v12
  v_exp_f32 v4, v4
  v_mfma_f32_16x16x32_bf16 v[24:27], v[132:135], v[44:47], v[24:27]
  v_mul_f32 v5, v5, v13
  v_fma_f32 v14, v38, v76, v14
  v_exp_f32 v5, v5
  v_mfma_f32_16x16x32_bf16 v[28:31], v[136:139], v[44:47], v[28:31]
  v_fma_f32 v15, v39, v76, v15
  v_mul_f32 v6, v14, v14
  s_waitcnt lgkmcnt(4)
  v_mfma_f32_16x16x32_bf16 v[20:23], v[140:143], v[48:51], v[20:23]
  ds_read_b128 v[44:47], v85 offset:12288
  buffer_load_dwordx4 a[220:223], v110, s[8:11], s101 offen offset:1024 sc1
  v_mfma_f32_16x16x32_bf16 v[24:27], v[144:147], v[48:51], v[24:27]
  v_mul_f32 v7, v15, v15
  v_fma_f32 v6, v6, v78, v77
  v_mfma_f32_16x16x32_bf16 v[28:31], v[148:151], v[48:51], v[28:31]
  v_fma_f32 v7, v7, v78, v77
  v_mul_f32 v6, v6, v14
  v_exp_f32 v6, v6
  s_waitcnt lgkmcnt(4)
  v_mfma_f32_16x16x32_bf16 v[20:23], v[152:155], v[52:55], v[20:23]
  ds_read_b128 v[48:51], v85 offset:13312
  v_mul_f32 v7, v7, v15
  v_exp_f32 v7, v7
  v_mfma_f32_16x16x32_bf16 v[24:27], v[156:159], v[52:55], v[24:27]
  buffer_load_dwordx4 a[224:227], v110, s[8:11], s101 offen offset:2048 sc1
  v_fma_f32 v4, v4, v79, v79
  v_rcp_f32 v4, v4
  v_mfma_f32_16x16x32_bf16 v[28:31], v[160:163], v[52:55], v[28:31]
  v_fma_f32 v5, v5, v79, v79
  v_fma_f32 v6, v6, v79, v79
  v_rcp_f32 v5, v5
  s_waitcnt lgkmcnt(4)
  v_mfma_f32_16x16x32_bf16 v[20:23], v[164:167], v[56:59], v[20:23]
  ds_read_b128 v[52:55], v85 offset:14336
  v_rcp_f32 v6, v6
  v_mfma_f32_16x16x32_bf16 v[24:27], v[168:171], v[56:59], v[24:27]
  v_fma_f32 v7, v7, v79, v79
  v_mul_f32 v8, v8, v1
  v_rcp_f32 v7, v7
  v_mfma_f32_16x16x32_bf16 v[28:31], v[172:175], v[56:59], v[28:31]
  buffer_load_dwordx4 a[228:231], v110, s[8:11], s101 offen offset:3072 sc1
  v_mul_f32 v9, v9, v2
  s_waitcnt lgkmcnt(4)
  v_mfma_f32_16x16x32_bf16 v[20:23], v[176:179], v[60:63], v[20:23]
  ds_read_b128 v[56:59], v85 offset:15360
  v_mul_f32 v10, v10, v3
  v_mfma_f32_16x16x32_bf16 v[24:27], v[180:183], v[60:63], v[24:27]
  v_mul_f32 v11, v11, v84
  v_cvt_pk_bf16_f32 v8, v8, v9
  v_mfma_f32_16x16x32_bf16 v[28:31], v[184:187], v[60:63], v[28:31]
  v_cvt_pk_bf16_f32 v9, v10, v11
  v_fma_f32 v16, v40, v76, v16
  s_waitcnt lgkmcnt(4)
  v_mfma_f32_16x16x32_bf16 v[20:23], v[188:191], v[64:67], v[20:23]
  ds_read_b128 v[60:63], v85 offset:16384
  s_add_u32 s101, s101, 4096
  buffer_load_dwordx4 a[232:235], v110, s[8:11], s101 offen offset:0 sc1
  v_mfma_f32_16x16x32_bf16 v[24:27], v[192:195], v[64:67], v[24:27]
  v_fma_f32 v17, v41, v76, v17
  v_mul_f32 v1, v16, v16
  v_mfma_f32_16x16x32_bf16 v[28:31], a[0:3], v[64:67], v[28:31]
  v_mul_f32 v2, v17, v17
  v_fma_f32 v1, v1, v78, v77
  s_waitcnt lgkmcnt(4)
  v_mfma_f32_16x16x32_bf16 v[20:23], a[4:7], v[44:47], v[20:23]
  ds_read_b128 v[64:67], v85 offset:17408
  v_fma_f32 v2, v2, v78, v77
  v_mfma_f32_16x16x32_bf16 v[24:27], a[8:11], v[44:47], v[24:27]
  buffer_load_dwordx4 a[236:239], v110, s[8:11], s101 offen offset:1024 sc1
  v_mul_f32 v1, v1, v16
  v_exp_f32 v1, v1
  v_mfma_f32_16x16x32_bf16 v[28:31], a[12:15], v[44:47], v[28:31]
  v_mul_f32 v2, v2, v17
  v_fma_f32 v18, v42, v76, v18
  v_exp_f32 v2, v2
  s_waitcnt lgkmcnt(4)
  v_mfma_f32_16x16x32_bf16 v[20:23], a[16:19], v[48:51], v[20:23]
  ds_read_b128 v[44:47], v85 offset:18432
  v_fma_f32 v19, v43, v76, v19
  v_mfma_f32_16x16x32_bf16 v[24:27], a[20:23], v[48:51], v[24:27]
  v_mul_f32 v3, v18, v18
  v_mul_f32 v84, v19, v19
  v_mfma_f32_16x16x32_bf16 v[28:31], a[24:27], v[48:51], v[28:31]
  buffer_load_dwordx4 a[240:243], v110, s[8:11], s101 offen offset:2048 sc1
  v_fma_f32 v3, v3, v78, v77
  s_waitcnt lgkmcnt(4)
  v_mfma_f32_16x16x32_bf16 v[20:23], a[28:31], v[52:55], v[20:23]
  ds_read_b128 v[48:51], v85 offset:19456
  v_fma_f32 v84, v84, v78, v77
  v_mfma_f32_16x16x32_bf16 v[24:27], a[32:35], v[52:55], v[24:27]
  v_mul_f32 v3, v3, v18
  v_mul_f32 v84, v84, v19
  v_exp_f32 v3, v3
  v_mfma_f32_16x16x32_bf16 v[28:31], a[36:39], v[52:55], v[28:31]
  v_fma_f32 v1, v1, v79, v79
  v_exp_f32 v84, v84
  s_waitcnt lgkmcnt(4)
  v_mfma_f32_16x16x32_bf16 v[20:23], a[40:43], v[56:59], v[20:23]
  buffer_load_dwordx4 a[244:247], v110, s[8:11], s101 offen offset:3072 sc1
  v_rcp_f32 v1, v1
  v_mfma_f32_16x16x32_bf16 v[24:27], a[44:47], v[56:59], v[24:27]
  v_fma_f32 v2, v2, v79, v79
  v_fma_f32 v3, v3, v79, v79
  v_rcp_f32 v2, v2
  v_mfma_f32_16x16x32_bf16 v[28:31], a[48:51], v[56:59], v[28:31]
  v_fma_f32 v84, v84, v79, v79
  v_rcp_f32 v3, v3
  s_waitcnt lgkmcnt(3)
  v_mfma_f32_16x16x32_bf16 v[20:23], a[52:55], v[60:63], v[20:23]
  v_mul_f32 v12, v12, v4
  v_rcp_f32 v84, v84
  v_mfma_f32_16x16x32_bf16 v[24:27], a[56:59], v[60:63], v[24:27]
  s_add_u32 s101, s101, 4096
  buffer_load_dwordx4 a[248:251], v110, s[8:11], s101 offen offset:0 sc1
  v_mul_f32 v13, v13, v5
  v_mfma_f32_16x16x32_bf16 v[28:31], a[60:63], v[60:63], v[28:31]
  v_mul_f32 v14, v14, v6
  v_mul_f32 v15, v15, v7
  s_waitcnt lgkmcnt(2)
  v_mfma_f32_16x16x32_bf16 v[20:23], a[64:67], v[64:67], v[20:23]
  v_cvt_pk_bf16_f32 v10, v12, v13
  v_cvt_pk_bf16_f32 v11, v14, v15
  v_mfma_f32_16x16x32_bf16 v[24:27], a[68:71], v[64:67], v[24:27]
  buffer_store_dwordx4 v[8:11], v110, s[12:15], s29 offen offset:2048
  buffer_store_dwordx4 v[8:11], v110, s[16:19], s29 offen offset:2048 sc1
  v_mul_f32 v16, v16, v1
  v_mfma_f32_16x16x32_bf16 v[28:31], a[72:75], v[64:67], v[28:31]
  buffer_load_dwordx4 a[252:255], v110, s[8:11], s101 offen offset:1024 sc1
  v_mul_f32 v17, v17, v2
  s_waitcnt lgkmcnt(1)
  v_mfma_f32_16x16x32_bf16 v[20:23], a[76:79], v[44:47], v[20:23]
  v_mul_f32 v18, v18, v3
  v_mul_f32 v19, v19, v84
  v_mfma_f32_16x16x32_bf16 v[24:27], a[80:83], v[44:47], v[24:27]
  v_cvt_pk_bf16_f32 v12, v16, v17
  v_cvt_pk_bf16_f32 v13, v18, v19
  v_mfma_f32_16x16x32_bf16 v[28:31], a[84:87], v[44:47], v[28:31]
  buffer_store_dwordx2 v[12:13], v110, s[12:15], s30 offen offset:2048
  buffer_store_dwordx2 v[12:13], v110, s[16:19], s30 offen offset:2048 sc1
  s_waitcnt lgkmcnt(0)
  v_mfma_f32_16x16x32_bf16 v[20:23], a[88:91], v[48:51], v[20:23]
  buffer_load_dwordx4 v[112:115], v110, s[8:11], s101 offen offset:2048 sc1
  v_mfma_f32_16x16x32_bf16 v[24:27], a[92:95], v[48:51], v[24:27]
  v_mfma_f32_16x16x32_bf16 v[28:31], a[96:99], v[48:51], v[28:31]
  s_barrier
  s_nop 3
  v_pk_fma_f32 v[20:21], v[32:33], v[80:81], v[20:21] op_sel_hi:[1,0,1]
  v_pk_fma_f32 v[22:23], v[34:35], v[80:81], v[22:23] op_sel_hi:[1,0,1]
  v_pk_fma_f32 v[24:25], v[36:37], v[80:81], v[24:25] op_sel_hi:[1,0,1]
  v_pk_fma_f32 v[26:27], v[38:39], v[80:81], v[26:27] op_sel_hi:[1,0,1]
  v_pk_fma_f32 v[28:29], v[40:41], v[80:81], v[28:29] op_sel_hi:[1,0,1]
  v_pk_fma_f32 v[30:31], v[42:43], v[80:81], v[30:31] op_sel_hi:[1,0,1]
  v_pk_mul_f32 v[44:45], v[20:21], v[20:21]
  v_pk_mul_f32 v[46:47], v[22:23], v[22:23]
  v_pk_mul_f32 v[48:49], v[24:25], v[24:25]
  v_pk_mul_f32 v[50:51], v[26:27], v[26:27]
  v_pk_mul_f32 v[52:53], v[28:29], v[28:29]
  v_pk_mul_f32 v[54:55], v[30:31], v[30:31]
  v_pk_fma_f32 v[44:45], v[44:45], v[82:83], v[80:81] op_sel:[0,0,1] op_sel_hi:[1,0,1]
  v_pk_fma_f32 v[46:47], v[46:47], v[82:83], v[80:81] op_sel:[0,0,1] op_sel_hi:[1,0,1]
  v_pk_fma_f32 v[48:49], v[48:49], v[82:83], v[80:81] op_sel:[0,0,1] op_sel_hi:[1,0,1]
  v_pk_fma_f32 v[50:51], v[50:51], v[82:83], v[80:81] op_sel:[0,0,1] op_sel_hi:[1,0,1]
  v_pk_fma_f32 v[52:53], v[52:53], v[82:83], v[80:81] op_sel:[0,0,1] op_sel_hi:[1,0,1]
  v_pk_fma_f32 v[54:55], v[54:55], v[82:83], v[80:81] op_sel:[0,0,1] op_sel_hi:[1,0,1]
  v_pk_mul_f32 v[44:45], v[44:45], v[20:21]
  v_pk_mul_f32 v[46:47], v[46:47], v[22:23]
  v_pk_mul_f32 v[48:49], v[48:49], v[24:25]
  v_pk_mul_f32 v[50:51], v[50:51], v[26:27]
  v_pk_mul_f32 v[52:53], v[52:53], v[28:29]
  v_pk_mul_f32 v[54:55], v[54:55], v[30:31]
  v_exp_f32 v44, v44
  v_exp_f32 v45, v45
  v_exp_f32 v46, v46
  v_exp_f32 v47, v47
  v_exp_f32 v48, v48
  v_exp_f32 v49, v49
  v_exp_f32 v50, v50
  v_exp_f32 v51, v51
  v_exp_f32 v52, v52
  v_exp_f32 v53, v53
  v_exp_f32 v54, v54
  v_exp_f32 v55, v55
  v_pk_fma_f32 v[44:45], v[44:45], v[82:83], v[82:83] op_sel:[0,1,1] op_sel_hi:[1,1,1]
  v_pk_fma_f32 v[46:47], v[46:47], v[82:83], v[82:83] op_sel:[0,1,1] op_sel_hi:[1,1,1]
  v_pk_fma_f32 v[48:49], v[48:49], v[82:83], v[82:83] op_sel:[0,1,1] op_sel_hi:[1,1,1]
  v_pk_fma_f32 v[50:51], v[50:51], v[82:83], v[82:83] op_sel:[0,1,1] op_sel_hi:[1,1,1]
  v_pk_fma_f32 v[52:53], v[52:53], v[82:83], v[82:83] op_sel:[0,1,1] op_sel_hi:[1,1,1]
  v_pk_fma_f32 v[54:55], v[54:55], v[82:83], v[82:83] op_sel:[0,1,1] op_sel_hi:[1,1,1]
  v_rcp_f32 v44, v44
  v_rcp_f32 v45, v45
  v_rcp_f32 v46, v46
  v_rcp_f32 v47, v47
  v_rcp_f32 v48, v48
  v_rcp_f32 v49, v49
  v_rcp_f32 v50, v50
  v_rcp_f32 v51, v51
  v_rcp_f32 v52, v52
  v_rcp_f32 v53, v53
  v_rcp_f32 v54, v54
  v_rcp_f32 v55, v55
  v_pk_mul_f32 v[44:45], v[44:45], v[20:21]
  v_pk_mul_f32 v[46:47], v[46:47], v[22:23]
  v_pk_mul_f32 v[48:49], v[48:49], v[24:25]
  v_pk_mul_f32 v[50:51], v[50:51], v[26:27]
  v_pk_mul_f32 v[52:53], v[52:53], v[28:29]
  v_pk_mul_f32 v[54:55], v[54:55], v[30:31]
  v_cvt_pk_bf16_f32 v20, v44, v45
  v_cvt_pk_bf16_f32 v21, v46, v47
  v_cvt_pk_bf16_f32 v22, v48, v49
  v_cvt_pk_bf16_f32 v23, v50, v51
  v_cvt_pk_bf16_f32 v24, v52, v53
  v_cvt_pk_bf16_f32 v25, v54, v55
  buffer_store_dwordx4 v[20:23], v110, s[12:15], s29 offen offset:3072
  buffer_store_dwordx4 v[20:23], v110, s[16:19], s29 offen offset:3072 sc1
  buffer_store_dwordx2 v[24:25], v110, s[12:15], s30 offen offset:3072
  buffer_store_dwordx2 v[24:25], v110, s[16:19], s30 offen offset:3072 sc1
  buffer_load_dwordx4 v[116:119], v110, s[8:11], s101 offen offset:3072 sc1
  s_add_u32 s101, s101, 4096
  buffer_load_dwordx4 v[120:123], v110, s[8:11], s101 offen offset:0 sc1
  buffer_load_dwordx4 v[124:127], v110, s[8:11], s101 offen offset:1024 sc1
  buffer_load_dwordx4 v[128:131], v110, s[8:11], s101 offen offset:2048 sc1
  buffer_load_dwordx4 v[132:135], v110, s[8:11], s101 offen offset:3072 sc1
  s_mov_b32 s41, 0xffff0000
  v_lshlrev_b32 v66, 16, v100
  v_and_b32 v67, s41, v100
  v_lshlrev_b32 v68, 16, v101
  v_and_b32 v69, s41, v101
  v_lshlrev_b32 v70, 16, v102
  v_and_b32 v71, s41, v102
  v_lshlrev_b32 v72, 16, v103
  v_and_b32 v73, s41, v103
  v_lshlrev_b32 v74, 16, v104
  v_and_b32 v75, s41, v104
  v_lshlrev_b32 v76, 16, v105
  v_and_b32 v77, s41, v105
  v_lshlrev_b32 v78, 16, v106
  v_and_b32 v79, s41, v106
  v_lshlrev_b32 v80, 16, v107
  v_and_b32 v81, s41, v107
  v_lshlrev_b32 v82, 16, v108
  v_and_b32 v83, s41, v108
  v_lshlrev_b32 v84, 16, v109
  v_and_b32 v85, s41, v109
  s_lshl_b32 s40, s96, 5
  s_add_u32 s40, s40, s6
  s_lshl_b32 s40, s40, 2
  s_add_u32 s40, s40, 163840
  s_waitcnt vmcnt(5)
  v_mov_b32 v2, s3
  v_mov_b32 v3, 0
  s_mov_b64 exec, 1
  buffer_store_dword v2, v3, s[12:15], s40 offen
  buffer_store_dword v2, v3, s[16:19], s40 offen sc1
  s_mov_b64 exec, -1
  s_mov_b32 s40, 163840
  s_mov_b32 s97, 0x20000
  buffer_load_dword v1, v111, s[8:11], s40 offen sc1
  v_lshlrev_b32 v8, 16, v90
  v_and_b32 v9, s41, v90
  v_lshlrev_b32 v10, 16, v91
  v_and_b32 v11, s41, v91
  v_lshlrev_b32 v12, 16, v92
  v_and_b32 v13, s41, v92
  v_lshlrev_b32 v14, 16, v93
  v_and_b32 v15, s41, v93
  v_lshlrev_b32 v16, 16, v94
  v_and_b32 v17, s41, v94
  v_lshlrev_b32 v18, 16, v95
  v_and_b32 v19, s41, v95
  v_lshlrev_b32 v20, 16, v96
  v_and_b32 v21, s41, v96
  v_lshlrev_b32 v22, 16, v97
  v_and_b32 v23, s41, v97
  v_lshlrev_b32 v24, 16, v98
  v_and_b32 v25, s41, v98
  v_lshlrev_b32 v26, 16, v99
  v_and_b32 v27, s41, v99
  v_pk_add_f32 v[8:9], v[8:9], v[66:67]
  v_pk_add_f32 v[10:11], v[10:11], v[68:69]
  v_pk_add_f32 v[12:13], v[12:13], v[70:71]
  v_pk_add_f32 v[14:15], v[14:15], v[72:73]
  v_pk_add_f32 v[16:17], v[16:17], v[74:75]
  v_pk_add_f32 v[18:19], v[18:19], v[76:77]
  v_pk_add_f32 v[20:21], v[20:21], v[78:79]
  v_pk_add_f32 v[22:23], v[22:23], v[80:81]
  v_pk_add_f32 v[24:25], v[24:25], v[82:83]
  v_pk_add_f32 v[26:27], v[26:27], v[84:85]
  s_lshl_b32 s42, s6, 1
  s_mul_i32 s41, s98, 98304
  s_add_u32 s41, s41, 5799936
  s_mul_i32 s43, s98, 25600
  s_add_u32 s43, s43, 8970240
  s_cmp_eq_u32 s42, 3
  s_cselect_b32 s41, s43, s41
  s_mul_i32 s43, s98, 81920
  s_add_u32 s43, s43, 524288
  s_cmp_lt_u32 s42, 3
  s_cselect_b32 s41, s43, s41
  s_mul_i32 s43, s42, 24576
  s_add_u32 s41, s41, s43
  s_add_u32 s42, s42, 1
  s_mul_i32 s44, s98, 98304
  s_add_u32 s44, s44, 5799936
  s_mul_i32 s43, s98, 25600
  s_add_u32 s43, s43, 8970240
  s_cmp_eq_u32 s42, 3
  s_cselect_b32 s44, s43, s44
  s_mul_i32 s43, s98, 81920
  s_add_u32 s43, s43, 524288
  s_cmp_lt_u32 s42, 3
  s_cselect_b32 s44, s43, s44
  s_mul_i32 s43, s42, 24576
  s_add_u32 s44, s44, s43
  s_mul_i32 s42, s6, 20480
  s_add_u32 s42, s42, 81920
  s_lshl_b32 s43, s24, 10
  s_add_u32 s28, s43, s41
  s_add_u32 s32, s43, s42
  s_add_u32 s43, s43, s42
  v_add_u32 v60, s43, v110
  s_lshl_b32 s43, s25, 10
  s_add_u32 s29, s43, s41
  s_add_u32 s33, s43, s42
  s_add_u32 s43, s43, s42
  v_add_u32 v61, s43, v110
  s_lshl_b32 s43, s26, 10
  s_add_u32 s30, s43, s41
  s_add_u32 s34, s43, s42
  s_add_u32 s43, s43, s42
  v_add_u32 v62, s43, v110
  s_lshl_b32 s43, s27, 10
  s_add_u32 s31, s43, s41
  s_add_u32 s35, s43, s42
  s_add_u32 s43, s43, s42
  v_add_u32 v63, s43, v110
  s_sub_u32 s44, s44, s42
  v_subrev_u32 v66, 81920, v60
  v_subrev_u32 v67, 81920, v61
  v_subrev_u32 v68, 81920, v62
  v_subrev_u32 v69, 81920, v63
  v_subrev_u32 v86, 81920, v86
  v_subrev_u32 v87, 81920, v87
  v_subrev_u32 v88, 81920, v88
  v_subrev_u32 v89, 81920, v89
  v_and_b32 v64, 15, v0
  v_mul_u32_u24 v64, 1280, v64
  v_lshrrev_b32 v2, 4, v0
  v_mul_u32_u24 v2, 40, v2
  v_add_u32 v64, v64, v2
  s_lshl_b32 s46, s98, 2
  s_add_u32 s46, s46, s6
  s_mul_i32 s46, s46, 20480
  s_mul_i32 s47, s99, 160
  s_add_u32 s47, s47, s46
  s_branch polle_36
poll_35:
  s_sub_u32 s97, s97, 1
  s_cbranch_scc1 END
  buffer_load_dword v1, v111, s[8:11], s40 offen sc1
polle_36:
  s_waitcnt vmcnt(0)
  v_cmp_ne_u32 vcc, s3, v1
  s_nop 1
  s_cbranch_vccnz poll_35
PAD0:
  s_cbranch_execz PAD1
  s_sub_u32 m0, s32, 81920
  s_nop 0
  buffer_load_dwordx4 v110, s[8:11], s28 offen sc1 lds
  s_sub_u32 m0, s33, 81920
  s_nop 0
  buffer_load_dwordx4 v110, s[8:11], s29 offen sc1 lds
  s_sub_u32 m0, s34, 81920
  s_nop 0
  buffer_load_dwordx4 v110, s[8:11], s30 offen sc1 lds
  s_sub_u32 m0, s35, 81920
  s_nop 0
  buffer_load_dwordx4 v110, s[8:11], s31 offen sc1 lds
  s_sub_u32 m0, s32, 77824
  s_add_u32 s28, s28, 4096
  buffer_load_dwordx4 v110, s[8:11], s28 offen sc1 lds
  s_sub_u32 m0, s33, 77824
  s_add_u32 s29, s29, 4096
  buffer_load_dwordx4 v110, s[8:11], s29 offen sc1 lds
  s_sub_u32 m0, s34, 77824
  s_add_u32 s30, s30, 4096
  buffer_load_dwordx4 v110, s[8:11], s30 offen sc1 lds
  s_sub_u32 m0, s35, 77824
  s_add_u32 s31, s31, 4096
  buffer_load_dwordx4 v110, s[8:11], s31 offen sc1 lds
  s_sub_u32 m0, s32, 73728
  s_add_u32 s28, s28, 4096
  buffer_load_dwordx4 v110, s[8:11], s28 offen sc1 lds
  s_sub_u32 m0, s33, 73728
  s_add_u32 s29, s29, 4096
  buffer_load_dwordx4 v110, s[8:11], s29 offen sc1 lds
  s_sub_u32 m0, s34, 73728
  s_add_u32 s30, s30, 4096
  buffer_load_dwordx4 v110, s[8:11], s30 offen sc1 lds
  s_sub_u32 m0, s35, 73728
  s_add_u32 s31, s31, 4096
  buffer_load_dwordx4 v110, s[8:11], s31 offen sc1 lds
PAD1:
  s_cbranch_execz PAD2
  s_waitcnt vmcnt(11)
  ds_read_b128 v[28:31], v66 offset:0
  s_waitcnt vmcnt(10)
  ds_read_b128 v[32:35], v67 offset:0
  s_waitcnt vmcnt(9)
  ds_read_b128 v[36:39], v68 offset:0
  s_waitcnt vmcnt(8)
  ds_read_b128 v[40:43], v69 offset:0
  s_waitcnt lgkmcnt(3)
  v_mfma_f32_16x16x32_bf16 v[136:139], a[100:103], v[28:31], 0
  s_waitcnt vmcnt(7)
  ds_read_b128 v[44:47], v66 offset:4096
  v_mfma_f32_16x16x32_bf16 v[140:143], a[104:107], v[28:31], 0
  s_sub_u32 m0, s32, 69632
  s_add_u32 s28, s28, 4096
  buffer_load_dwordx4 v110, s[8:11], s28 offen sc1 lds
  v_mfma_f32_16x16x32_bf16 v[144:147], a[108:111], v[28:31], 0
  v_mfma_f32_16x16x32_bf16 v[148:151], a[112:115], v[28:31], 0
  s_sub_u32 m0, s33, 69632
  s_add_u32 s29, s29, 4096
  buffer_load_dwordx4 v110, s[8:11], s29 offen sc1 lds
  v_mfma_f32_16x16x32_bf16 v[152:155], a[116:119], v[28:31], 0
  s_waitcnt lgkmcnt(3)
  v_mfma_f32_16x16x32_bf16 v[156:159], a[100:103], v[32:35], 0
  s_waitcnt vmcnt(8)
  ds_read_b128 v[48:51], v67 offset:4096
  v_mfma_f32_16x16x32_bf16 v[160:163], a[104:107], v[32:35], 0
PAD2:
  s_cbranch_execz PAD3
  s_sub_u32 m0, s34, 69632
  s_add_u32 s30, s30, 4096
  buffer_load_dwordx4 v110, s[8:11], s30 offen sc1 lds
  v_mfma_f32_16x16x32_bf16 v[164:167], a[108:111], v[32:35], 0
  v_mfma_f32_16x16x32_bf16 v[168:171], a[112:115], v[32:35], 0
  s_sub_u32 m0, s35, 69632
  s_add_u32 s31, s31, 4096
  buffer_load_dwordx4 v110, s[8:11], s31 offen sc1 lds
  v_mfma_f32_16x16x32_bf16 v[172:175], a[116:119], v[32:35], 0
  s_waitcnt lgkmcnt(3)
  v_mfma_f32_16x16x32_bf16 v[176:179], a[100:103], v[36:39], 0
  s_waitcnt vmcnt(9)
  ds_read_b128 v[52:55], v68 offset:4096
  v_mfma_f32_16x16x32_bf16 v[180:183], a[104:107], v[36:39], 0
  s_sub_u32 m0, s32, 65536
  s_add_u32 s28, s28, 4096
  buffer_load_dwordx4 v110, s[8:11], s28 offen sc1 lds
  v_mfma_f32_16x16x32_bf16 v[184:187], a[108:111], v[36:39], 0
  v_mfma_f32_16x16x32_bf16 v[188:191], a[112:115], v[36:39], 0
PAD3:
  s_cbranch_execz PAD4
  s_sub_u32 m0, s33, 65536
  s_add_u32 s29, s29, 4096
  buffer_load_dwordx4 v110, s[8:11], s29 offen sc1 lds
  v_mfma_f32_16x16x32_bf16 v[192:195], a[116:119], v[36:39], 0
  s_waitcnt lgkmcnt(3)
  v_mfma_f32_16x16x32_bf16 v[8:11], a[100:103], v[40:43], v[8:11]
  s_waitcnt vmcnt(10)
  ds_read_b128 v[56:59], v69 offset:4096
  v_mfma_f32_16x16x32_bf16 v[12:15], a[104:107], v[40:43], v[12:15]
  s_sub_u32 m0, s34, 65536
  s_add_u32 s30, s30, 4096
  buffer_load_dwordx4 v110, s[8:11], s30 offen sc1 lds
  v_mfma_f32_16x16x32_bf16 v[16:19], a[108:111], v[40:43], v[16:19]
  v_mfma_f32_16x16x32_bf16 v[20:23], a[112:115], v[40:43], v[20:23]
  s_sub_u32 m0, s35, 65536
  s_add_u32 s31, s31, 4096
  buffer_load_dwordx4 v110, s[8:11], s31 offen sc1 lds
  v_mfma_f32_16x16x32_bf16 v[24:27], a[116:119], v[40:43], v[24:27]
  s_waitcnt lgkmcnt(3)
  v_mfma_f32_16x16x32_bf16 v[136:139], a[120:123], v[44:47], v[136:139]
  s_waitcnt vmcnt(11)
  ds_read_b128 v[28:31], v66 offset:8192
PAD4:
  s_cbranch_execz PAD5
  v_mfma_f32_16x16x32_bf16 v[140:143], a[124:127], v[44:47], v[140:143]
  s_sub_u32 m0, s32, 81920
  s_add_u32 s28, s28, 4096
  buffer_load_dwordx4 v110, s[8:11], s28 offen sc1 lds
  v_mfma_f32_16x16x32_bf16 v[144:147], a[128:131], v[44:47], v[144:147]
  v_mfma_f32_16x16x32_bf16 v[148:151], a[132:135], v[44:47], v[148:151]
  s_sub_u32 m0, s33, 81920
  s_add_u32 s29, s29, 4096
  buffer_load_dwordx4 v110, s[8:11], s29 offen sc1 lds
  v_mfma_f32_16x16x32_bf16 v[152:155], a[136:139], v[44:47], v[152:155]
  s_waitcnt lgkmcnt(3)
  v_mfma_f32_16x16x32_bf16 v[156:159], a[120:123], v[48:51], v[156:159]
  s_waitcnt vmcnt(12)
  ds_read_b128 v[32:35], v67 offset:8192
  v_mfma_f32_16x16x32_bf16 v[160:163], a[124:127], v[48:51], v[160:163]
  s_sub_u32 m0, s34, 81920
  s_add_u32 s30, s30, 4096
  buffer_load_dwordx4 v110, s[8:11], s30 offen sc1 lds
  v_mfma_f32_16x16x32_bf16 v[164:167], a[128:131], v[48:51], v[164:167]
PAD5:
  s_cbranch_execz PAD6
  v_mfma_f32_16x16x32_bf16 v[168:171], a[132:135], v[48:51], v[168:171]
  s_sub_u32 m0, s35, 81920
  s_add_u32 s31, s31, 4096
  buffer_load_dwordx4 v110, s[8:11], s31 offen sc1 lds
  v_mfma_f32_16x16x32_bf16 v[172:175], a[136:139], v[48:51], v[172:175]
  s_waitcnt lgkmcnt(3)
  v_mfma_f32_16x16x32_bf16 v[176:179], a[120:123], v[52:55], v[176:179]
  s_waitcnt vmcnt(13)
  ds_read_b128 v[36:39], v68 offset:8192
  v_mfma_f32_16x16x32_bf16 v[180:183], a[124:127], v[52:55], v[180:183]
  s_sub_u32 m0, s32, 77824
  s_add_u32 s28, s32, s44
  buffer_load_dwordx4 v110, s[8:11], s28 offen sc1 lds
  v_mfma_f32_16x16x32_bf16 v[184:187], a[128:131], v[52:55], v[184:187]
  v_mfma_f32_16x16x32_bf16 v[188:191], a[132:135], v[52:55], v[188:191]
  s_sub_u32 m0, s33, 77824
  s_add_u32 s29, s33, s44
  buffer_load_dwordx4 v110, s[8:11], s29 offen sc1 lds
  v_mfma_f32_16x16x32_bf16 v[192:195], a[136:139], v[52:55], v[192:195]
PAD6:
  s_cbranch_execz PAD7
  s_waitcnt lgkmcnt(3)
  v_mfma_f32_16x16x32_bf16 v[8:11], a[120:123], v[56:59], v[8:11]
  s_waitcnt vmcnt(14)
  ds_read_b128 v[40:43], v69 offset:8192
  v_mfma_f32_16x16x32_bf16 v[12:15], a[124:127], v[56:59], v[12:15]
  s_sub_u32 m0, s34, 77824
  s_add_u32 s30, s34, s44
  buffer_load_dwordx4 v110, s[8:11], s30 offen sc1 lds
  v_mfma_f32_16x16x32_bf16 v[16:19], a[128:131], v[56:59], v[16:19]
  v_mfma_f32_16x16x32_bf16 v[20:23], a[132:135], v[56:59], v[20:23]
  s_sub_u32 m0, s35, 77824
  s_add_u32 s31, s35, s44
  buffer_load_dwordx4 v110, s[8:11], s31 offen sc1 lds
  v_mfma_f32_16x16x32_bf16 v[24:27], a[136:139], v[56:59], v[24:27]
  s_waitcnt lgkmcnt(3)
  v_mfma_f32_16x16x32_bf16 v[136:139], a[140:143], v[28:31], v[136:139]
  s_waitcnt vmcnt(15)
  ds_read_b128 v[44:47], v66 offset:12288
  v_mfma_f32_16x16x32_bf16 v[140:143], a[144:147], v[28:31], v[140:143]
PAD7:
  s_cbranch_execz PAD8
  s_add_u32 m0, s32, 8192
  s_add_u32 s28, s28, 4096
  buffer_load_dwordx4 v110, s[8:11], s28 offen sc1 lds
  v_mfma_f32_16x16x32_bf16 v[144:147], a[148:151], v[28:31], v[144:147]
  v_mfma_f32_16x16x32_bf16 v[148:151], a[152:155], v[28:31], v[148:151]
  s_add_u32 m0, s33, 8192
  s_add_u32 s29, s29, 4096
  buffer_load_dwordx4 v110, s[8:11], s29 offen sc1 lds
  v_mfma_f32_16x16x32_bf16 v[152:155], a[156:159], v[28:31], v[152:155]
  s_waitcnt lgkmcnt(3)
  v_mfma_f32_16x16x32_bf16 v[156:159], a[140:143], v[32:35], v[156:159]
  s_waitcnt vmcnt(16)
  ds_read_b128 v[48:51], v67 offset:12288
  v_mfma_f32_16x16x32_bf16 v[160:163], a[144:147], v[32:35], v[160:163]
  s_add_u32 m0, s34, 8192
  s_add_u32 s30, s30, 4096
  buffer_load_dwordx4 v110, s[8:11], s30 offen sc1 lds
  v_mfma_f32_16x16x32_bf16 v[164:167], a[148:151], v[32:35], v[164:167]
  v_mfma_f32_16x16x32_bf16 v[168:171], a[152:155], v[32:35], v[168:171]
PAD8:
  s_cbranch_execz WRET
  s_add_u32 m0, s35, 8192
  s_add_u32 s31, s31, 4096
  buffer_load_dwordx4 v110, s[8:11], s31 offen sc1 lds
  v_mfma_f32_16x16x32_bf16 v[172:175], a[156:159], v[32:35], v[172:175]
  s_waitcnt lgkmcnt(3)
  v_mfma_f32_16x16x32_bf16 v[176:179], a[140:143], v[36:39], v[176:179]
  s_waitcnt vmcnt(17)
  ds_read_b128 v[52:55], v68 offset:12288
  v_mfma_f32_16x16x32_bf16 v[180:183], a[144:147], v[36:39], v[180:183]
  s_add_u32 m0, s32, 12288
  s_add_u32 s28, s28, 4096
  buffer_load_dwordx4 v110, s[8:11], s28 offen sc1 lds
  v_mfma_f32_16x16x32_bf16 v[184:187], a[148:151], v[36:39], v[184:187]
  v_mfma_f32_16x16x32_bf16 v[188:191], a[152:155], v[36:39], v[188:191]
  s_add_u32 m0, s33, 12288
  s_add_u32 s29, s29, 4096
  buffer_load_dwordx4 v110, s[8:11], s29 offen sc1 lds
  v_mfma_f32_16x16x32_bf16 v[192:195], a[156:159], v[36:39], v[192:195]
  s_waitcnt lgkmcnt(3)
  v_mfma_f32_16x16x32_bf16 v[8:11], a[140:143], v[40:43], v[8:11]
  s_waitcnt vmcnt(18)
  ds_read_b128 v[56:59], v69 offset:12288
PAD9:
  s_cbranch_execz PAD10
  v_mfma_f32_16x16x32_bf16 v[12:15], a[144:147], v[40:43], v[12:15]
  s_add_u32 m0, s34, 12288
  s_add_u32 s30, s30, 4096
  buffer_load_dwordx4 v110, s[8:11], s30 offen sc1 lds
  v_mfma_f32_16x16x32_bf16 v[16:19], a[148:151], v[40:43], v[16:19]
  v_mfma_f32_16x16x32_bf16 v[20:23], a[152:155], v[40:43], v[20:23]
  s_add_u32 m0, s35, 12288
  s_add_u32 s31, s31, 4096
  buffer_load_dwordx4 v110, s[8:11], s31 offen sc1 lds
  v_mfma_f32_16x16x32_bf16 v[24:27], a[156:159], v[40:43], v[24:27]
  s_waitcnt lgkmcnt(3)
  v_mfma_f32_16x16x32_bf16 v[136:139], a[160:163], v[44:47], v[136:139]
  s_waitcnt vmcnt(19)
  ds_read_b128 v[28:31], v66 offset:16384
  v_mfma_f32_16x16x32_bf16 v[140:143], a[164:167], v[44:47], v[140:143]
  s_add_u32 m0, s32, 16384
  s_add_u32 s28, s28, 4096
  buffer_load_dwordx4 v110, s[8:11], s28 offen sc1 lds
  v_mfma_f32_16x16x32_bf16 v[144:147], a[168:171], v[44:47], v[144:147]
PAD10:
  s_cbranch_execz PAD11
  v_mfma_f32_16x16x32_bf16 v[148:151], a[172:175], v[44:47], v[148:151]
  s_add_u32 m0, s33, 16384
  s_add_u32 s29, s29, 4096
  buffer_load_dwordx4 v110, s[8:11], s29 offen sc1 lds
  v_mfma_f32_16x16x32_bf16 v[152:155], a[176:179], v[44:47], v[152:155]
  s_waitcnt lgkmcnt(3)
  v_mfma_f32_16x16x32_bf16 v[156:159], a[160:163], v[48:51], v[156:159]
  s_waitcnt vmcnt(20)
  ds_read_b128 v[32:35], v67 offset:16384
  v_mfma_f32_16x16x32_bf16 v[160:163], a[164:167], v[48:51], v[160:163]
  s_add_u32 m0, s34, 16384
  s_add_u32 s30, s30, 4096
  buffer_load_dwordx4 v110, s[8:11], s30 offen sc1 lds
  v_mfma_f32_16x16x32_bf16 v[164:167], a[168:171], v[48:51], v[164:167]
  v_mfma_f32_16x16x32_bf16 v[168:171], a[172:175], v[48:51], v[168:171]
  s_add_u32 m0, s35, 16384
  s_add_u32 s31, s31, 4096
  buffer_load_dwordx4 v110, s[8:11], s31 offen sc1 lds
  v_mfma_f32_16x16x32_bf16 v[172:175], a[176:179], v[48:51], v[172:175]
PAD11:
  s_cbranch_execz PAD12
  s_waitcnt lgkmcnt(3)
  v_mfma_f32_16x16x32_bf16 v[176:179], a[160:163], v[52:55], v[176:179]
  s_waitcnt vmcnt(21)
  ds_read_b128 v[36:39], v68 offset:16384
  v_mfma_f32_16x16x32_bf16 v[180:183], a[164:167], v[52:55], v[180:183]
  s_add_u32 m0, s32, 0
  s_add_u32 s28, s28, 4096
  buffer_load_dwordx4 v110, s[8:11], s28 offen sc1 lds
  v_mfma_f32_16x16x32_bf16 v[184:187], a[168:171], v[52:55], v[184:187]
  v_mfma_f32_16x16x32_bf16 v[188:191], a[172:175], v[52:55], v[188:191]
  s_add_u32 m0, s32, 4096
  s_add_u32 s28, s28, 4096
  buffer_load_dwordx4 v110, s[8:11], s28 offen sc1 lds
  v_mfma_f32_16x16x32_bf16 v[192:195], a[176:179], v[52:55], v[192:195]
  s_waitcnt lgkmcnt(3)
  v_mfma_f32_16x16x32_bf16 v[8:11], a[160:163], v[56:59], v[8:11]
  s_waitcnt vmcnt(22)
  ds_read_b128 v[40:43], v69 offset:16384
  v_mfma_f32_16x16x32_bf16 v[12:15], a[164:167], v[56:59], v[12:15]
PAD12:
  s_cbranch_execz PAD13
  s_add_u32 m0, s33, 0
  s_add_u32 s29, s29, 4096
  buffer_load_dwordx4 v110, s[8:11], s29 offen sc1 lds
  v_mfma_f32_16x16x32_bf16 v[16:19], a[168:171], v[56:59], v[16:19]
  v_mfma_f32_16x16x32_bf16 v[20:23], a[172:175], v[56:59], v[20:23]
  s_add_u32 m0, s33, 4096
  s_add_u32 s29, s29, 4096
  buffer_load_dwordx4 v110, s[8:11], s29 offen sc1 lds
  v_mfma_f32_16x16x32_bf16 v[24:27], a[176:179], v[56:59], v[24:27]
  s_waitcnt lgkmcnt(3)
  v_mfma_f32_16x16x32_bf16 v[136:139], a[180:183], v[28:31], v[136:139]
  s_waitcnt vmcnt(23)
  ds_read_b128 v[44:47], v66 offset:0
  v_mfma_f32_16x16x32_bf16 v[140:143], a[184:187], v[28:31], v[140:143]
  s_add_u32 m0, s34, 0
  s_add_u32 s30, s30, 4096
  buffer_load_dwordx4 v110, s[8:11], s30 offen sc1 lds
  v_mfma_f32_16x16x32_bf16 v[144:147], a[188:191], v[28:31], v[144:147]
  v_mfma_f32_16x16x32_bf16 v[148:151], a[192:195], v[28:31], v[148:151]
PAD13:
  s_cbranch_execz PAD14
  s_add_u32 m0, s34, 4096
  s_add_u32 s30, s30, 4096
  buffer_load_dwordx4 v110, s[8:11], s30 offen sc1 lds
  v_mfma_f32_16x16x32_bf16 v[152:155], a[196:199], v[28:31], v[152:155]
  s_waitcnt lgkmcnt(3)
  v_mfma_f32_16x16x32_bf16 v[156:159], a[180:183], v[32:35], v[156:159]
  s_waitcnt vmcnt(24)
  ds_read_b128 v[48:51], v67 offset:0
  v_mfma_f32_16x16x32_bf16 v[160:163], a[184:187], v[32:35], v[160:163]
  s_add_u32 m0, s35, 0
  s_add_u32 s31, s31, 4096
  buffer_load_dwordx4 v110, s[8:11], s31 offen sc1 lds
  v_mfma_f32_16x16x32_bf16 v[164:167], a[188:191], v[32:35], v[164:167]
  v_mfma_f32_16x16x32_bf16 v[168:171], a[192:195], v[32:35], v[168:171]
  s_add_u32 m0, s35, 4096
  s_add_u32 s31, s31, 4096
  buffer_load_dwordx4 v110, s[8:11], s31 offen sc1 lds
  v_mfma_f32_16x16x32_bf16 v[172:175], a[196:199], v[32:35], v[172:175]
  s_waitcnt lgkmcnt(3)
  v_mfma_f32_16x16x32_bf16 v[176:179], a[180:183], v[36:39], v[176:179]
  s_waitcnt vmcnt(25)
  ds_read_b128 v[52:55], v68 offset:0
PAD14:
  s_cbranch_execz PAD15
  v_mfma_f32_16x16x32_bf16 v[180:183], a[184:187], v[36:39], v[180:183]
  v_mfma_f32_16x16x32_bf16 v[184:187], a[188:191], v[36:39], v[184:187]
  v_mfma_f32_16x16x32_bf16 v[188:191], a[192:195], v[36:39], v[188:191]
  v_mfma_f32_16x16x32_bf16 v[192:195], a[196:199], v[36:39], v[192:195]
  s_waitcnt lgkmcnt(3)
  v_mfma_f32_16x16x32_bf16 v[8:11], a[180:183], v[40:43], v[8:11]
  s_waitcnt vmcnt(24)
  ds_read_b128 v[56:59], v69 offset:0
  v_mfma_f32_16x16x32_bf16 v[12:15], a[184:187], v[40:43], v[12:15]
  v_mfma_f32_16x16x32_bf16 v[16:19], a[188:191], v[40:43], v[16:19]
PAD15:
  s_cbranch_execz PAD16
  v_mfma_f32_16x16x32_bf16 v[20:23], a[192:195], v[40:43], v[20:23]
  v_mfma_f32_16x16x32_bf16 v[24:27], a[196:199], v[40:43], v[24:27]
  s_waitcnt lgkmcnt(3)
  v_mfma_f32_16x16x32_bf16 v[136:139], v[196:199], v[44:47], v[136:139]
  s_waitcnt vmcnt(23)
  ds_read_b128 v[28:31], v66 offset:4096
  v_mfma_f32_16x16x32_bf16 v[140:143], v[200:203], v[44:47], v[140:143]
  v_mfma_f32_16x16x32_bf16 v[144:147], v[204:207], v[44:47], v[144:147]
  v_mfma_f32_16x16x32_bf16 v[148:151], v[208:211], v[44:47], v[148:151]
  v_mfma_f32_16x16x32_bf16 v[152:155], v[212:215], v[44:47], v[152:155]
PAD16:
  s_cbranch_execz PAD17
  s_waitcnt lgkmcnt(3)
  v_mfma_f32_16x16x32_bf16 v[156:159], v[196:199], v[48:51], v[156:159]
  s_waitcnt vmcnt(22)
  ds_read_b128 v[32:35], v67 offset:4096
  v_mfma_f32_16x16x32_bf16 v[160:163], v[200:203], v[48:51], v[160:163]
  v_mfma_f32_16x16x32_bf16 v[164:167], v[204:207], v[48:51], v[164:167]
  v_mfma_f32_16x16x32_bf16 v[168:171], v[208:211], v[48:51], v[168:171]
  v_mfma_f32_16x16x32_bf16 v[172:175], v[212:215], v[48:51], v[172:175]
  s_waitcnt lgkmcnt(3)
  v_mfma_f32_16x16x32_bf16 v[176:179], v[196:199], v[52:55], v[176:179]
  s_waitcnt vmcnt(21)
  ds_read_b128 v[36:39], v68 offset:4096
  v_mfma_f32_16x16x32_bf16 v[180:183], v[200:203], v[52:55], v[180:183]
PAD17:
  s_cbranch_execz PAD18
  v_mfma_f32_16x16x32_bf16 v[184:187], v[204:207], v[52:55], v[184:187]
  v_mfma_f32_16x16x32_bf16 v[188:191], v[208:211], v[52:55], v[188:191]
  v_mfma_f32_16x16x32_bf16 v[192:195], v[212:215], v[52:55], v[192:195]
  s_waitcnt lgkmcnt(3)
  v_mfma_f32_16x16x32_bf16 v[8:11], v[196:199], v[56:59], v[8:11]
  s_waitcnt vmcnt(20)
  ds_read_b128 v[40:43], v69 offset:4096
  v_mfma_f32_16x16x32_bf16 v[12:15], v[200:203], v[56:59], v[12:15]
  v_mfma_f32_16x16x32_bf16 v[16:19], v[204:207], v[56:59], v[16:19]
  v_mfma_f32_16x16x32_bf16 v[20:23], v[208:211], v[56:59], v[20:23]
PAD18:
  s_cbranch_execz WRET
  v_mfma_f32_16x16x32_bf16 v[24:27], v[212:215], v[56:59], v[24:27]
  s_waitcnt lgkmcnt(3)
  v_mfma_f32_16x16x32_bf16 v[136:139], v[216:219], v[28:31], v[136:139]
  s_waitcnt vmcnt(19)
  ds_read_b128 v[44:47], v60 offset:8192
  v_mfma_f32_16x16x32_bf16 v[140:143], v[220:223], v[28:31], v[140:143]
  v_mfma_f32_16x16x32_bf16 v[144:147], v[224:227], v[28:31], v[144:147]
  v_mfma_f32_16x16x32_bf16 v[148:151], v[228:231], v[28:31], v[148:151]
  v_mfma_f32_16x16x32_bf16 v[152:155], v[232:235], v[28:31], v[152:155]
  s_waitcnt lgkmcnt(3)
  v_mfma_f32_16x16x32_bf16 v[156:159], v[216:219], v[32:35], v[156:159]
  s_waitcnt vmcnt(18)
  ds_read_b128 v[48:51], v61 offset:8192
PAD19:
  s_cbranch_execz PAD20
  v_mfma_f32_16x16x32_bf16 v[160:163], v[220:223], v[32:35], v[160:163]
  v_mfma_f32_16x16x32_bf16 v[164:167], v[224:227], v[32:35], v[164:167]
  v_mfma_f32_16x16x32_bf16 v[168:171], v[228:231], v[32:35], v[168:171]
  v_mfma_f32_16x16x32_bf16 v[172:175], v[232:235], v[32:35], v[172:175]
  s_waitcnt lgkmcnt(3)
  v_mfma_f32_16x16x32_bf16 v[176:179], v[216:219], v[36:39], v[176:179]
  s_waitcnt vmcnt(17)
  ds_read_b128 v[52:55], v62 offset:8192
  v_mfma_f32_16x16x32_bf16 v[180:183], v[220:223], v[36:39], v[180:183]
  v_mfma_f32_16x16x32_bf16 v[184:187], v[224:227], v[36:39], v[184:187]
PAD20:
  s_cbranch_execz PAD21
  v_mfma_f32_16x16x32_bf16 v[188:191], v[228:231], v[36:39], v[188:191]
  v_mfma_f32_16x16x32_bf16 v[192:195], v[232:235], v[36:39], v[192:195]
  s_waitcnt lgkmcnt(3)
  s_or_b32 s7, s5, s6
  s_cmp_lg_u32 s7, 0
  s_cbranch_scc1 nowb_37
  buffer_wbl2 sc1
  s_branch wbe_38
nowb_37:
  buffer_load_dword v1, off, s[8:11], 0
wbe_38:
  v_mfma_f32_16x16x32_bf16 v[8:11], v[216:219], v[40:43], v[8:11]
  s_waitcnt vmcnt(17)
  ds_read_b128 v[56:59], v63 offset:8192
  v_mfma_f32_16x16x32_bf16 v[12:15], v[220:223], v[40:43], v[12:15]
  v_mfma_f32_16x16x32_bf16 v[16:19], v[224:227], v[40:43], v[16:19]
  v_mfma_f32_16x16x32_bf16 v[20:23], v[228:231], v[40:43], v[20:23]
  v_mfma_f32_16x16x32_bf16 v[24:27], v[232:235], v[40:43], v[24:27]
PAD21:
  s_cbranch_execz PAD22
  s_waitcnt lgkmcnt(3)
  v_mfma_f32_16x16x32_bf16 v[136:139], v[236:239], v[44:47], v[136:139]
  s_waitcnt vmcnt(16)
  ds_read_b128 v[28:31], v60 offset:12288
  v_mfma_f32_16x16x32_bf16 v[140:143], v[240:243], v[44:47], v[140:143]
  v_mfma_f32_16x16x32_bf16 v[144:147], v[244:247], v[44:47], v[144:147]
  v_mfma_f32_16x16x32_bf16 v[148:151], v[248:251], v[44:47], v[148:151]
  v_mfma_f32_16x16x32_bf16 v[152:155], v[252:255], v[44:47], v[152:155]
  s_waitcnt lgkmcnt(3)
  v_mfma_f32_16x16x32_bf16 v[156:159], v[236:239], v[48:51], v[156:159]
  s_waitcnt vmcnt(15)
  ds_read_b128 v[32:35], v61 offset:12288
  v_mfma_f32_16x16x32_bf16 v[160:163], v[240:243], v[48:51], v[160:163]
PAD22:
  s_cbranch_execz PAD23
  v_mfma_f32_16x16x32_bf16 v[164:167], v[244:247], v[48:51], v[164:167]
  v_mfma_f32_16x16x32_bf16 v[168:171], v[248:251], v[48:51], v[168:171]
  v_mfma_f32_16x16x32_bf16 v[172:175], v[252:255], v[48:51], v[172:175]
  s_waitcnt lgkmcnt(3)
  v_mfma_f32_16x16x32_bf16 v[176:179], v[236:239], v[52:55], v[176:179]
  s_waitcnt vmcnt(14)
  ds_read_b128 v[36:39], v62 offset:12288
  v_mfma_f32_16x16x32_bf16 v[180:183], v[240:243], v[52:55], v[180:183]
  v_mfma_f32_16x16x32_bf16 v[184:187], v[244:247], v[52:55], v[184:187]
  v_mfma_f32_16x16x32_bf16 v[188:191], v[248:251], v[52:55], v[188:191]
PAD23:
  s_cbranch_execz PAD24
  v_mfma_f32_16x16x32_bf16 v[192:195], v[252:255], v[52:55], v[192:195]
  s_waitcnt lgkmcnt(3)
  v_mfma_f32_16x16x32_bf16 v[8:11], v[236:239], v[56:59], v[8:11]
  s_waitcnt vmcnt(13)
  ds_read_b128 v[40:43], v63 offset:12288
  v_mfma_f32_16x16x32_bf16 v[12:15], v[240:243], v[56:59], v[12:15]
  v_mfma_f32_16x16x32_bf16 v[16:19], v[244:247], v[56:59], v[16:19]
  v_mfma_f32_16x16x32_bf16 v[20:23], v[248:251], v[56:59], v[20:23]
  v_mfma_f32_16x16x32_bf16 v[24:27], v[252:255], v[56:59], v[24:27]
  s_waitcnt lgkmcnt(3)
  v_mfma_f32_16x16x32_bf16 v[136:139], a[200:203], v[28:31], v[136:139]
  s_waitcnt vmcnt(12)
  ds_read_b128 v[44:47], v60 offset:16384
PAD24:
  s_cbranch_execz PAD25
  v_mfma_f32_16x16x32_bf16 v[140:143], a[204:207], v[28:31], v[140:143]
  v_mfma_f32_16x16x32_bf16 v[144:147], a[208:211], v[28:31], v[144:147]
  v_mfma_f32_16x16x32_bf16 v[148:151], a[212:215], v[28:31], v[148:151]
  v_mfma_f32_16x16x32_bf16 v[152:155], a[216:219], v[28:31], v[152:155]
  s_waitcnt lgkmcnt(3)
  v_mfma_f32_16x16x32_bf16 v[156:159], a[200:203], v[32:35], v[156:159]
  s_waitcnt vmcnt(11)
  ds_read_b128 v[48:51], v61 offset:16384
  v_mfma_f32_16x16x32_bf16 v[160:163], a[204:207], v[32:35], v[160:163]
  v_mfma_f32_16x16x32_bf16 v[164:167], a[208:211], v[32:35], v[164:167]
PAD25:
  s_cbranch_execz PAD26
  v_mfma_f32_16x16x32_bf16 v[168:171], a[212:215], v[32:35], v[168:171]
  v_mfma_f32_16x16x32_bf16 v[172:175], a[216:219], v[32:35], v[172:175]
  s_waitcnt lgkmcnt(3)
  v_mfma_f32_16x16x32_bf16 v[176:179], a[200:203], v[36:39], v[176:179]
  s_waitcnt vmcnt(10)
  ds_read_b128 v[52:55], v62 offset:16384
  v_mfma_f32_16x16x32_bf16 v[180:183], a[204:207], v[36:39], v[180:183]
  v_mfma_f32_16x16x32_bf16 v[184:187], a[208:211], v[36:39], v[184:187]
  v_mfma_f32_16x16x32_bf16 v[188:191], a[212:215], v[36:39], v[188:191]
  v_mfma_f32_16x16x32_bf16 v[192:195], a[216:219], v[36:39], v[192:195]
PAD26:
  s_cbranch_execz PAD27
  s_waitcnt lgkmcnt(3)
  v_mfma_f32_16x16x32_bf16 v[8:11], a[200:203], v[40:43], v[8:11]
  s_waitcnt vmcnt(9)
  ds_read_b128 v[56:59], v63 offset:16384
  v_mfma_f32_16x16x32_bf16 v[12:15], a[204:207], v[40:43], v[12:15]
  v_mfma_f32_16x16x32_bf16 v[16:19], a[208:211], v[40:43], v[16:19]
  v_mfma_f32_16x16x32_bf16 v[20:23], a[212:215], v[40:43], v[20:23]
  v_mfma_f32_16x16x32_bf16 v[24:27], a[216:219], v[40:43], v[24:27]
  s_waitcnt lgkmcnt(3)
  s_barrier
  v_mfma_f32_16x16x32_bf16 v[136:139], a[220:223], v[44:47], v[136:139]
  s_waitcnt vmcnt(8)
  ds_read_b128 v[28:31], v60 offset:0
  v_mfma_f32_16x16x32_bf16 v[140:143], a[224:227], v[44:47], v[140:143]
PAD27:
  s_cbranch_execz PAD28
  v_mfma_f32_16x16x32_bf16 v[144:147], a[228:231], v[44:47], v[144:147]
  v_mfma_f32_16x16x32_bf16 v[148:151], a[232:235], v[44:47], v[148:151]
  v_mfma_f32_16x16x32_bf16 v[152:155], a[236:239], v[44:47], v[152:155]
  s_waitcnt lgkmcnt(3)
  v_mfma_f32_16x16x32_bf16 v[156:159], a[220:223], v[48:51], v[156:159]
  s_waitcnt vmcnt(7)
  ds_read_b128 v[32:35], v60 offset:4096
  v_mfma_f32_16x16x32_bf16 v[160:163], a[224:227], v[48:51], v[160:163]
  v_mfma_f32_16x16x32_bf16 v[164:167], a[228:231], v[48:51], v[164:167]
  v_mfma_f32_16x16x32_bf16 v[168:171], a[232:235], v[48:51], v[168:171]
PAD28:
  s_cbranch_execz WRET
  v_mfma_f32_16x16x32_bf16 v[172:175], a[236:239], v[48:51], v[172:175]
  s_waitcnt lgkmcnt(3)
  v_mfma_f32_16x16x32_bf16 v[176:179], a[220:223], v[52:55], v[176:179]
  s_waitcnt vmcnt(6)
  ds_read_b128 v[36:39], v61 offset:0
  v_mfma_f32_16x16x32_bf16 v[180:183], a[224:227], v[52:55], v[180:183]
  v_mfma_f32_16x16x32_bf16 v[184:187], a[228:231], v[52:55], v[184:187]
  v_mfma_f32_16x16x32_bf16 v[188:191], a[232:235], v[52:55], v[188:191]
  v_mfma_f32_16x16x32_bf16 v[192:195], a[236:239], v[52:55], v[192:195]
  s_waitcnt lgkmcnt(3)
  v_mfma_f32_16x16x32_bf16 v[8:11], a[220:223], v[56:59], v[8:11]
  s_waitcnt vmcnt(5)
  ds_read_b128 v[40:43], v61 offset:4096
PAD29:
  s_cbranch_execz PAD30
  v_mfma_f32_16x16x32_bf16 v[12:15], a[224:227], v[56:59], v[12:15]
  v_mfma_f32_16x16x32_bf16 v[16:19], a[228:231], v[56:59], v[16:19]
  v_mfma_f32_16x16x32_bf16 v[20:23], a[232:235], v[56:59], v[20:23]
  v_mfma_f32_16x16x32_bf16 v[24:27], a[236:239], v[56:59], v[24:27]
  s_waitcnt lgkmcnt(3)
  v_mfma_f32_16x16x32_bf16 v[136:139], a[240:243], v[28:31], v[136:139]
  s_waitcnt vmcnt(4)
  ds_read_b128 v[44:47], v62 offset:0
  v_mfma_f32_16x16x32_bf16 v[140:143], a[244:247], v[28:31], v[140:143]
  v_mfma_f32_16x16x32_bf16 v[144:147], a[248:251], v[28:31], v[144:147]
PAD30:
  s_cbranch_execz PAD31
  v_mfma_f32_16x16x32_bf16 v[148:151], a[252:255], v[28:31], v[148:151]
  v_mfma_f32_16x16x32_bf16 v[152:155], v[112:115], v[28:31], v[152:155]
  s_waitcnt lgkmcnt(3)
  v_mfma_f32_16x16x32_bf16 v[136:139], v[116:119], v[32:35], v[136:139]
  s_waitcnt vmcnt(3)
  ds_read_b128 v[48:51], v62 offset:4096
  v_mfma_f32_16x16x32_bf16 v[140:143], v[120:123], v[32:35], v[140:143]
  v_mfma_f32_16x16x32_bf16 v[144:147], v[124:127], v[32:35], v[144:147]
  v_mfma_f32_16x16x32_bf16 v[148:151], v[128:131], v[32:35], v[148:151]
  v_mfma_f32_16x16x32_bf16 v[152:155], v[132:135], v[32:35], v[152:155]
PAD31:
  s_cbranch_execz PAD32
  s_waitcnt lgkmcnt(3)
  v_mfma_f32_16x16x32_bf16 v[156:159], a[240:243], v[36:39], v[156:159]
  s_waitcnt vmcnt(2)
  ds_read_b128 v[52:55], v63 offset:0
  v_mfma_f32_16x16x32_bf16 v[160:163], a[244:247], v[36:39], v[160:163]
  ds_write_b128 v86, v[136:139] offset:0
  v_mfma_f32_16x16x32_bf16 v[164:167], a[248:251], v[36:39], v[164:167]
  ds_write_b128 v86, v[140:143] offset:1024
  v_mfma_f32_16x16x32_bf16 v[168:171], a[252:255], v[36:39], v[168:171]
  ds_write_b128 v86, v[144:147] offset:2048
  v_mfma_f32_16x16x32_bf16 v[172:175], v[112:115], v[36:39], v[172:175]
  ds_write_b128 v86, v[148:151] offset:3072
  s_waitcnt lgkmcnt(7)
  v_mfma_f32_16x16x32_bf16 v[156:159], v[116:119], v[40:43], v[156:159]
  s_waitcnt vmcnt(1)
  ds_read_b128 v[56:59], v63 offset:4096
  v_mfma_f32_16x16x32_bf16 v[160:163], v[120:123], v[40:43], v[160:163]
PAD32:
  s_cbranch_execz PAD33
  ds_write_b128 v86, v[152:155] offset:4096
  v_mfma_f32_16x16x32_bf16 v[164:167], v[124:127], v[40:43], v[164:167]
  v_mfma_f32_16x16x32_bf16 v[168:171], v[128:131], v[40:43], v[168:171]
  v_mfma_f32_16x16x32_bf16 v[172:175], v[132:135], v[40:43], v[172:175]
  s_waitcnt lgkmcnt(8)
  v_mfma_f32_16x16x32_bf16 v[176:179], a[240:243], v[44:47], v[176:179]
  v_mfma_f32_16x16x32_bf16 v[180:183], a[244:247], v[44:47], v[180:183]
  ds_write_b128 v87, v[156:159] offset:0
  v_mfma_f32_16x16x32_bf16 v[184:187], a[248:251], v[44:47], v[184:187]
  ds_write_b128 v87, v[160:163] offset:1024
  v_mfma_f32_16x16x32_bf16 v[188:191], a[252:255], v[44:47], v[188:191]
PAD33:
  s_cbranch_execz PAD34
  ds_write_b128 v87, v[164:167] offset:2048
  v_mfma_f32_16x16x32_bf16 v[192:195], v[112:115], v[44:47], v[192:195]
  ds_write_b128 v87, v[168:171] offset:3072
  s_waitcnt lgkmcnt(11)
  v_mfma_f32_16x16x32_bf16 v[176:179], v[116:119], v[48:51], v[176:179]
  v_mfma_f32_16x16x32_bf16 v[180:183], v[120:123], v[48:51], v[180:183]
  ds_write_b128 v87, v[172:175] offset:4096
  v_mfma_f32_16x16x32_bf16 v[184:187], v[124:127], v[48:51], v[184:187]
  v_mfma_f32_16x16x32_bf16 v[188:191], v[128:131], v[48:51], v[188:191]
  v_mfma_f32_16x16x32_bf16 v[192:195], v[132:135], v[48:51], v[192:195]
  s_waitcnt lgkmcnt(11)
  v_mfma_f32_16x16x32_bf16 v[8:11], a[240:243], v[52:55], v[8:11]
PAD34:
  s_cbranch_execz PAD35
  v_mfma_f32_16x16x32_bf16 v[12:15], a[244:247], v[52:55], v[12:15]
  ds_write_b128 v88, v[176:179] offset:0
  v_mfma_f32_16x16x32_bf16 v[16:19], a[248:251], v[52:55], v[16:19]
  ds_write_b128 v88, v[180:183] offset:1024
  v_mfma_f32_16x16x32_bf16 v[20:23], a[252:255], v[52:55], v[20:23]
  ds_write_b128 v88, v[184:187] offset:2048
  v_mfma_f32_16x16x32_bf16 v[24:27], v[112:115], v[52:55], v[24:27]
  ds_write_b128 v88, v[188:191] offset:3072
  s_waitcnt lgkmcnt(10)
  v_mfma_f32_16x16x32_bf16 v[8:11], v[116:119], v[56:59], v[8:11]
  v_mfma_f32_16x16x32_bf16 v[12:15], v[120:123], v[56:59], v[12:15]
  ds_write_b128 v88, v[192:195] offset:4096
  v_mfma_f32_16x16x32_bf16 v[16:19], v[124:127], v[56:59], v[16:19]
PAD35:
  s_cbranch_execz PAD36
  v_mfma_f32_16x16x32_bf16 v[20:23], v[128:131], v[56:59], v[20:23]
  v_mfma_f32_16x16x32_bf16 v[24:27], v[132:135], v[56:59], v[24:27]
  s_waitcnt lgkmcnt(0)
  s_barrier
PAD36:
  s_cbranch_execz PAD37
  ds_read_b128 v[136:139], v89 offset:0
  ds_read_b128 v[156:159], v89 offset:5120
  ds_read_b128 v[176:179], v89 offset:10240
  ds_read_b128 v[140:143], v89 offset:1024
  ds_read_b128 v[160:163], v89 offset:6144
  ds_read_b128 v[180:183], v89 offset:11264
  ds_read_b128 v[144:147], v89 offset:2048
  ds_read_b128 v[164:167], v89 offset:7168
  ds_read_b128 v[184:187], v89 offset:12288
  ds_read_b128 v[148:151], v89 offset:3072
  ds_read_b128 v[168:171], v89 offset:8192
  ds_read_b128 v[188:191], v89 offset:13312
  ds_read_b128 v[152:155], v89 offset:4096
  ds_read_b128 v[172:175], v89 offset:9216
  ds_read_b128 v[192:195], v89 offset:14336
  s_waitcnt lgkmcnt(12)
  v_pk_add_f32 v[136:137], v[136:137], v[156:157]
  v_pk_add_f32 v[8:9], v[8:9], v[176:177]
  v_pk_add_f32 v[138:139], v[138:139], v[158:159]
  v_pk_add_f32 v[10:11], v[10:11], v[178:179]
  v_pk_add_f32 v[8:9], v[8:9], v[136:137]
  v_pk_add_f32 v[10:11], v[10:11], v[138:139]
  v_cvt_pk_bf16_f32 v28, v8, v9
  v_cvt_pk_bf16_f32 v29, v10, v11
PAD37:
  s_cbranch_execz PAD38
  s_waitcnt lgkmcnt(9)
  v_pk_add_f32 v[140:141], v[140:141], v[160:161]
  v_pk_add_f32 v[12:13], v[12:13], v[180:181]
  v_pk_add_f32 v[142:143], v[142:143], v[162:163]
  v_pk_add_f32 v[14:15], v[14:15], v[182:183]
  v_pk_add_f32 v[12:13], v[12:13], v[140:141]
  v_pk_add_f32 v[14:15], v[14:15], v[142:143]
  v_cvt_pk_bf16_f32 v30, v12, v13
  v_cvt_pk_bf16_f32 v31, v14, v15
  buffer_store_dwordx4 v[28:31], v64, s[20:23], s47 offen
  s_waitcnt lgkmcnt(6)
  v_pk_add_f32 v[144:145], v[144:145], v[164:165]
  v_pk_add_f32 v[16:17], v[16:17], v[184:185]
  v_pk_add_f32 v[146:147], v[146:147], v[166:167]
  v_pk_add_f32 v[18:19], v[18:19], v[186:187]
  v_pk_add_f32 v[16:17], v[16:17], v[144:145]
  v_pk_add_f32 v[18:19], v[18:19], v[146:147]
  v_cvt_pk_bf16_f32 v32, v16, v17
  v_cvt_pk_bf16_f32 v33, v18, v19
PAD38:
  s_cbranch_execz WRET
  s_waitcnt lgkmcnt(3)
  v_pk_add_f32 v[148:149], v[148:149], v[168:169]
  v_pk_add_f32 v[20:21], v[20:21], v[188:189]
  v_pk_add_f32 v[150:151], v[150:151], v[170:171]
  v_pk_add_f32 v[22:23], v[22:23], v[190:191]
  v_pk_add_f32 v[20:21], v[20:21], v[148:149]
  v_pk_add_f32 v[22:23], v[22:23], v[150:151]
  v_cvt_pk_bf16_f32 v34, v20, v21
  v_cvt_pk_bf16_f32 v35, v22, v23
  buffer_store_dwordx4 v[32:35], v64, s[20:23], s47 offen offset:16
  s_waitcnt lgkmcnt(0)
  v_pk_add_f32 v[152:153], v[152:153], v[172:173]
  v_pk_add_f32 v[24:25], v[24:25], v[192:193]
  v_pk_add_f32 v[154:155], v[154:155], v[174:175]
  v_pk_add_f32 v[26:27], v[26:27], v[194:195]
  v_pk_add_f32 v[24:25], v[24:25], v[152:153]
  v_pk_add_f32 v[26:27], v[26:27], v[154:155]
  v_cvt_pk_bf16_f32 v36, v24, v25
  v_cvt_pk_bf16_f32 v37, v26, v27
  buffer_store_dwordx2 v[36:37], v64, s[20:23], s47 offen offset:32
END:
  s_endpgm
.section .rodata,"a"
.p2align 6
.amdhsa_kernel sequential_preLN__ssm_conv_s4d__mixer_s_mlp__prompt_kernel
  .amdhsa_next_free_vgpr 512
  .amdhsa_next_free_sgpr 102
  .amdhsa_accum_offset 256
  .amdhsa_group_segment_fixed_size 0
  .amdhsa_kernarg_size 120
  .amdhsa_user_sgpr_count 2
  .amdhsa_user_sgpr_kernarg_segment_ptr 1
  .amdhsa_system_sgpr_workgroup_id_x 1
.end_amdhsa_kernel
```
